```python
import torch

def _softmax(x, axis=-1):
    return torch.softmax(x, dim=axis)
def _gelu(x):
    return torch.nn.functional.gelu(x, approximate="tanh")
def _silu(x):
    return torch.nn.functional.silu(x)
def _sigmoid(x):
    return torch.sigmoid(x)
def _layernorm(x, axis=-1, eps=1e-5):
    m = x.mean(dim=axis, keepdim=True)
    v = x.var(dim=axis, keepdim=True, unbiased=False)
    return (x - m) / torch.sqrt(v + eps)
def _scatter_add(tgt, idx, src, axis=0):
    return tgt.clone().index_add_(axis, idx, src)
def _segment_sum(src, seg, n):
    out = torch.zeros((n,) + src.shape[1:], dtype=src.dtype)
    return out.index_add_(0, seg, src)
def _pad(x, pw):
    flat = tuple(v for pair in reversed(pw) for v in pair)
    return torch.nn.functional.pad(x, flat)

kernel_name = 'concat_heads__mha_block_cached__mha_block_cached__near_ridge'

def setup_inputs():

    _w = (lambda a: (lambda t: t.to(torch.bfloat16) if t.is_floating_point() else t)(torch.as_tensor(a)))
    def _A_setup():
        B, Sq, D = 8, 240, 1024
        H, Sk, Dh = 32, 1024, 128
        return {
            "x": _w((lambda *s: torch.randn(*s, dtype=torch.bfloat16) * 0.8)(B, Sq, D)),
            "k_cache": _w((lambda *s: torch.randn(*s, dtype=torch.bfloat16) * 0.8)(B, H, Sk, Dh)),
            "v_cache": _w((lambda *s: torch.randn(*s, dtype=torch.bfloat16) * 0.05)(B, H, Sk, Dh)),
            "wq": _w((lambda *s: torch.randn(*s, dtype=torch.bfloat16) * 0.8)(D, H * Dh) * (D ** -0.5)),
            "wo": _w((lambda *s: torch.randn(*s, dtype=torch.bfloat16) * 0.05)(H * Dh, D) * ((H * Dh) ** -0.5)),
        }
    _A_in = _A_setup()

    def _B_setup():
        B, Sq, D = 8, 240, 1024
        H, Sk, Dh = 32, 1024, 128
        return {
            "x": _w((lambda *s: torch.randn(*s, dtype=torch.bfloat16) * 0.8)(B, Sq, D)),
            "k_cache": _w((lambda *s: torch.randn(*s, dtype=torch.bfloat16) * 0.8)(B, H, Sk, Dh)),
            "v_cache": _w((lambda *s: torch.randn(*s, dtype=torch.bfloat16) * 0.05)(B, H, Sk, Dh)),
            "wq": _w((lambda *s: torch.randn(*s, dtype=torch.bfloat16) * 0.8)(D, H * Dh) * (D ** -0.5)),
            "wo": _w((lambda *s: torch.randn(*s, dtype=torch.bfloat16) * 0.05)(H * Dh, D) * ((H * Dh) ** -0.5)),
        }
    _B_in = _B_setup()

    return {
        "A_x": _A_in["x"],
        "A_k_cache": _A_in["k_cache"],
        "A_v_cache": _A_in["v_cache"],
        "A_wq": _A_in["wq"],
        "A_wo": _A_in["wo"],
        "B_x": _B_in["x"],
        "B_k_cache": _B_in["k_cache"],
        "B_v_cache": _B_in["v_cache"],
        "B_wq": _B_in["wq"],
        "B_wo": _B_in["wo"],
    }

def reference(A_x, A_k_cache, A_v_cache, A_wq, A_wo, B_x, B_k_cache, B_v_cache, B_wq, B_wo):
    def _A_ref(x, k_cache, v_cache, wq, wo):
        B, Sq, D = x.shape
        H, Dh = 32, 128
        q = (lambda x, *d: x.permute(*d))((x @ wq).reshape(B, Sq, H, Dh), 0, 2, 1, 3)
        scores = torch.einsum("bhqd,bhkd->bhqk", q, k_cache) * (Dh ** -0.5)
        p = _softmax(scores, axis=-1)
        o = torch.einsum("bhqk,bhkd->bhqd", p, v_cache)
        return (lambda x, *d: x.permute(*d))(o, 0, 2, 1, 3).reshape(B, Sq, H * Dh) @ wo

    def _B_ref(x, k_cache, v_cache, wq, wo):
        B, Sq, D = x.shape
        H, Dh = 32, 128
        q = (lambda x, *d: x.permute(*d))((x @ wq).reshape(B, Sq, H, Dh), 0, 2, 1, 3)
        scores = torch.einsum("bhqd,bhkd->bhqk", q, k_cache) * (Dh ** -0.5)
        p = _softmax(scores, axis=-1)
        o = torch.einsum("bhqk,bhkd->bhqd", p, v_cache)
        return (lambda x, *d: x.permute(*d))(o, 0, 2, 1, 3).reshape(B, Sq, H * Dh) @ wo

    a = _A_ref(A_x, A_k_cache, A_v_cache, A_wq, A_wo)
    b = _B_ref(B_x, B_k_cache, B_v_cache, B_wq, B_wo)
    return torch.concatenate([a, b], axis=-1)
```

```asm
; @launch grid=(256,1,1) block=(256,1,1) lds=163840

.amdgcn_target "amdgcn-amd-amdhsa--gfx950"
.text
.globl concat_heads__mha_block_cached__mha_block_cached__near_ridge_kernel
.p2align 12
s_endpgm
.p2align 9
.p2align 8
.type concat_heads__mha_block_cached__mha_block_cached__near_ridge_kernel,@function
concat_heads__mha_block_cached__mha_block_cached__near_ridge_kernel:
    s_cmp_ge_u32 s2, 256
    s_cbranch_scc1 L_k1_end
    s_and_b32 s58, s2, 1
    s_mul_i32 s58, s58, 40
    s_add_u32 s59, s58, 32
    s_load_dwordx8 s[48:55], s[0:1], s58
    s_load_dwordx2 s[56:57], s[0:1], s59
    s_load_dwordx4 s[60:63], s[0:1], 80
    s_load_dwordx2 s[64:65], s[0:1], 96
    v_lshrrev_b32 v237, 6, v0
    v_and_b32 v0, 63, v0
    s_and_b32 s70, s2, 7
    v_readfirstlane_b32 s28, v237
    s_lshr_b32 s71, s2, 3
    s_and_b32 s31, s70, 4
    s_and_b32 s72, s71, 3
    s_add_u32 s31, s31, s72
    s_and_b32 s32, s70, 2
    s_lshl_b32 s32, s32, 2
    s_lshr_b32 s72, s71, 2
    s_add_u32 s32, s32, s72
    s_mov_b32 s38, s32
    s_lshl_b32 s29, s28, 12
    s_lshl_b32 s30, s28, 13
    s_lshl_b32 s72, s31, 5
    s_add_u32 s72, s72, s32
    s_lshl_b32 s33, s72, 18
    s_cmp_eq_u32 s28, 3
    s_cselect_b32 s66, 15, 16
    s_lshl_b32 s66, 1, s66
    s_lshr_b32 s67, s66, 4
    s_mov_b32 s68, 0x3f803f80
    s_mov_b32 s45, 0
    s_mov_b32 s46, 0
    s_mov_b32 s10, 0x4000000
    s_mov_b32 s11, 0x00020000
    s_mov_b32 s14, 0x4000000
    s_mov_b32 s15, 0x00020000
    s_mov_b32 s19, 0x00020000
    s_mov_b32 s23, 0x00020000
    s_mov_b32 s26, 31457280
    s_mov_b32 s27, 0x00020000
    v_and_b32 v237, 15, v0
    v_lshrrev_b32 v238, 4, v0
    v_lshrrev_b32 v239, 2, v237
    v_and_b32 v240, 3, v237
    v_lshlrev_b32 v241, 3, v239
    v_add_u32 v241, v241, v240
    v_lshlrev_b32 v241, 8, v241
    v_add_u32 v242, 0, v238
    v_xor_b32 v242, v242, v237
    v_lshlrev_b32 v242, 4, v242
    v_add_u32 v196, v241, v242
    v_add_u32 v242, 4, v238
    v_xor_b32 v242, v242, v237
    v_lshlrev_b32 v242, 4, v242
    v_add_u32 v197, v241, v242
    v_add_u32 v242, 8, v238
    v_xor_b32 v242, v242, v237
    v_lshlrev_b32 v242, 4, v242
    v_add_u32 v198, v241, v242
    v_add_u32 v242, 12, v238
    v_xor_b32 v242, v242, v237
    v_lshlrev_b32 v242, 4, v242
    v_add_u32 v199, v241, v242
    v_lshlrev_b32 v241, 3, v238
    v_add_u32 v241, v241, v239
    v_lshlrev_b32 v241, 8, v241
    v_and_b32 v242, 1, v240
    v_lshlrev_b32 v242, 3, v242
    v_add_u32 v241, v241, v242
    v_add_u32 v241, 0x10000, v241
    v_and_b32 v242, 1, v238
    v_lshlrev_b32 v242, 2, v242
    v_or_b32 v242, v242, v239
    v_lshlrev_b32 v242, 1, v242
    v_lshrrev_b32 v240, 1, v240
    v_add_u32 v243, 0, v240
    v_xor_b32 v243, v243, v242
    v_lshlrev_b32 v243, 4, v243
    v_add_u32 v200, v241, v243
    v_add_u32 v243, 2, v240
    v_xor_b32 v243, v243, v242
    v_lshlrev_b32 v243, 4, v243
    v_add_u32 v201, v241, v243
    v_add_u32 v243, 4, v240
    v_xor_b32 v243, v243, v242
    v_lshlrev_b32 v243, 4, v243
    v_add_u32 v202, v241, v243
    v_add_u32 v243, 6, v240
    v_xor_b32 v243, v243, v242
    v_lshlrev_b32 v243, 4, v243
    v_add_u32 v203, v241, v243
    v_add_u32 v243, 8, v240
    v_xor_b32 v243, v243, v242
    v_lshlrev_b32 v243, 4, v243
    v_add_u32 v204, v241, v243
    v_add_u32 v243, 10, v240
    v_xor_b32 v243, v243, v242
    v_lshlrev_b32 v243, 4, v243
    v_add_u32 v205, v241, v243
    v_add_u32 v243, 12, v240
    v_xor_b32 v243, v243, v242
    v_lshlrev_b32 v243, 4, v243
    v_add_u32 v206, v241, v243
    v_add_u32 v243, 14, v240
    v_xor_b32 v243, v243, v242
    v_lshlrev_b32 v243, 4, v243
    v_add_u32 v207, v241, v243
    v_lshlrev_b32 v241, 8, v238
    v_add_u32 v241, s29, v241
    s_lshl_b32 s72, s28, 1
    s_add_u32 s72, s72, 0
    s_and_b32 s72, s72, 3
    s_lshl_b32 s72, s72, 2
    v_or_b32 v242, s72, v238
    v_xor_b32 v242, v242, v237
    v_lshlrev_b32 v242, 4, v242
    v_add_u32 v208, v241, v242
    v_or_b32 v242, 0, v238
    v_lshlrev_b32 v242, 1, v242
    v_xor_b32 v242, v242, v237
    v_lshlrev_b32 v242, 4, v242
    v_add_u32 v210, v241, v242
    s_lshl_b32 s72, s28, 1
    s_add_u32 s72, s72, 1
    s_and_b32 s72, s72, 3
    s_lshl_b32 s72, s72, 2
    v_or_b32 v242, s72, v238
    v_xor_b32 v242, v242, v237
    v_lshlrev_b32 v242, 4, v242
    v_add_u32 v209, v241, v242
    v_or_b32 v242, 4, v238
    v_lshlrev_b32 v242, 1, v242
    v_xor_b32 v242, v242, v237
    v_lshlrev_b32 v242, 4, v242
    v_add_u32 v211, v241, v242
    s_lshl_b32 s72, s28, 4
    v_add_u32 v241, s72, v238
    v_lshlrev_b32 v241, 13, v241
    v_or_b32 v242, 0, v238
    v_lshlrev_b32 v242, 1, v242
    v_xor_b32 v242, v242, v237
    v_lshlrev_b32 v242, 4, v242
    v_add_u32 v242, v241, v242
    v_add_u32 v212, 0, v242
    v_or_b32 v242, 0, v238
    v_lshlrev_b32 v242, 1, v242
    v_xor_b32 v242, v242, v237
    v_lshlrev_b32 v242, 4, v242
    v_add_u32 v242, v241, v242
    v_add_u32 v213, 31744, v242
    v_or_b32 v242, 4, v238
    v_lshlrev_b32 v242, 1, v242
    v_xor_b32 v242, v242, v237
    v_lshlrev_b32 v242, 4, v242
    v_add_u32 v242, v241, v242
    v_add_u32 v214, 63488, v242
    v_or_b32 v242, 4, v238
    v_lshlrev_b32 v242, 1, v242
    v_xor_b32 v242, v242, v237
    v_lshlrev_b32 v242, 4, v242
    v_add_u32 v242, v241, v242
    v_add_u32 v215, 95232, v242
    v_lshrrev_b32 v241, 3, v0
    v_and_b32 v242, 7, v0
    v_xor_b32 v242, v242, v241
    v_lshlrev_b32 v242, 4, v242
    s_lshl_b32 s72, s28, 6
    v_add_u32 v241, s72, v241
    v_lshlrev_b32 v241, 11, v241
    v_add_u32 v241, v241, v242
    v_add_u32 v216, 0, v241
    v_add_u32 v217, 15360, v241
    v_add_u32 v218, 30720, v241
    v_add_u32 v219, 46080, v241
    v_lshlrev_b32 v241, 7, v237
    v_add_u32 v241, s30, v241
    v_and_b32 v243, 7, v237
    v_add_u32 v242, 0, v238
    v_xor_b32 v242, v242, v243
    v_lshlrev_b32 v242, 4, v242
    v_add_u32 v220, v241, v242
    v_add_u32 v242, 4, v238
    v_xor_b32 v242, v242, v243
    v_lshlrev_b32 v242, 4, v242
    v_add_u32 v221, v241, v242
    s_lshl_b32 s72, s28, 6
    v_add_u32 v241, s72, v237
    v_lshlrev_b32 v241, 4, v241
    v_mul_u32_u24 v242, 30720, v238
    v_add_u32 v236, v241, v242
    s_mul_i32 s70, s32, 491520
    s_mul_i32 s71, s31, 3840
    s_add_u32 s70, s70, s71
    s_and_b32 s71, s2, 1
    s_mul_i32 s71, s71, 15728640
    s_add_u32 s70, s70, s71
    v_add_u32 v236, s70, v236
    s_waitcnt lgkmcnt(0)
    s_mov_b32 s24, s64
    s_mov_b32 s25, s65
L_k1_cold:
    s_mov_b32 s16, s48
    s_mov_b32 s17, s49
    s_mov_b32 s18, 3932160
    s_mov_b32 s20, s54
    s_mov_b32 s21, s55
    s_mov_b32 s22, 8388608
    s_mov_b32 s8, s50
    s_mov_b32 s9, s51
    s_mov_b32 s12, s52
    s_mov_b32 s13, s53
    s_lshl_b32 s70, s45, 4
    s_add_u32 s32, s38, s70
    s_mov_b32 s3, 0
    s_mul_i32 s36, s31, 491520
    s_lshl_b32 s35, s32, 8
    s_lshr_b32 s70, s32, 3
    s_lshl_b32 s70, s70, 1
    s_add_u32 s70, s70, s31
    s_lshl_b32 s70, s70, 1
    s_and_b32 s71, s32, 3
    s_add_u32 s70, s70, s71
    s_and_b32 s70, s70, 15
    s_lshl_b32 s71, s70, 7
    s_add_u32 s36, s36, s71
    s_lshl_b32 s71, s70, 19
    s_add_u32 s35, s35, s71
    s_add_u32 s37, s36, s66
    s_add_u32 m0, s29, 65536
    s_nop 0
    buffer_load_dwordx4 v212, s[20:23], s35 offen offset:0 lds
    buffer_load_dwordx4 v213, s[20:23], s35 offen offset:1024 lds
    buffer_load_dwordx4 v214, s[20:23], s35 offen offset:2048 lds
    buffer_load_dwordx4 v215, s[20:23], s35 offen offset:3072 lds
    s_add_u32 s35, s35, 524288
    s_bitset0_b32 s35, 23
    s_add_u32 m0, s30, 131072
    s_nop 0
    buffer_load_dwordx4 v216, s[16:19], s36 offen offset:0 lds
    buffer_load_dwordx4 v217, s[16:19], s36 offen offset:1024 lds
    buffer_load_dwordx4 v218, s[16:19], s36 offen offset:2048 lds
    buffer_load_dwordx4 v219, s[16:19], s36 offen offset:3072 lds
    s_add_u32 m0, m0, s67
    s_nop 0
    buffer_load_dwordx4 v216, s[16:19], s37 offen offset:0 lds
    buffer_load_dwordx4 v217, s[16:19], s37 offen offset:1024 lds
    buffer_load_dwordx4 v218, s[16:19], s37 offen offset:2048 lds
    buffer_load_dwordx4 v219, s[16:19], s37 offen offset:3072 lds
    s_add_u32 s36, s36, 128
    s_bitset0_b32 s36, 11
    s_add_u32 s37, s37, 128
    s_bitset0_b32 s37, 11
    s_add_u32 m0, s29, 81920
    s_nop 0
    buffer_load_dwordx4 v212, s[20:23], s35 offen offset:0 lds
    buffer_load_dwordx4 v213, s[20:23], s35 offen offset:1024 lds
    buffer_load_dwordx4 v214, s[20:23], s35 offen offset:2048 lds
    buffer_load_dwordx4 v215, s[20:23], s35 offen offset:3072 lds
    s_add_u32 s35, s35, 524288
    s_bitset0_b32 s35, 23
    s_mov_b32 m0, s30
    s_nop 0
    buffer_load_dwordx4 v216, s[16:19], s36 offen offset:0 lds
    buffer_load_dwordx4 v217, s[16:19], s36 offen offset:1024 lds
    buffer_load_dwordx4 v218, s[16:19], s36 offen offset:2048 lds
    buffer_load_dwordx4 v219, s[16:19], s36 offen offset:3072 lds
    s_add_u32 m0, m0, s67
    s_nop 0
    buffer_load_dwordx4 v216, s[16:19], s37 offen offset:0 lds
    buffer_load_dwordx4 v217, s[16:19], s37 offen offset:1024 lds
    buffer_load_dwordx4 v218, s[16:19], s37 offen offset:2048 lds
    buffer_load_dwordx4 v219, s[16:19], s37 offen offset:3072 lds
    s_add_u32 s36, s36, 128
    s_bitset0_b32 s36, 11
    s_add_u32 s37, s37, 128
    s_bitset0_b32 s37, 11
    s_mov_b32 s40, 131072
    s_mov_b32 s41, 0
    s_mov_b32 s42, 32768
    s_mov_b32 s43, 0
    s_add_u32 s39, s29, 114688
    v_mov_b32 v224, v200
    v_mov_b32 v225, v201
    v_mov_b32 v226, v202
    v_mov_b32 v227, v203
    v_mov_b32 v228, v204
    v_mov_b32 v229, v205
    v_mov_b32 v230, v206
    v_mov_b32 v231, v207
    v_add_u32 v222, 131072, v220
    v_add_u32 v223, 131072, v221
    v_mbcnt_lo_u32_b32 v237, -1, 0
    v_mbcnt_hi_u32_b32 v237, -1, v237
    s_and_b32 s70, s2, 7
    s_lshr_b32 s71, s2, 3
    v_lshlrev_b32 v195, 2, v237
    v_and_b32 v238, 15, v237
    v_lshrrev_b32 v239, 4, v237
    s_and_b32 s72, s70, 4
    s_lshl_b32 s72, s72, 1
    s_lshr_b32 s73, s71, 2
    s_add_u32 s72, s72, s73
    s_and_b32 s73, s71, 3
    s_and_b32 s58, s70, 4
    s_lshr_b32 s58, s58, 1
    s_and_b32 s59, s71, 1
    s_add_u32 s58, s58, s59
    s_cmp_ge_u32 s71, 28
    s_cselect_b32 s72, 7, s72
    s_cselect_b32 s73, s58, s73
    s_and_b32 s58, s70, 2
    s_lshl_b32 s58, s58, 1
    s_add_u32 s73, s73, s58
    s_lshl_b32 s58, s73, 8
    s_and_b32 s70, s70, 1
    s_lshl_b32 s71, s70, 3
    s_lshr_b32 s101, s72, 1
    s_add_u32 s101, s101, s71
    s_lshl_b32 s101, s101, 2
    s_add_u32 s59, s72, 1
    s_lshr_b32 s59, s59, 1
    s_add_u32 s59, s59, s71
    s_lshl_b32 s59, s59, 2
    s_lshl_b32 s72, s72, 7
    s_lshl_b32 s71, s28, 5
    s_add_u32 s72, s72, s71
    v_add_u32 v238, s72, v238
    s_mul_i32 s70, s70, 15728640
    v_mul_u32_u24 v237, 30720, v239
    v_lshlrev_b32 v193, 4, v238
    v_add_u32 v193, v193, v237
    v_add_u32 v193, s70, v193
    v_lshlrev_b32 v194, 12, v238
    v_lshlrev_b32 v239, 4, v239
    v_add_u32 v194, v194, v239
    v_mov_b32 v240, 0
    v_mov_b32 v241, 0
    v_mov_b32 v242, 0
    v_mov_b32 v243, 0
    v_mbcnt_lo_u32_b32 v244, -1, 0
    v_mbcnt_hi_u32_b32 v244, -1, v244
    v_lshlrev_b32 v244, 4, v244
    ds_write_b128 v244, v[240:243] offset:30720
    ds_write_b128 v244, v[240:243] offset:31744
    ds_write_b128 v244, v[240:243] offset:63488
    ds_write_b128 v244, v[240:243] offset:64512
    v_add_u32 v244, 161792, v244
    ds_write_b128 v244, v[240:243] offset:0
    ds_write_b128 v244, v[240:243] offset:1024
    s_waitcnt lgkmcnt(0)
    s_waitcnt vmcnt(12)
    s_barrier
    ds_read_b128 a[192:195], v222 offset:0
    ds_read_b128 a[196:199], v222 offset:2048
    ds_read_b128 a[200:203], v222 offset:4096
    ds_read_b128 a[204:207], v222 offset:6144
    ds_read_b64_tr_b16 a[160:161], v224 offset:0
    ds_read_b64_tr_b16 a[162:163], v224 offset:1024
    ds_read_b64_tr_b16 a[164:165], v225 offset:0
    ds_read_b64_tr_b16 a[166:167], v225 offset:1024
    ds_read_b64_tr_b16 a[168:169], v226 offset:0
    ds_read_b64_tr_b16 a[170:171], v226 offset:1024
    ds_read_b64_tr_b16 a[172:173], v227 offset:0
    ds_read_b64_tr_b16 a[174:175], v227 offset:1024
    ds_read_b64_tr_b16 a[176:177], v228 offset:0
    ds_read_b64_tr_b16 a[178:179], v228 offset:1024
    ds_read_b64_tr_b16 a[180:181], v229 offset:0
    ds_read_b64_tr_b16 a[182:183], v229 offset:1024
    ds_read_b64_tr_b16 a[184:185], v230 offset:0
    ds_read_b64_tr_b16 a[186:187], v230 offset:1024
    ds_read_b64_tr_b16 a[188:189], v231 offset:0
    ds_read_b64_tr_b16 a[190:191], v231 offset:1024
    s_waitcnt lgkmcnt(0)
L_k1_q:
    s_mov_b32 s34, s33
    s_mov_b32 s75, s34
    s_mov_b32 s47, 0
    s_mov_b32 s68, 0
    s_cmp_eq_u32 s28, 3
    s_cbranch_scc1 L_w3_Q
    v_mfma_f32_16x16x32_bf16 v[0:3], a[160:163], a[192:195], 0
    s_add_u32 m0, s29, 98304
    s_add_u32 s43, s43, 16384
    v_mfma_f32_16x16x32_bf16 v[16:19], a[164:167], a[192:195], 0
    s_and_b32 s43, s43, 0xffff
    v_mfma_f32_16x16x32_bf16 v[4:7], a[160:163], a[196:199], 0
    buffer_load_dwordx4 v212, s[20:23], s35 offen offset:0 lds
    v_mfma_f32_16x16x32_bf16 v[20:23], a[164:167], a[196:199], 0
    ds_read_b128 a[208:211], v223 offset:0
    v_mfma_f32_16x16x32_bf16 v[8:11], a[160:163], a[200:203], 0
    buffer_load_dwordx4 v213, s[20:23], s35 offen offset:1024 lds
    v_mfma_f32_16x16x32_bf16 v[24:27], a[164:167], a[200:203], 0
    ds_read_b128 a[212:215], v223 offset:2048
    v_mfma_f32_16x16x32_bf16 v[12:15], a[160:163], a[204:207], 0
    s_cmp_gt_u32 s3, 0
    ds_read_b64_tr_b16 a[160:161], v224 offset:8192
    v_mfma_f32_16x16x32_bf16 v[28:31], a[164:167], a[204:207], 0
    s_cselect_b32 s26, 31457280, 0
    ds_read_b64_tr_b16 a[162:163], v224 offset:9216
    v_mfma_f32_16x16x32_bf16 v[44:47], a[168:171], a[204:207], 0
    s_mov_b32 s71, 0
    ds_read_b64_tr_b16 a[164:165], v225 offset:8192
    v_add_u32 v222, s41, v220
    v_mfma_f32_16x16x32_bf16 v[60:63], a[172:175], a[204:207], 0
    ds_read_b64_tr_b16 a[166:167], v225 offset:9216
    v_add_u32 v224, s43, v200
    v_mfma_f32_16x16x32_bf16 v[40:43], a[168:171], a[200:203], 0
    buffer_load_dwordx4 v214, s[20:23], s35 offen offset:2048 lds
    v_mfma_f32_16x16x32_bf16 v[56:59], a[172:175], a[200:203], 0
    ds_read_b128 a[216:219], v223 offset:4096
    v_mfma_f32_16x16x32_bf16 v[36:39], a[168:171], a[196:199], 0
    buffer_load_dwordx4 v215, s[20:23], s35 offen offset:3072 lds
    v_mfma_f32_16x16x32_bf16 v[52:55], a[172:175], a[196:199], 0
    s_add_u32 m0, s30, 32768
    ds_read_b128 a[220:223], v223 offset:6144
    v_mfma_f32_16x16x32_bf16 v[32:35], a[168:171], a[192:195], 0
    ds_read_b64_tr_b16 a[168:169], v226 offset:8192
    v_add_u32 v225, s43, v201
    v_mfma_f32_16x16x32_bf16 v[48:51], a[172:175], a[192:195], 0
    ds_read_b64_tr_b16 a[170:171], v226 offset:9216
    s_waitcnt lgkmcnt(10)
    v_mfma_f32_16x16x32_bf16 v[64:67], a[176:179], a[192:195], 0
    ds_read_b64_tr_b16 a[172:173], v227 offset:8192
    v_add_u32 v226, s43, v202
    v_mfma_f32_16x16x32_bf16 v[80:83], a[180:183], a[192:195], 0
    ds_read_b64_tr_b16 a[174:175], v227 offset:9216
    v_add_u32 v223, s41, v221
    v_mfma_f32_16x16x32_bf16 v[68:71], a[176:179], a[196:199], 0
    buffer_load_dwordx4 v216, s[16:19], s36 offen offset:0 lds
    v_mfma_f32_16x16x32_bf16 v[84:87], a[180:183], a[196:199], 0
    buffer_load_dwordx4 v217, s[16:19], s36 offen offset:1024 lds
    v_mfma_f32_16x16x32_bf16 v[72:75], a[176:179], a[200:203], 0
    buffer_load_dwordx4 v218, s[16:19], s36 offen offset:2048 lds
    v_mfma_f32_16x16x32_bf16 v[88:91], a[180:183], a[200:203], 0
    buffer_load_dwordx4 v219, s[16:19], s36 offen offset:3072 lds
    v_mfma_f32_16x16x32_bf16 v[76:79], a[176:179], a[204:207], 0
    s_mov_b32 s70, s40
    ds_read_b64_tr_b16 a[176:177], v228 offset:8192
    v_add_u32 v227, s43, v203
    v_mfma_f32_16x16x32_bf16 v[92:95], a[180:183], a[204:207], 0
    s_add_u32 m0, m0, s67
    s_mov_b32 s40, s41
    ds_read_b64_tr_b16 a[178:179], v228 offset:9216
    v_mfma_f32_16x16x32_bf16 v[108:111], a[184:187], a[204:207], 0
    s_mov_b32 s41, s42
    ds_read_b64_tr_b16 a[180:181], v229 offset:8192
    v_add_u32 v228, s43, v204
    v_mfma_f32_16x16x32_bf16 v[124:127], a[188:191], a[204:207], 0
    s_mov_b32 s42, s70
    ds_read_b64_tr_b16 a[182:183], v229 offset:9216
    buffer_store_dwordx4 v[128:131], v236, s[24:27], s71 offen offset:0 sc1
    v_mfma_f32_16x16x32_bf16 v[104:107], a[184:187], a[200:203], 0
    buffer_load_dwordx4 v216, s[16:19], s37 offen offset:0 lds
    v_mfma_f32_16x16x32_bf16 v[120:123], a[188:191], a[200:203], 0
    buffer_load_dwordx4 v217, s[16:19], s37 offen offset:1024 lds
    v_mfma_f32_16x16x32_bf16 v[100:103], a[184:187], a[196:199], 0
    buffer_load_dwordx4 v218, s[16:19], s37 offen offset:2048 lds
    v_mfma_f32_16x16x32_bf16 v[116:119], a[188:191], a[196:199], 0
    buffer_load_dwordx4 v219, s[16:19], s37 offen offset:3072 lds
    v_mfma_f32_16x16x32_bf16 v[96:99], a[184:187], a[192:195], 0
    ds_read_b64_tr_b16 a[184:185], v230 offset:8192
    v_add_u32 v229, s43, v205
    v_mfma_f32_16x16x32_bf16 v[112:115], a[188:191], a[192:195], 0
    ds_read_b64_tr_b16 a[186:187], v230 offset:9216
    s_waitcnt lgkmcnt(6)
    v_mfma_f32_16x16x32_bf16 v[0:3], a[160:163], a[208:211], v[0:3]
    ds_read_b64_tr_b16 a[188:189], v231 offset:8192
    s_add_u32 s36, s36, 128
    s_bitset0_b32 s36, 11
    s_add_u32 s37, s37, 128
    s_bitset0_b32 s37, 11
    s_add_u32 s35, s35, 524288
    s_bitset0_b32 s35, 23
    v_mfma_f32_16x16x32_bf16 v[16:19], a[164:167], a[208:211], v[16:19]
    s_waitcnt vmcnt(13)
    ds_read_b64_tr_b16 a[190:191], v231 offset:9216
    s_mov_b32 m0, s39
    s_barrier
    s_mov_b32 s44, 13
L_k1_qloop:
    v_mfma_f32_16x16x32_bf16 v[4:7], a[160:163], a[212:215], v[4:7]
    buffer_load_dwordx4 v212, s[20:23], s35 offen offset:0 lds
    v_mfma_f32_16x16x32_bf16 v[20:23], a[164:167], a[212:215], v[20:23]
    ds_read_b128 a[192:195], v222 offset:0
    v_mfma_f32_16x16x32_bf16 v[8:11], a[160:163], a[216:219], v[8:11]
    buffer_load_dwordx4 v213, s[20:23], s35 offen offset:1024 lds
    v_mfma_f32_16x16x32_bf16 v[24:27], a[164:167], a[216:219], v[24:27]
    ds_read_b128 a[196:199], v222 offset:2048
    v_mfma_f32_16x16x32_bf16 v[12:15], a[160:163], a[220:223], v[12:15]
    ds_read_b64_tr_b16 a[160:161], v224 offset:0
    v_add_u32 v230, s43, v206
    v_mfma_f32_16x16x32_bf16 v[28:31], a[164:167], a[220:223], v[28:31]
    ds_read_b64_tr_b16 a[162:163], v224 offset:1024
    v_add_u32 v231, s43, v207
    v_mfma_f32_16x16x32_bf16 v[44:47], a[168:171], a[220:223], v[44:47]
    ds_read_b64_tr_b16 a[164:165], v225 offset:0
    v_mfma_f32_16x16x32_bf16 v[60:63], a[172:175], a[220:223], v[60:63]
    ds_read_b64_tr_b16 a[166:167], v225 offset:1024
    v_mfma_f32_16x16x32_bf16 v[40:43], a[168:171], a[216:219], v[40:43]
    buffer_load_dwordx4 v214, s[20:23], s35 offen offset:2048 lds
    v_mfma_f32_16x16x32_bf16 v[56:59], a[172:175], a[216:219], v[56:59]
    ds_read_b128 a[200:203], v222 offset:4096
    v_mfma_f32_16x16x32_bf16 v[36:39], a[168:171], a[212:215], v[36:39]
    buffer_load_dwordx4 v215, s[20:23], s35 offen offset:3072 lds
    v_mfma_f32_16x16x32_bf16 v[52:55], a[172:175], a[212:215], v[52:55]
    s_add_u32 m0, s42, s30
    ds_read_b128 a[204:207], v222 offset:6144
    v_mfma_f32_16x16x32_bf16 v[32:35], a[168:171], a[208:211], v[32:35]
    s_add_u32 s35, s35, 524288
    ds_read_b64_tr_b16 a[168:169], v226 offset:0
    v_add_u32 v222, s41, v220
    v_mfma_f32_16x16x32_bf16 v[48:51], a[172:175], a[208:211], v[48:51]
    s_bitset0_b32 s35, 23
    ds_read_b64_tr_b16 a[170:171], v226 offset:1024
    s_waitcnt lgkmcnt(10)
    v_mfma_f32_16x16x32_bf16 v[64:67], a[176:179], a[208:211], v[64:67]
    s_add_u32 s39, s39, 16384
    ds_read_b64_tr_b16 a[172:173], v227 offset:0
    v_mfma_f32_16x16x32_bf16 v[80:83], a[180:183], a[208:211], v[80:83]
    s_and_b32 s39, s39, 0xffff
    ds_read_b64_tr_b16 a[174:175], v227 offset:1024
    v_mfma_f32_16x16x32_bf16 v[68:71], a[176:179], a[212:215], v[68:71]
    buffer_load_dwordx4 v216, s[16:19], s36 offen offset:0 lds
    v_mfma_f32_16x16x32_bf16 v[84:87], a[180:183], a[212:215], v[84:87]
    s_add_u32 s68, s68, 122880
    s_sub_u32 s71, s68, 491264
    s_cselect_b32 s68, s68, s71
    v_mfma_f32_16x16x32_bf16 v[72:75], a[176:179], a[216:219], v[72:75]
    buffer_load_dwordx4 v217, s[16:19], s36 offen offset:1024 lds
    v_mfma_f32_16x16x32_bf16 v[88:91], a[180:183], a[216:219], v[88:91]
    s_add_u32 s47, s47, 4
    s_cmp_lt_u32 s47, s3
    s_cselect_b32 s26, 31457280, 0
    v_mfma_f32_16x16x32_bf16 v[76:79], a[176:179], a[220:223], v[76:79]
    s_or_b32 s39, s39, 0x10000
    ds_read_b64_tr_b16 a[176:177], v228 offset:0
    v_mfma_f32_16x16x32_bf16 v[92:95], a[180:183], a[220:223], v[92:95]
    ds_read_b64_tr_b16 a[178:179], v228 offset:1024
    v_mfma_f32_16x16x32_bf16 v[108:111], a[184:187], a[220:223], v[108:111]
    ds_read_b64_tr_b16 a[180:181], v229 offset:0
    v_mfma_f32_16x16x32_bf16 v[124:127], a[188:191], a[220:223], v[124:127]
    ds_read_b64_tr_b16 a[182:183], v229 offset:1024
    v_mfma_f32_16x16x32_bf16 v[104:107], a[184:187], a[216:219], v[104:107]
    buffer_load_dwordx4 v218, s[16:19], s36 offen offset:2048 lds
    v_mfma_f32_16x16x32_bf16 v[120:123], a[188:191], a[216:219], v[120:123]
    v_mfma_f32_16x16x32_bf16 v[100:103], a[184:187], a[212:215], v[100:103]
    buffer_load_dwordx4 v219, s[16:19], s36 offen offset:3072 lds
    v_mfma_f32_16x16x32_bf16 v[116:119], a[188:191], a[212:215], v[116:119]
    s_add_u32 m0, m0, s67
    v_mfma_f32_16x16x32_bf16 v[96:99], a[184:187], a[208:211], v[96:99]
    ds_read_b64_tr_b16 a[184:185], v230 offset:0
    v_mfma_f32_16x16x32_bf16 v[112:115], a[188:191], a[208:211], v[112:115]
    ds_read_b64_tr_b16 a[186:187], v230 offset:1024
    s_waitcnt lgkmcnt(6)
    v_mfma_f32_16x16x32_bf16 v[0:3], a[160:163], a[192:195], v[0:3]
    s_add_u32 s43, s43, 16384
    ds_read_b64_tr_b16 a[188:189], v231 offset:0
    v_mfma_f32_16x16x32_bf16 v[16:19], a[164:167], a[192:195], v[16:19]
    s_and_b32 s43, s43, 0xffff
    ds_read_b64_tr_b16 a[190:191], v231 offset:1024
    v_mfma_f32_16x16x32_bf16 v[4:7], a[160:163], a[196:199], v[4:7]
    buffer_load_dwordx4 v216, s[16:19], s37 offen offset:0 lds
    v_mfma_f32_16x16x32_bf16 v[20:23], a[164:167], a[196:199], v[20:23]
    ds_read_b128 a[208:211], v223 offset:0
    v_mfma_f32_16x16x32_bf16 v[8:11], a[160:163], a[200:203], v[8:11]
    buffer_load_dwordx4 v217, s[16:19], s37 offen offset:1024 lds
    v_mfma_f32_16x16x32_bf16 v[24:27], a[164:167], a[200:203], v[24:27]
    ds_read_b128 a[212:215], v223 offset:2048
    v_mfma_f32_16x16x32_bf16 v[12:15], a[160:163], a[204:207], v[12:15]
    s_add_u32 s36, s36, 128
    ds_read_b64_tr_b16 a[160:161], v224 offset:8192
    v_mfma_f32_16x16x32_bf16 v[28:31], a[164:167], a[204:207], v[28:31]
    s_bitset0_b32 s36, 11
    ds_read_b64_tr_b16 a[162:163], v224 offset:9216
    v_mfma_f32_16x16x32_bf16 v[44:47], a[168:171], a[204:207], v[44:47]
    ds_read_b64_tr_b16 a[164:165], v225 offset:8192
    v_mfma_f32_16x16x32_bf16 v[60:63], a[172:175], a[204:207], v[60:63]
    ds_read_b64_tr_b16 a[166:167], v225 offset:9216
    v_add_u32 v224, s43, v200
    v_mfma_f32_16x16x32_bf16 v[40:43], a[168:171], a[200:203], v[40:43]
    buffer_load_dwordx4 v218, s[16:19], s37 offen offset:2048 lds
    v_mfma_f32_16x16x32_bf16 v[56:59], a[172:175], a[200:203], v[56:59]
    ds_read_b128 a[216:219], v223 offset:4096
    v_mfma_f32_16x16x32_bf16 v[36:39], a[168:171], a[196:199], v[36:39]
    buffer_load_dwordx4 v219, s[16:19], s37 offen offset:3072 lds
    v_mfma_f32_16x16x32_bf16 v[52:55], a[172:175], a[196:199], v[52:55]
    ds_read_b128 a[220:223], v223 offset:6144
    v_mfma_f32_16x16x32_bf16 v[32:35], a[168:171], a[192:195], v[32:35]
    ds_read_b64_tr_b16 a[168:169], v226 offset:8192
    v_add_u32 v225, s43, v201
    v_mfma_f32_16x16x32_bf16 v[48:51], a[172:175], a[192:195], v[48:51]
    ds_read_b64_tr_b16 a[170:171], v226 offset:9216
    s_waitcnt lgkmcnt(10)
    v_mfma_f32_16x16x32_bf16 v[64:67], a[176:179], a[192:195], v[64:67]
    s_add_u32 s37, s37, 128
    ds_read_b64_tr_b16 a[172:173], v227 offset:8192
    v_add_u32 v226, s43, v202
    v_mfma_f32_16x16x32_bf16 v[80:83], a[180:183], a[192:195], v[80:83]
    s_bitset0_b32 s37, 11
    ds_read_b64_tr_b16 a[174:175], v227 offset:9216
    v_add_u32 v223, s41, v221
    v_mfma_f32_16x16x32_bf16 v[68:71], a[176:179], a[196:199], v[68:71]
    s_set_gpr_idx_on s47, 1
    v_mov_b32 v240, v128
    s_set_gpr_idx_off
    v_mfma_f32_16x16x32_bf16 v[84:87], a[180:183], a[196:199], v[84:87]
    s_set_gpr_idx_on s47, 1
    v_mov_b32 v241, v129
    s_set_gpr_idx_off
    v_mfma_f32_16x16x32_bf16 v[72:75], a[176:179], a[200:203], v[72:75]
    s_set_gpr_idx_on s47, 1
    v_mov_b32 v242, v130
    s_set_gpr_idx_off
    v_mfma_f32_16x16x32_bf16 v[88:91], a[180:183], a[200:203], v[88:91]
    s_set_gpr_idx_on s47, 1
    v_mov_b32 v243, v131
    s_set_gpr_idx_off
    v_mfma_f32_16x16x32_bf16 v[76:79], a[176:179], a[204:207], v[76:79]
    s_mov_b32 s70, s40
    ds_read_b64_tr_b16 a[176:177], v228 offset:8192
    v_add_u32 v227, s43, v203
    v_mfma_f32_16x16x32_bf16 v[92:95], a[180:183], a[204:207], v[92:95]
    s_mov_b32 s40, s41
    ds_read_b64_tr_b16 a[178:179], v228 offset:9216
    v_mfma_f32_16x16x32_bf16 v[108:111], a[184:187], a[204:207], v[108:111]
    s_mov_b32 s41, s42
    ds_read_b64_tr_b16 a[180:181], v229 offset:8192
    v_add_u32 v228, s43, v204
    v_mfma_f32_16x16x32_bf16 v[124:127], a[188:191], a[204:207], v[124:127]
    s_mov_b32 s42, s70
    ds_read_b64_tr_b16 a[182:183], v229 offset:9216
    v_mfma_f32_16x16x32_bf16 v[104:107], a[184:187], a[200:203], v[104:107]
    s_sub_u32 s44, s44, 1
    v_mfma_f32_16x16x32_bf16 v[120:123], a[188:191], a[200:203], v[120:123]
    buffer_store_dwordx4 v[240:243], v236, s[24:27], s68 offen sc1
    v_mfma_f32_16x16x32_bf16 v[100:103], a[184:187], a[196:199], v[100:103]
    v_mfma_f32_16x16x32_bf16 v[116:119], a[188:191], a[196:199], v[116:119]
    s_cmp_lg_u32 s44, 0
    v_mfma_f32_16x16x32_bf16 v[96:99], a[184:187], a[192:195], v[96:99]
    ds_read_b64_tr_b16 a[184:185], v230 offset:8192
    v_add_u32 v229, s43, v205
    v_mfma_f32_16x16x32_bf16 v[112:115], a[188:191], a[192:195], v[112:115]
    ds_read_b64_tr_b16 a[186:187], v230 offset:9216
    s_waitcnt lgkmcnt(6)
    v_mfma_f32_16x16x32_bf16 v[0:3], a[160:163], a[208:211], v[0:3]
    s_mov_b32 m0, s39
    ds_read_b64_tr_b16 a[188:189], v231 offset:8192
    v_mfma_f32_16x16x32_bf16 v[16:19], a[164:167], a[208:211], v[16:19]
    s_waitcnt vmcnt(14)
    ds_read_b64_tr_b16 a[190:191], v231 offset:9216
    s_barrier
    s_cbranch_scc1 L_k1_qloop
    v_mfma_f32_16x16x32_bf16 v[4:7], a[160:163], a[212:215], v[4:7]
    s_mov_b32 m0, s29
    v_mfma_f32_16x16x32_bf16 v[20:23], a[164:167], a[212:215], v[20:23]
    ds_read_b128 a[192:195], v222 offset:0
    v_mfma_f32_16x16x32_bf16 v[8:11], a[160:163], a[216:219], v[8:11]
    buffer_load_dwordx4 v208, s[8:11], s34 offen offset:0 nt lds
    v_mfma_f32_16x16x32_bf16 v[24:27], a[164:167], a[216:219], v[24:27]
    ds_read_b128 a[196:199], v222 offset:2048
    v_mfma_f32_16x16x32_bf16 v[12:15], a[160:163], a[220:223], v[12:15]
    ds_read_b64_tr_b16 a[160:161], v224 offset:0
    v_add_u32 v230, s43, v206
    v_mfma_f32_16x16x32_bf16 v[28:31], a[164:167], a[220:223], v[28:31]
    ds_read_b64_tr_b16 a[162:163], v224 offset:1024
    v_add_u32 v231, s43, v207
    v_mfma_f32_16x16x32_bf16 v[44:47], a[168:171], a[220:223], v[44:47]
    ds_read_b64_tr_b16 a[164:165], v225 offset:0
    v_mfma_f32_16x16x32_bf16 v[60:63], a[172:175], a[220:223], v[60:63]
    ds_read_b64_tr_b16 a[166:167], v225 offset:1024
    v_mfma_f32_16x16x32_bf16 v[40:43], a[168:171], a[216:219], v[40:43]
    v_mfma_f32_16x16x32_bf16 v[56:59], a[172:175], a[216:219], v[56:59]
    ds_read_b128 a[200:203], v222 offset:4096
    v_mfma_f32_16x16x32_bf16 v[36:39], a[168:171], a[212:215], v[36:39]
    buffer_load_dwordx4 v208, s[8:11], s34 offen offset:1024 nt lds
    v_mfma_f32_16x16x32_bf16 v[52:55], a[172:175], a[212:215], v[52:55]
    ds_read_b128 a[204:207], v222 offset:6144
    v_mfma_f32_16x16x32_bf16 v[32:35], a[168:171], a[208:211], v[32:35]
    ds_read_b64_tr_b16 a[168:169], v226 offset:0
    v_add_u32 v222, s41, v220
    v_mfma_f32_16x16x32_bf16 v[48:51], a[172:175], a[208:211], v[48:51]
    ds_read_b64_tr_b16 a[170:171], v226 offset:1024
    s_waitcnt lgkmcnt(10)
    v_mfma_f32_16x16x32_bf16 v[64:67], a[176:179], a[208:211], v[64:67]
    ds_read_b64_tr_b16 a[172:173], v227 offset:0
    v_mfma_f32_16x16x32_bf16 v[80:83], a[180:183], a[208:211], v[80:83]
    ds_read_b64_tr_b16 a[174:175], v227 offset:1024
    v_mfma_f32_16x16x32_bf16 v[68:71], a[176:179], a[212:215], v[68:71]
    v_mfma_f32_16x16x32_bf16 v[84:87], a[180:183], a[212:215], v[84:87]
    v_mfma_f32_16x16x32_bf16 v[72:75], a[176:179], a[216:219], v[72:75]
    buffer_load_dwordx4 v209, s[8:11], s34 offen offset:2048 nt lds
    v_mfma_f32_16x16x32_bf16 v[88:91], a[180:183], a[216:219], v[88:91]
    v_mfma_f32_16x16x32_bf16 v[76:79], a[176:179], a[220:223], v[76:79]
    ds_read_b64_tr_b16 a[176:177], v228 offset:0
    v_mfma_f32_16x16x32_bf16 v[92:95], a[180:183], a[220:223], v[92:95]
    ds_read_b64_tr_b16 a[178:179], v228 offset:1024
    v_mfma_f32_16x16x32_bf16 v[108:111], a[184:187], a[220:223], v[108:111]
    ds_read_b64_tr_b16 a[180:181], v229 offset:0
    v_mfma_f32_16x16x32_bf16 v[124:127], a[188:191], a[220:223], v[124:127]
    ds_read_b64_tr_b16 a[182:183], v229 offset:1024
    v_mfma_f32_16x16x32_bf16 v[104:107], a[184:187], a[216:219], v[104:107]
    v_mfma_f32_16x16x32_bf16 v[120:123], a[188:191], a[216:219], v[120:123]
    v_mfma_f32_16x16x32_bf16 v[100:103], a[184:187], a[212:215], v[100:103]
    buffer_load_dwordx4 v209, s[8:11], s34 offen offset:3072 nt lds
    v_mfma_f32_16x16x32_bf16 v[116:119], a[188:191], a[212:215], v[116:119]
    v_mfma_f32_16x16x32_bf16 v[96:99], a[184:187], a[208:211], v[96:99]
    ds_read_b64_tr_b16 a[184:185], v230 offset:0
    v_mfma_f32_16x16x32_bf16 v[112:115], a[188:191], a[208:211], v[112:115]
    ds_read_b64_tr_b16 a[186:187], v230 offset:1024
    s_waitcnt lgkmcnt(6)
    v_mfma_f32_16x16x32_bf16 v[0:3], a[160:163], a[192:195], v[0:3]
    s_add_u32 s43, s43, 16384
    ds_read_b64_tr_b16 a[188:189], v231 offset:0
    v_mfma_f32_16x16x32_bf16 v[16:19], a[164:167], a[192:195], v[16:19]
    s_and_b32 s43, s43, 0xffff
    ds_read_b64_tr_b16 a[190:191], v231 offset:1024
    v_mfma_f32_16x16x32_bf16 v[4:7], a[160:163], a[196:199], v[4:7]
    v_mfma_f32_16x16x32_bf16 v[20:23], a[164:167], a[196:199], v[20:23]
    ds_read_b128 a[208:211], v223 offset:0
    v_mfma_f32_16x16x32_bf16 v[8:11], a[160:163], a[200:203], v[8:11]
    v_mfma_f32_16x16x32_bf16 v[24:27], a[164:167], a[200:203], v[24:27]
    ds_read_b128 a[212:215], v223 offset:2048
    v_mfma_f32_16x16x32_bf16 v[12:15], a[160:163], a[204:207], v[12:15]
    s_add_u32 s34, s34, 16384
    ds_read_b64_tr_b16 a[160:161], v224 offset:8192
    v_mfma_f32_16x16x32_bf16 v[28:31], a[164:167], a[204:207], v[28:31]
    ds_read_b64_tr_b16 a[162:163], v224 offset:9216
    v_mfma_f32_16x16x32_bf16 v[44:47], a[168:171], a[204:207], v[44:47]
    ds_read_b64_tr_b16 a[164:165], v225 offset:8192
    v_mfma_f32_16x16x32_bf16 v[60:63], a[172:175], a[204:207], v[60:63]
    ds_read_b64_tr_b16 a[166:167], v225 offset:9216
    v_add_u32 v224, s43, v200
    v_mfma_f32_16x16x32_bf16 v[40:43], a[168:171], a[200:203], v[40:43]
    v_mfma_f32_16x16x32_bf16 v[56:59], a[172:175], a[200:203], v[56:59]
    ds_read_b128 a[216:219], v223 offset:4096
    v_mfma_f32_16x16x32_bf16 v[36:39], a[168:171], a[196:199], v[36:39]
    v_mfma_f32_16x16x32_bf16 v[52:55], a[172:175], a[196:199], v[52:55]
    ds_read_b128 a[220:223], v223 offset:6144
    v_mfma_f32_16x16x32_bf16 v[32:35], a[168:171], a[192:195], v[32:35]
    ds_read_b64_tr_b16 a[168:169], v226 offset:8192
    v_add_u32 v225, s43, v201
    v_mfma_f32_16x16x32_bf16 v[48:51], a[172:175], a[192:195], v[48:51]
    ds_read_b64_tr_b16 a[170:171], v226 offset:9216
    s_waitcnt lgkmcnt(10)
    v_mfma_f32_16x16x32_bf16 v[64:67], a[176:179], a[192:195], v[64:67]
    ds_read_b64_tr_b16 a[172:173], v227 offset:8192
    v_add_u32 v226, s43, v202
    v_mfma_f32_16x16x32_bf16 v[80:83], a[180:183], a[192:195], v[80:83]
    ds_read_b64_tr_b16 a[174:175], v227 offset:9216
    v_add_u32 v223, s41, v221
    v_mfma_f32_16x16x32_bf16 v[68:71], a[176:179], a[196:199], v[68:71]
    s_cmp_gt_u32 s3, 56
    s_cselect_b32 s26, 31457280, 0
    s_mov_b32 s71, 245760
    v_mfma_f32_16x16x32_bf16 v[84:87], a[180:183], a[196:199], v[84:87]
    v_mfma_f32_16x16x32_bf16 v[72:75], a[176:179], a[200:203], v[72:75]
    buffer_store_dwordx4 v[184:187], v236, s[24:27], s71 offen offset:768 sc1
    v_mfma_f32_16x16x32_bf16 v[88:91], a[180:183], a[200:203], v[88:91]
    v_mfma_f32_16x16x32_bf16 v[76:79], a[176:179], a[204:207], v[76:79]
    s_mov_b32 s70, s40
    ds_read_b64_tr_b16 a[176:177], v228 offset:8192
    v_add_u32 v227, s43, v203
    v_mfma_f32_16x16x32_bf16 v[92:95], a[180:183], a[204:207], v[92:95]
    s_mov_b32 s40, s41
    ds_read_b64_tr_b16 a[178:179], v228 offset:9216
    v_mfma_f32_16x16x32_bf16 v[108:111], a[184:187], a[204:207], v[108:111]
    s_mov_b32 s41, s42
    ds_read_b64_tr_b16 a[180:181], v229 offset:8192
    v_add_u32 v228, s43, v204
    v_mfma_f32_16x16x32_bf16 v[124:127], a[188:191], a[204:207], v[124:127]
    s_mov_b32 s42, s70
    ds_read_b64_tr_b16 a[182:183], v229 offset:9216
    v_mfma_f32_16x16x32_bf16 v[104:107], a[184:187], a[200:203], v[104:107]
    v_mfma_f32_16x16x32_bf16 v[120:123], a[188:191], a[200:203], v[120:123]
    v_mfma_f32_16x16x32_bf16 v[100:103], a[184:187], a[196:199], v[100:103]
    v_mfma_f32_16x16x32_bf16 v[116:119], a[188:191], a[196:199], v[116:119]
    v_mfma_f32_16x16x32_bf16 v[96:99], a[184:187], a[192:195], v[96:99]
    ds_read_b64_tr_b16 a[184:185], v230 offset:8192
    v_add_u32 v229, s43, v205
    v_mfma_f32_16x16x32_bf16 v[112:115], a[188:191], a[192:195], v[112:115]
    ds_read_b64_tr_b16 a[186:187], v230 offset:9216
    s_waitcnt lgkmcnt(6)
    v_mfma_f32_16x16x32_bf16 v[0:3], a[160:163], a[208:211], v[0:3]
    ds_read_b64_tr_b16 a[188:189], v231 offset:8192
    v_mfma_f32_16x16x32_bf16 v[16:19], a[164:167], a[208:211], v[16:19]
    s_waitcnt vmcnt(6)
    ds_read_b64_tr_b16 a[190:191], v231 offset:9216
    s_barrier
    v_mfma_f32_16x16x32_bf16 v[4:7], a[160:163], a[212:215], v[4:7]
    s_add_u32 m0, s29, 16384
    v_mfma_f32_16x16x32_bf16 v[20:23], a[164:167], a[212:215], v[20:23]
    ds_read_b128 a[192:195], v222 offset:0
    v_mfma_f32_16x16x32_bf16 v[8:11], a[160:163], a[216:219], v[8:11]
    buffer_load_dwordx4 v208, s[8:11], s34 offen offset:0 nt lds
    v_mfma_f32_16x16x32_bf16 v[24:27], a[164:167], a[216:219], v[24:27]
    ds_read_b128 a[196:199], v222 offset:2048
    v_mfma_f32_16x16x32_bf16 v[12:15], a[160:163], a[220:223], v[12:15]
    ds_read_b64_tr_b16 a[160:161], v224 offset:0
    v_add_u32 v230, s43, v206
    v_mfma_f32_16x16x32_bf16 v[28:31], a[164:167], a[220:223], v[28:31]
    ds_read_b64_tr_b16 a[162:163], v224 offset:1024
    v_add_u32 v231, s43, v207
    v_mfma_f32_16x16x32_bf16 v[44:47], a[168:171], a[220:223], v[44:47]
    ds_read_b64_tr_b16 a[164:165], v225 offset:0
    v_mfma_f32_16x16x32_bf16 v[60:63], a[172:175], a[220:223], v[60:63]
    ds_read_b64_tr_b16 a[166:167], v225 offset:1024
    v_mfma_f32_16x16x32_bf16 v[40:43], a[168:171], a[216:219], v[40:43]
    v_mfma_f32_16x16x32_bf16 v[56:59], a[172:175], a[216:219], v[56:59]
    ds_read_b128 a[200:203], v222 offset:4096
    v_mfma_f32_16x16x32_bf16 v[36:39], a[168:171], a[212:215], v[36:39]
    buffer_load_dwordx4 v208, s[8:11], s34 offen offset:1024 nt lds
    v_mfma_f32_16x16x32_bf16 v[52:55], a[172:175], a[212:215], v[52:55]
    ds_read_b128 a[204:207], v222 offset:6144
    v_mfma_f32_16x16x32_bf16 v[32:35], a[168:171], a[208:211], v[32:35]
    ds_read_b64_tr_b16 a[168:169], v226 offset:0
    v_add_u32 v222, s41, v220
    v_mfma_f32_16x16x32_bf16 v[48:51], a[172:175], a[208:211], v[48:51]
    ds_read_b64_tr_b16 a[170:171], v226 offset:1024
    s_waitcnt lgkmcnt(10)
    v_mfma_f32_16x16x32_bf16 v[64:67], a[176:179], a[208:211], v[64:67]
    ds_read_b64_tr_b16 a[172:173], v227 offset:0
    v_mfma_f32_16x16x32_bf16 v[80:83], a[180:183], a[208:211], v[80:83]
    ds_read_b64_tr_b16 a[174:175], v227 offset:1024
    v_mfma_f32_16x16x32_bf16 v[68:71], a[176:179], a[212:215], v[68:71]
    v_mfma_f32_16x16x32_bf16 v[84:87], a[180:183], a[212:215], v[84:87]
    v_mfma_f32_16x16x32_bf16 v[72:75], a[176:179], a[216:219], v[72:75]
    buffer_load_dwordx4 v209, s[8:11], s34 offen offset:2048 nt lds
    v_mfma_f32_16x16x32_bf16 v[88:91], a[180:183], a[216:219], v[88:91]
    v_mfma_f32_16x16x32_bf16 v[76:79], a[176:179], a[220:223], v[76:79]
    ds_read_b64_tr_b16 a[176:177], v228 offset:0
    v_mfma_f32_16x16x32_bf16 v[92:95], a[180:183], a[220:223], v[92:95]
    ds_read_b64_tr_b16 a[178:179], v228 offset:1024
    v_mfma_f32_16x16x32_bf16 v[108:111], a[184:187], a[220:223], v[108:111]
    ds_read_b64_tr_b16 a[180:181], v229 offset:0
    v_mfma_f32_16x16x32_bf16 v[124:127], a[188:191], a[220:223], v[124:127]
    ds_read_b64_tr_b16 a[182:183], v229 offset:1024
    v_mfma_f32_16x16x32_bf16 v[104:107], a[184:187], a[216:219], v[104:107]
    v_mfma_f32_16x16x32_bf16 v[120:123], a[188:191], a[216:219], v[120:123]
    v_mfma_f32_16x16x32_bf16 v[100:103], a[184:187], a[212:215], v[100:103]
    buffer_load_dwordx4 v209, s[8:11], s34 offen offset:3072 nt lds
    v_mfma_f32_16x16x32_bf16 v[116:119], a[188:191], a[212:215], v[116:119]
    v_mfma_f32_16x16x32_bf16 v[96:99], a[184:187], a[208:211], v[96:99]
    ds_read_b64_tr_b16 a[184:185], v230 offset:0
    v_mfma_f32_16x16x32_bf16 v[112:115], a[188:191], a[208:211], v[112:115]
    ds_read_b64_tr_b16 a[186:187], v230 offset:1024
    s_waitcnt lgkmcnt(6)
    v_mfma_f32_16x16x32_bf16 v[0:3], a[160:163], a[192:195], v[0:3]
    s_add_u32 s43, s43, 16384
    ds_read_b64_tr_b16 a[188:189], v231 offset:0
    v_mfma_f32_16x16x32_bf16 v[16:19], a[164:167], a[192:195], v[16:19]
    s_and_b32 s43, s43, 0xffff
    ds_read_b64_tr_b16 a[190:191], v231 offset:1024
    v_mfma_f32_16x16x32_bf16 v[4:7], a[160:163], a[196:199], v[4:7]
    v_mfma_f32_16x16x32_bf16 v[20:23], a[164:167], a[196:199], v[20:23]
    ds_read_b128 a[208:211], v223 offset:0
    v_mfma_f32_16x16x32_bf16 v[8:11], a[160:163], a[200:203], v[8:11]
    v_mfma_f32_16x16x32_bf16 v[24:27], a[164:167], a[200:203], v[24:27]
    ds_read_b128 a[212:215], v223 offset:2048
    v_mfma_f32_16x16x32_bf16 v[12:15], a[160:163], a[204:207], v[12:15]
    s_add_u32 s34, s34, 16384
    ds_read_b64_tr_b16 a[160:161], v224 offset:8192
    v_mfma_f32_16x16x32_bf16 v[28:31], a[164:167], a[204:207], v[28:31]
    ds_read_b64_tr_b16 a[162:163], v224 offset:9216
    v_mfma_f32_16x16x32_bf16 v[44:47], a[168:171], a[204:207], v[44:47]
    ds_read_b64_tr_b16 a[164:165], v225 offset:8192
    v_mfma_f32_16x16x32_bf16 v[60:63], a[172:175], a[204:207], v[60:63]
    ds_read_b64_tr_b16 a[166:167], v225 offset:9216
    v_add_u32 v224, s43, v200
    v_mfma_f32_16x16x32_bf16 v[40:43], a[168:171], a[200:203], v[40:43]
    v_mfma_f32_16x16x32_bf16 v[56:59], a[172:175], a[200:203], v[56:59]
    ds_read_b128 a[216:219], v223 offset:4096
    v_mfma_f32_16x16x32_bf16 v[36:39], a[168:171], a[196:199], v[36:39]
    v_mfma_f32_16x16x32_bf16 v[52:55], a[172:175], a[196:199], v[52:55]
    ds_read_b128 a[220:223], v223 offset:6144
    v_mfma_f32_16x16x32_bf16 v[32:35], a[168:171], a[192:195], v[32:35]
    ds_read_b64_tr_b16 a[168:169], v226 offset:8192
    v_add_u32 v225, s43, v201
    v_mfma_f32_16x16x32_bf16 v[48:51], a[172:175], a[192:195], v[48:51]
    ds_read_b64_tr_b16 a[170:171], v226 offset:9216
    s_waitcnt lgkmcnt(10)
    v_mfma_f32_16x16x32_bf16 v[64:67], a[176:179], a[192:195], v[64:67]
    ds_read_b64_tr_b16 a[172:173], v227 offset:8192
    v_add_u32 v226, s43, v202
    v_mfma_f32_16x16x32_bf16 v[80:83], a[180:183], a[192:195], v[80:83]
    ds_read_b64_tr_b16 a[174:175], v227 offset:9216
    v_add_u32 v223, s41, v221
    v_mfma_f32_16x16x32_bf16 v[68:71], a[176:179], a[196:199], v[68:71]
    s_cmp_gt_u32 s3, 60
    s_cselect_b32 s26, 31457280, 0
    s_mov_b32 s71, 368640
    v_mfma_f32_16x16x32_bf16 v[84:87], a[180:183], a[196:199], v[84:87]
    v_mfma_f32_16x16x32_bf16 v[72:75], a[176:179], a[200:203], v[72:75]
    buffer_store_dwordx4 v[188:191], v236, s[24:27], s71 offen offset:768 sc1
    v_mfma_f32_16x16x32_bf16 v[88:91], a[180:183], a[200:203], v[88:91]
    v_mfma_f32_16x16x32_bf16 v[76:79], a[176:179], a[204:207], v[76:79]
    s_mov_b32 s70, s40
    ds_read_b64_tr_b16 a[176:177], v228 offset:8192
    v_add_u32 v227, s43, v203
    v_mfma_f32_16x16x32_bf16 v[92:95], a[180:183], a[204:207], v[92:95]
    s_mov_b32 s40, s41
    ds_read_b64_tr_b16 a[178:179], v228 offset:9216
    v_mfma_f32_16x16x32_bf16 v[108:111], a[184:187], a[204:207], v[108:111]
    s_mov_b32 s41, s42
    ds_read_b64_tr_b16 a[180:181], v229 offset:8192
    v_add_u32 v228, s43, v204
    v_mfma_f32_16x16x32_bf16 v[124:127], a[188:191], a[204:207], v[124:127]
    s_mov_b32 s42, s70
    ds_read_b64_tr_b16 a[182:183], v229 offset:9216
    v_mfma_f32_16x16x32_bf16 v[104:107], a[184:187], a[200:203], v[104:107]
    v_mfma_f32_16x16x32_bf16 v[120:123], a[188:191], a[200:203], v[120:123]
    v_mfma_f32_16x16x32_bf16 v[100:103], a[184:187], a[196:199], v[100:103]
    v_mfma_f32_16x16x32_bf16 v[116:119], a[188:191], a[196:199], v[116:119]
    v_mfma_f32_16x16x32_bf16 v[96:99], a[184:187], a[192:195], v[96:99]
    ds_read_b64_tr_b16 a[184:185], v230 offset:8192
    v_add_u32 v229, s43, v205
    v_mfma_f32_16x16x32_bf16 v[112:115], a[188:191], a[192:195], v[112:115]
    ds_read_b64_tr_b16 a[186:187], v230 offset:9216
    s_waitcnt lgkmcnt(6)
    v_mfma_f32_16x16x32_bf16 v[0:3], a[160:163], a[208:211], v[0:3]
    ds_read_b64_tr_b16 a[188:189], v231 offset:8192
    v_mfma_f32_16x16x32_bf16 v[16:19], a[164:167], a[208:211], v[16:19]
    ds_read_b64_tr_b16 a[190:191], v231 offset:9216
    v_mfma_f32_16x16x32_bf16 v[4:7], a[160:163], a[212:215], v[4:7]
    s_add_u32 m0, s29, 65536
    v_mfma_f32_16x16x32_bf16 v[20:23], a[164:167], a[212:215], v[20:23]
    v_mfma_f32_16x16x32_bf16 v[8:11], a[160:163], a[216:219], v[8:11]
    buffer_load_dwordx4 v210, s[12:15], s75 offen offset:0 nt lds
    v_mfma_f32_16x16x32_bf16 v[24:27], a[164:167], a[216:219], v[24:27]
    v_mfma_f32_16x16x32_bf16 v[12:15], a[160:163], a[220:223], v[12:15]
    v_mfma_f32_16x16x32_bf16 v[28:31], a[164:167], a[220:223], v[28:31]
    v_mfma_f32_16x16x32_bf16 v[44:47], a[168:171], a[220:223], v[44:47]
    v_mfma_f32_16x16x32_bf16 v[60:63], a[172:175], a[220:223], v[60:63]
    v_mfma_f32_16x16x32_bf16 v[40:43], a[168:171], a[216:219], v[40:43]
    buffer_load_dwordx4 v210, s[12:15], s75 offen offset:1024 nt lds
    v_mfma_f32_16x16x32_bf16 v[56:59], a[172:175], a[216:219], v[56:59]
    v_mfma_f32_16x16x32_bf16 v[36:39], a[168:171], a[212:215], v[36:39]
    v_mfma_f32_16x16x32_bf16 v[52:55], a[172:175], a[212:215], v[52:55]
    v_mfma_f32_16x16x32_bf16 v[32:35], a[168:171], a[208:211], v[32:35]
    v_mfma_f32_16x16x32_bf16 v[48:51], a[172:175], a[208:211], v[48:51]
    s_waitcnt lgkmcnt(0)
    v_mfma_f32_16x16x32_bf16 v[64:67], a[176:179], a[208:211], v[64:67]
    v_mfma_f32_16x16x32_bf16 v[80:83], a[180:183], a[208:211], v[80:83]
    v_mfma_f32_16x16x32_bf16 v[68:71], a[176:179], a[212:215], v[68:71]
    buffer_load_dwordx4 v211, s[12:15], s75 offen offset:2048 nt lds
    v_mfma_f32_16x16x32_bf16 v[84:87], a[180:183], a[212:215], v[84:87]
    v_mfma_f32_16x16x32_bf16 v[72:75], a[176:179], a[216:219], v[72:75]
    v_mfma_f32_16x16x32_bf16 v[88:91], a[180:183], a[216:219], v[88:91]
    v_mfma_f32_16x16x32_bf16 v[76:79], a[176:179], a[220:223], v[76:79]
    v_mfma_f32_16x16x32_bf16 v[92:95], a[180:183], a[220:223], v[92:95]
    v_mfma_f32_16x16x32_bf16 v[108:111], a[184:187], a[220:223], v[108:111]
    buffer_load_dwordx4 v211, s[12:15], s75 offen offset:3072 nt lds
    v_mfma_f32_16x16x32_bf16 v[124:127], a[188:191], a[220:223], v[124:127]
    v_mfma_f32_16x16x32_bf16 v[104:107], a[184:187], a[216:219], v[104:107]
    s_add_u32 s75, s75, 16384
    v_mfma_f32_16x16x32_bf16 v[120:123], a[188:191], a[216:219], v[120:123]
    v_mfma_f32_16x16x32_bf16 v[100:103], a[184:187], a[212:215], v[100:103]
    v_mfma_f32_16x16x32_bf16 v[116:119], a[188:191], a[212:215], v[116:119]
    v_mfma_f32_16x16x32_bf16 v[96:99], a[184:187], a[208:211], v[96:99]
    v_mfma_f32_16x16x32_bf16 v[112:115], a[188:191], a[208:211], v[112:115]
L_w3e_Q:
    s_cmp_eq_u32 s45, 0
    s_cbranch_scc0 L_k1_nonext
    s_add_u32 s32, s38, 16
    s_mov_b32 s100, 524288
    s_mov_b32 s42, 23
    s_mul_i32 s36, s31, 491520
    s_lshl_b32 s35, s32, 8
    s_lshr_b32 s70, s32, 3
    s_lshl_b32 s70, s70, 1
    s_add_u32 s70, s70, s31
    s_lshl_b32 s70, s70, 1
    s_and_b32 s71, s32, 3
    s_add_u32 s70, s70, s71
    s_and_b32 s70, s70, 15
    s_lshl_b32 s71, s70, 7
    s_add_u32 s36, s36, s71
    s_lshl_b32 s71, s70, 19
    s_add_u32 s35, s35, s71
    s_add_u32 s37, s36, s66
    s_mov_b32 s4, s48
    s_mov_b32 s5, s49
    s_mov_b32 s6, 0
    s_mov_b32 s96, s48
    s_mov_b32 s97, s49
    s_mov_b32 s98, 0
    s_branch L_k1_next2
L_k1_nonext:
    s_mov_b32 s18, 0
    s_mov_b32 s20, s56
    s_mov_b32 s21, s57
    s_mov_b32 s22, 8388608
    s_mov_b32 s35, s58
    s_mov_b32 s100, 131072
    s_lshr_b32 s70, s58, 8
    s_and_b32 s70, s70, 3
    s_lshl_b32 s70, s70, 0
    s_lshr_b32 s68, s2, 5
    s_lshl_b32 s68, s68, 0
    s_add_u32 s68, s68, s70
    s_and_b32 s68, s68, 3
    s_lshl_b32 s70, s68, 17
    s_add_u32 s35, s58, s70
    s_mov_b32 s42, 19
    v_mbcnt_lo_u32_b32 v237, -1, 0
    v_mbcnt_hi_u32_b32 v237, -1, v237
    s_lshr_b32 s70, s28, 1
    s_lshl_b32 s70, s70, 16
    s_and_b32 s71, s28, 1
    s_lshl_b32 s71, s71, 14
    s_add_u32 s70, s70, s71
    s_lshl_b32 s71, s28, 17
    s_sub_u32 s70, s70, s71
    v_lshrrev_b32 v237, 4, v237
    v_mul_u32_u24 v237, 6144, v237
    v_sub_u32 v237, s70, v237
    v_add_u32 v212, v212, v237
    v_add_u32 v213, v213, v237
    v_subrev_u32 v237, 57344, v237
    v_add_u32 v214, v214, v237
    v_add_u32 v215, v215, v237
    s_load_dwordx2 s[4:5], s[0:1], 32
    s_load_dwordx2 s[96:97], s[0:1], 72
    s_mov_b32 s6, 8388608
    s_mov_b32 s98, 8388608
L_k1_next2:
    s_mov_b32 s7, 0x00020000
    s_mov_b32 s99, 0x00020000
    v_mbcnt_lo_u32_b32 v233, -1, 0
    v_mbcnt_hi_u32_b32 v233, -1, v233
    v_lshlrev_b32 v233, 7, v233
    s_lshl_b32 s69, s2, 2
    s_add_u32 s69, s69, s28
    s_lshl_b32 s69, s69, 13
    s_mov_b32 s70, 0x3e0293ee
    s_mov_b32 s71, s70
    s_nop 7
    v_pk_mul_f32 v[0:1], s[70:71], v[0:1]
    v_pk_mul_f32 v[2:3], s[70:71], v[2:3]
    v_pk_mul_f32 v[16:17], s[70:71], v[16:17]
    v_pk_mul_f32 v[18:19], s[70:71], v[18:19]
    v_cvt_pk_bf16_f32 v128, v0, v1
    v_cvt_pk_bf16_f32 v129, v2, v3
    v_cvt_pk_bf16_f32 v130, v16, v17
    v_cvt_pk_bf16_f32 v131, v18, v19
    s_nop 1
    v_permlane32_swap_b32 v128, v130
    v_permlane32_swap_b32 v129, v131
    s_nop 0
    v_permlane16_swap_b32 v128, v130
    v_permlane16_swap_b32 v129, v131
    v_pk_mul_f32 v[4:5], s[70:71], v[4:5]
    v_pk_mul_f32 v[6:7], s[70:71], v[6:7]
    v_pk_mul_f32 v[20:21], s[70:71], v[20:21]
    v_pk_mul_f32 v[22:23], s[70:71], v[22:23]
    v_cvt_pk_bf16_f32 v144, v4, v5
    v_cvt_pk_bf16_f32 v145, v6, v7
    v_cvt_pk_bf16_f32 v146, v20, v21
    v_cvt_pk_bf16_f32 v147, v22, v23
    s_nop 1
    v_permlane32_swap_b32 v144, v146
    v_permlane32_swap_b32 v145, v147
    s_nop 0
    v_permlane16_swap_b32 v144, v146
    v_permlane16_swap_b32 v145, v147
    v_pk_mul_f32 v[8:9], s[70:71], v[8:9]
    v_pk_mul_f32 v[10:11], s[70:71], v[10:11]
    v_pk_mul_f32 v[24:25], s[70:71], v[24:25]
    v_pk_mul_f32 v[26:27], s[70:71], v[26:27]
    v_cvt_pk_bf16_f32 v160, v8, v9
    v_cvt_pk_bf16_f32 v161, v10, v11
    v_cvt_pk_bf16_f32 v162, v24, v25
    v_cvt_pk_bf16_f32 v163, v26, v27
    s_nop 1
    v_permlane32_swap_b32 v160, v162
    v_permlane32_swap_b32 v161, v163
    s_nop 0
    v_permlane16_swap_b32 v160, v162
    v_permlane16_swap_b32 v161, v163
    v_pk_mul_f32 v[12:13], s[70:71], v[12:13]
    v_pk_mul_f32 v[14:15], s[70:71], v[14:15]
    v_pk_mul_f32 v[28:29], s[70:71], v[28:29]
    v_pk_mul_f32 v[30:31], s[70:71], v[30:31]
    v_cvt_pk_bf16_f32 v176, v12, v13
    v_cvt_pk_bf16_f32 v177, v14, v15
    v_cvt_pk_bf16_f32 v178, v28, v29
    v_cvt_pk_bf16_f32 v179, v30, v31
    s_nop 1
    v_permlane32_swap_b32 v176, v178
    v_permlane32_swap_b32 v177, v179
    s_nop 0
    v_permlane16_swap_b32 v176, v178
    v_permlane16_swap_b32 v177, v179
    s_add_u32 m0, s29, 32768
    v_pk_mul_f32 v[32:33], s[70:71], v[32:33]
    v_pk_mul_f32 v[34:35], s[70:71], v[34:35]
    v_pk_mul_f32 v[48:49], s[70:71], v[48:49]
    v_pk_mul_f32 v[50:51], s[70:71], v[50:51]
    buffer_load_dwordx4 v208, s[8:11], s34 offen offset:0 nt lds
    v_cvt_pk_bf16_f32 v132, v32, v33
    v_cvt_pk_bf16_f32 v133, v34, v35
    v_cvt_pk_bf16_f32 v134, v48, v49
    v_cvt_pk_bf16_f32 v135, v50, v51
    s_nop 1
    v_permlane32_swap_b32 v132, v134
    v_permlane32_swap_b32 v133, v135
    s_nop 0
    v_permlane16_swap_b32 v132, v134
    v_permlane16_swap_b32 v133, v135
    v_pk_mul_f32 v[36:37], s[70:71], v[36:37]
    v_pk_mul_f32 v[38:39], s[70:71], v[38:39]
    v_pk_mul_f32 v[52:53], s[70:71], v[52:53]
    v_pk_mul_f32 v[54:55], s[70:71], v[54:55]
    buffer_load_dwordx4 v208, s[8:11], s34 offen offset:1024 nt lds
    v_cvt_pk_bf16_f32 v148, v36, v37
    v_cvt_pk_bf16_f32 v149, v38, v39
    v_cvt_pk_bf16_f32 v150, v52, v53
    v_cvt_pk_bf16_f32 v151, v54, v55
    s_nop 1
    v_permlane32_swap_b32 v148, v150
    v_permlane32_swap_b32 v149, v151
    s_nop 0
    v_permlane16_swap_b32 v148, v150
    v_permlane16_swap_b32 v149, v151
    v_pk_mul_f32 v[40:41], s[70:71], v[40:41]
    v_pk_mul_f32 v[42:43], s[70:71], v[42:43]
    v_pk_mul_f32 v[56:57], s[70:71], v[56:57]
    v_pk_mul_f32 v[58:59], s[70:71], v[58:59]
    buffer_load_dwordx4 v209, s[8:11], s34 offen offset:2048 nt lds
    v_cvt_pk_bf16_f32 v164, v40, v41
    v_cvt_pk_bf16_f32 v165, v42, v43
    v_cvt_pk_bf16_f32 v166, v56, v57
    v_cvt_pk_bf16_f32 v167, v58, v59
    s_nop 1
    v_permlane32_swap_b32 v164, v166
    v_permlane32_swap_b32 v165, v167
    s_nop 0
    v_permlane16_swap_b32 v164, v166
    v_permlane16_swap_b32 v165, v167
    v_pk_mul_f32 v[44:45], s[70:71], v[44:45]
    v_pk_mul_f32 v[46:47], s[70:71], v[46:47]
    v_pk_mul_f32 v[60:61], s[70:71], v[60:61]
    v_pk_mul_f32 v[62:63], s[70:71], v[62:63]
    buffer_load_dwordx4 v209, s[8:11], s34 offen offset:3072 nt lds
    s_add_u32 s34, s34, 16384
    v_cvt_pk_bf16_f32 v180, v44, v45
    v_cvt_pk_bf16_f32 v181, v46, v47
    v_cvt_pk_bf16_f32 v182, v60, v61
    v_cvt_pk_bf16_f32 v183, v62, v63
    s_nop 1
    v_permlane32_swap_b32 v180, v182
    v_permlane32_swap_b32 v181, v183
    s_nop 0
    v_permlane16_swap_b32 v180, v182
    v_permlane16_swap_b32 v181, v183
    v_pk_mul_f32 v[64:65], s[70:71], v[64:65]
    v_pk_mul_f32 v[66:67], s[70:71], v[66:67]
    v_pk_mul_f32 v[80:81], s[70:71], v[80:81]
    v_pk_mul_f32 v[82:83], s[70:71], v[82:83]
    v_cvt_pk_bf16_f32 v136, v64, v65
    v_cvt_pk_bf16_f32 v137, v66, v67
    v_cvt_pk_bf16_f32 v138, v80, v81
    v_cvt_pk_bf16_f32 v139, v82, v83
    s_nop 1
    v_permlane32_swap_b32 v136, v138
    v_permlane32_swap_b32 v137, v139
    s_nop 0
    v_permlane16_swap_b32 v136, v138
    v_permlane16_swap_b32 v137, v139
    v_pk_mul_f32 v[68:69], s[70:71], v[68:69]
    v_pk_mul_f32 v[70:71], s[70:71], v[70:71]
    v_pk_mul_f32 v[84:85], s[70:71], v[84:85]
    v_pk_mul_f32 v[86:87], s[70:71], v[86:87]
    v_cvt_pk_bf16_f32 v152, v68, v69
    v_cvt_pk_bf16_f32 v153, v70, v71
    v_cvt_pk_bf16_f32 v154, v84, v85
    v_cvt_pk_bf16_f32 v155, v86, v87
    s_nop 1
    v_permlane32_swap_b32 v152, v154
    v_permlane32_swap_b32 v153, v155
    s_nop 0
    v_permlane16_swap_b32 v152, v154
    v_permlane16_swap_b32 v153, v155
    v_pk_mul_f32 v[72:73], s[70:71], v[72:73]
    v_pk_mul_f32 v[74:75], s[70:71], v[74:75]
    v_pk_mul_f32 v[88:89], s[70:71], v[88:89]
    v_pk_mul_f32 v[90:91], s[70:71], v[90:91]
    v_cvt_pk_bf16_f32 v168, v72, v73
    v_cvt_pk_bf16_f32 v169, v74, v75
    v_cvt_pk_bf16_f32 v170, v88, v89
    v_cvt_pk_bf16_f32 v171, v90, v91
    s_nop 1
    v_permlane32_swap_b32 v168, v170
    v_permlane32_swap_b32 v169, v171
    s_nop 0
    v_permlane16_swap_b32 v168, v170
    v_permlane16_swap_b32 v169, v171
    v_pk_mul_f32 v[76:77], s[70:71], v[76:77]
    v_pk_mul_f32 v[78:79], s[70:71], v[78:79]
    v_pk_mul_f32 v[92:93], s[70:71], v[92:93]
    v_pk_mul_f32 v[94:95], s[70:71], v[94:95]
    v_cvt_pk_bf16_f32 v184, v76, v77
    v_cvt_pk_bf16_f32 v185, v78, v79
    v_cvt_pk_bf16_f32 v186, v92, v93
    v_cvt_pk_bf16_f32 v187, v94, v95
    s_nop 1
    v_permlane32_swap_b32 v184, v186
    v_permlane32_swap_b32 v185, v187
    s_nop 0
    v_permlane16_swap_b32 v184, v186
    v_permlane16_swap_b32 v185, v187
    s_add_u32 m0, s29, 81920
    v_pk_mul_f32 v[96:97], s[70:71], v[96:97]
    v_pk_mul_f32 v[98:99], s[70:71], v[98:99]
    v_pk_mul_f32 v[112:113], s[70:71], v[112:113]
    v_pk_mul_f32 v[114:115], s[70:71], v[114:115]
    buffer_load_dwordx4 v210, s[12:15], s75 offen offset:0 nt lds
    v_cvt_pk_bf16_f32 v140, v96, v97
    v_cvt_pk_bf16_f32 v141, v98, v99
    v_cvt_pk_bf16_f32 v142, v112, v113
    v_cvt_pk_bf16_f32 v143, v114, v115
    s_nop 1
    v_permlane32_swap_b32 v140, v142
    v_permlane32_swap_b32 v141, v143
    s_nop 0
    v_permlane16_swap_b32 v140, v142
    v_permlane16_swap_b32 v141, v143
    v_pk_mul_f32 v[100:101], s[70:71], v[100:101]
    v_pk_mul_f32 v[102:103], s[70:71], v[102:103]
    v_pk_mul_f32 v[116:117], s[70:71], v[116:117]
    v_pk_mul_f32 v[118:119], s[70:71], v[118:119]
    buffer_load_dwordx4 v210, s[12:15], s75 offen offset:1024 nt lds
    v_cvt_pk_bf16_f32 v156, v100, v101
    v_cvt_pk_bf16_f32 v157, v102, v103
    v_cvt_pk_bf16_f32 v158, v116, v117
    v_cvt_pk_bf16_f32 v159, v118, v119
    s_nop 1
    v_permlane32_swap_b32 v156, v158
    v_permlane32_swap_b32 v157, v159
    s_nop 0
    v_permlane16_swap_b32 v156, v158
    v_permlane16_swap_b32 v157, v159
    v_pk_mul_f32 v[104:105], s[70:71], v[104:105]
    v_pk_mul_f32 v[106:107], s[70:71], v[106:107]
    v_pk_mul_f32 v[120:121], s[70:71], v[120:121]
    v_pk_mul_f32 v[122:123], s[70:71], v[122:123]
    buffer_load_dwordx4 v211, s[12:15], s75 offen offset:2048 nt lds
    v_cvt_pk_bf16_f32 v172, v104, v105
    v_cvt_pk_bf16_f32 v173, v106, v107
    v_cvt_pk_bf16_f32 v174, v120, v121
    v_cvt_pk_bf16_f32 v175, v122, v123
    s_nop 1
    v_permlane32_swap_b32 v172, v174
    v_permlane32_swap_b32 v173, v175
    s_nop 0
    v_permlane16_swap_b32 v172, v174
    v_permlane16_swap_b32 v173, v175
    v_pk_mul_f32 v[108:109], s[70:71], v[108:109]
    v_pk_mul_f32 v[110:111], s[70:71], v[110:111]
    v_pk_mul_f32 v[124:125], s[70:71], v[124:125]
    v_pk_mul_f32 v[126:127], s[70:71], v[126:127]
    buffer_load_dwordx4 v211, s[12:15], s75 offen offset:3072 nt lds
    s_add_u32 s75, s75, 16384
    v_cvt_pk_bf16_f32 v188, v108, v109
    v_cvt_pk_bf16_f32 v189, v110, v111
    v_cvt_pk_bf16_f32 v190, v124, v125
    v_cvt_pk_bf16_f32 v191, v126, v127
    s_nop 1
    v_permlane32_swap_b32 v188, v190
    v_permlane32_swap_b32 v189, v191
    s_nop 0
    v_permlane16_swap_b32 v188, v190
    v_permlane16_swap_b32 v189, v191
    s_waitcnt vmcnt(8)
    s_barrier
    s_sub_u32 s70, s45, s46
    s_cmp_eq_u32 s70, 1
    s_cbranch_scc0 L_sig_lo
    s_cmp_eq_u32 s28, 0
    s_cbranch_scc0 L_sig_lo
    s_and_b32 s70, s2, 1
    s_lshl_b32 s70, s70, 3
    s_add_u32 s70, s70, s31
    s_lshl_b32 s70, s70, 4
    v_mov_b32 v245, s70
    v_mov_b32 v246, 1
    s_mov_b64 exec, 1
    global_atomic_add v245, v246, s[62:63] sc1
    s_mov_b64 exec, -1
L_sig_lo:
    s_cmp_eq_u32 s46, 0
    s_cbranch_scc0 L_k1_truemax
    s_cmp_eq_u32 s28, 3
    s_cselect_b32 s70, 0xff800000, 0
    v_mov_b32 v96, 0
    v_mov_b32 v97, 0
    v_mov_b32 v98, 0
    v_mov_b32 v99, 0
    v_mov_b32 v100, 0
    v_mov_b32 v101, 0
    v_mov_b32 v102, 0
    v_mov_b32 v103, 0
    v_mov_b32 v104, 0
    v_mov_b32 v105, 0
    v_mov_b32 v106, 0
    v_mov_b32 v107, 0
    v_mov_b32 v108, s70
    v_mov_b32 v109, s70
    v_mov_b32 v110, s70
    v_mov_b32 v111, s70
L_k1_att:
    v_mov_b32 v252, 0x3f803f80
    v_mov_b32 v253, 0x3f803f80
    v_mov_b32 v254, 0x3f803f80
    v_mov_b32 v255, 0x3f803f80
    s_cmp_eq_u32 s28, 3
    s_cbranch_scc1 L_w3_A
    ds_read_b128 a[128:131], v196 offset:0
    ds_read_b128 a[132:135], v197 offset:0
    ds_read_b128 a[136:139], v198 offset:0
    ds_read_b128 a[140:143], v199 offset:0
    ds_read_b128 a[144:147], v196 offset:1024
    ds_read_b128 a[148:151], v197 offset:1024
    ds_read_b128 a[152:155], v198 offset:1024
    ds_read_b128 a[156:159], v199 offset:1024
    s_waitcnt lgkmcnt(0)
    v_mfma_f32_16x16x32_bf16 v[0:3], a[128:131], v[128:131], v[96:99]
    v_mfma_f32_16x16x32_bf16 v[4:7], a[128:131], v[144:147], v[100:103]
    v_mfma_f32_16x16x32_bf16 v[8:11], a[128:131], v[160:163], v[104:107]
    v_mfma_f32_16x16x32_bf16 v[12:15], a[128:131], v[176:179], v[108:111]
    ds_read_b128 a[128:131], v196 offset:8192
    v_mfma_f32_16x16x32_bf16 v[0:3], a[132:135], v[132:135], v[0:3]
    v_mfma_f32_16x16x32_bf16 v[4:7], a[132:135], v[148:151], v[4:7]
    v_mfma_f32_16x16x32_bf16 v[8:11], a[132:135], v[164:167], v[8:11]
    v_mfma_f32_16x16x32_bf16 v[12:15], a[132:135], v[180:183], v[12:15]
    ds_read_b128 a[132:135], v197 offset:8192
    v_mfma_f32_16x16x32_bf16 v[0:3], a[136:139], v[136:139], v[0:3]
    v_mfma_f32_16x16x32_bf16 v[4:7], a[136:139], v[152:155], v[4:7]
    v_mfma_f32_16x16x32_bf16 v[8:11], a[136:139], v[168:171], v[8:11]
    v_mfma_f32_16x16x32_bf16 v[12:15], a[136:139], v[184:187], v[12:15]
    ds_read_b128 a[136:139], v198 offset:8192
    v_mfma_f32_16x16x32_bf16 v[0:3], a[140:143], v[140:143], v[0:3]
    v_mfma_f32_16x16x32_bf16 v[4:7], a[140:143], v[156:159], v[4:7]
    v_mfma_f32_16x16x32_bf16 v[8:11], a[140:143], v[172:175], v[8:11]
    v_mfma_f32_16x16x32_bf16 v[12:15], a[140:143], v[188:191], v[12:15]
    ds_read_b128 a[140:143], v199 offset:8192
    v_mfma_f32_16x16x32_bf16 v[16:19], a[144:147], v[128:131], v[96:99]
    v_mfma_f32_16x16x32_bf16 v[20:23], a[144:147], v[144:147], v[100:103]
    v_mfma_f32_16x16x32_bf16 v[24:27], a[144:147], v[160:163], v[104:107]
    v_mfma_f32_16x16x32_bf16 v[28:31], a[144:147], v[176:179], v[108:111]
    ds_read_b128 a[144:147], v196 offset:9216
    v_mfma_f32_16x16x32_bf16 v[16:19], a[148:151], v[132:135], v[16:19]
    v_mfma_f32_16x16x32_bf16 v[20:23], a[148:151], v[148:151], v[20:23]
    v_mfma_f32_16x16x32_bf16 v[24:27], a[148:151], v[164:167], v[24:27]
    v_mfma_f32_16x16x32_bf16 v[28:31], a[148:151], v[180:183], v[28:31]
    ds_read_b128 a[148:151], v197 offset:9216
    v_mfma_f32_16x16x32_bf16 v[16:19], a[152:155], v[136:139], v[16:19]
    v_mfma_f32_16x16x32_bf16 v[20:23], a[152:155], v[152:155], v[20:23]
    v_mfma_f32_16x16x32_bf16 v[24:27], a[152:155], v[168:171], v[24:27]
    v_mfma_f32_16x16x32_bf16 v[28:31], a[152:155], v[184:187], v[28:31]
    ds_read_b128 a[152:155], v198 offset:9216
    v_mfma_f32_16x16x32_bf16 v[16:19], a[156:159], v[140:143], v[16:19]
    v_mfma_f32_16x16x32_bf16 v[20:23], a[156:159], v[156:159], v[20:23]
    v_mfma_f32_16x16x32_bf16 v[24:27], a[156:159], v[172:175], v[24:27]
    v_mfma_f32_16x16x32_bf16 v[28:31], a[156:159], v[188:191], v[28:31]
    ds_read_b128 a[156:159], v199 offset:9216
    s_waitcnt lgkmcnt(0)
    s_nop 4
    v_mfma_f32_16x16x32_bf16 v[32:35], a[128:131], v[128:131], v[96:99]
    v_exp_f32 v0, v0
    v_mfma_f32_16x16x32_bf16 v[48:51], a[144:147], v[128:131], v[96:99]
    v_exp_f32 v1, v1
    v_mfma_f32_16x16x32_bf16 v[36:39], a[128:131], v[144:147], v[100:103]
    s_add_u32 m0, s29, 49152
    v_mfma_f32_16x16x32_bf16 v[52:55], a[144:147], v[144:147], v[100:103]
    v_cvt_pk_bf16_f32 v64, v0, v1
    v_mfma_f32_16x16x32_bf16 v[40:43], a[128:131], v[160:163], v[104:107]
    v_exp_f32 v2, v2
    v_mfma_f32_16x16x32_bf16 v[56:59], a[144:147], v[160:163], v[104:107]
    v_exp_f32 v3, v3
    v_mfma_f32_16x16x32_bf16 v[44:47], a[128:131], v[176:179], v[108:111]
    buffer_load_dwordx4 v208, s[8:11], s34 offen offset:0 nt lds
    v_mfma_f32_16x16x32_bf16 v[60:63], a[144:147], v[176:179], v[108:111]
    v_cvt_pk_bf16_f32 v65, v2, v3
    ds_read_b128 a[128:131], v196 offset:16384
    v_exp_f32 v4, v4
    v_exp_f32 v5, v5
    s_nop 0
    v_cvt_pk_bf16_f32 v68, v4, v5
    ds_read_b128 a[144:147], v196 offset:17408
    v_exp_f32 v6, v6
    v_exp_f32 v7, v7
    buffer_load_dwordx4 v208, s[8:11], s34 offen offset:1024 nt lds
    v_cvt_pk_bf16_f32 v69, v6, v7
    ds_read_b64_tr_b16 a[160:161], v200 offset:0
    v_mfma_f32_16x16x32_bf16 v[32:35], a[132:135], v[132:135], v[32:35]
    v_exp_f32 v8, v8
    v_mfma_f32_16x16x32_bf16 v[48:51], a[148:151], v[132:135], v[48:51]
    v_exp_f32 v9, v9
    v_mfma_f32_16x16x32_bf16 v[36:39], a[132:135], v[148:151], v[36:39]
    ds_read_b64_tr_b16 a[162:163], v200 offset:1024
    v_mfma_f32_16x16x32_bf16 v[52:55], a[148:151], v[148:151], v[52:55]
    v_cvt_pk_bf16_f32 v72, v8, v9
    ds_read_b64_tr_b16 a[164:165], v201 offset:0
    v_mfma_f32_16x16x32_bf16 v[40:43], a[132:135], v[164:167], v[40:43]
    v_exp_f32 v10, v10
    v_mfma_f32_16x16x32_bf16 v[56:59], a[148:151], v[164:167], v[56:59]
    v_exp_f32 v11, v11
    v_mfma_f32_16x16x32_bf16 v[44:47], a[132:135], v[180:183], v[44:47]
    buffer_load_dwordx4 v209, s[8:11], s34 offen offset:2048 nt lds
    v_mfma_f32_16x16x32_bf16 v[60:63], a[148:151], v[180:183], v[60:63]
    v_cvt_pk_bf16_f32 v73, v10, v11
    ds_read_b128 a[132:135], v197 offset:16384
    v_exp_f32 v12, v12
    v_exp_f32 v13, v13
    ds_read_b64_tr_b16 a[166:167], v201 offset:1024
    v_cvt_pk_bf16_f32 v76, v12, v13
    ds_read_b128 a[148:151], v197 offset:17408
    v_exp_f32 v14, v14
    v_exp_f32 v15, v15
    s_waitcnt lgkmcnt(8)
    buffer_load_dwordx4 v209, s[8:11], s34 offen offset:3072 nt lds
    v_cvt_pk_bf16_f32 v77, v14, v15
    ds_read_b64_tr_b16 a[168:169], v202 offset:0
    v_mfma_f32_16x16x32_bf16 v[32:35], a[136:139], v[136:139], v[32:35]
    v_exp_f32 v16, v16
    v_mfma_f32_16x16x32_bf16 v[48:51], a[152:155], v[136:139], v[48:51]
    v_exp_f32 v17, v17
    v_mfma_f32_16x16x32_bf16 v[36:39], a[136:139], v[152:155], v[36:39]
    ds_read_b64_tr_b16 a[170:171], v202 offset:1024
    s_add_u32 m0, s29, 98304
    v_mfma_f32_16x16x32_bf16 v[52:55], a[152:155], v[152:155], v[52:55]
    v_cvt_pk_bf16_f32 v66, v16, v17
    ds_read_b64_tr_b16 a[172:173], v203 offset:0
    v_mfma_f32_16x16x32_bf16 v[40:43], a[136:139], v[168:171], v[40:43]
    v_exp_f32 v18, v18
    v_mfma_f32_16x16x32_bf16 v[56:59], a[152:155], v[168:171], v[56:59]
    v_exp_f32 v19, v19
    v_mfma_f32_16x16x32_bf16 v[44:47], a[136:139], v[184:187], v[44:47]
    buffer_load_dwordx4 v210, s[12:15], s75 offen offset:0 nt lds
    v_mfma_f32_16x16x32_bf16 v[60:63], a[152:155], v[184:187], v[60:63]
    v_cvt_pk_bf16_f32 v67, v18, v19
    ds_read_b128 a[136:139], v198 offset:16384
    v_exp_f32 v20, v20
    v_exp_f32 v21, v21
    ds_read_b64_tr_b16 a[174:175], v203 offset:1024
    v_cvt_pk_bf16_f32 v70, v20, v21
    ds_read_b128 a[152:155], v198 offset:17408
    v_exp_f32 v22, v22
    v_exp_f32 v23, v23
    buffer_load_dwordx4 v210, s[12:15], s75 offen offset:1024 nt lds
    v_cvt_pk_bf16_f32 v71, v22, v23
    ds_read_b64_tr_b16 a[176:177], v204 offset:0
    v_mfma_f32_16x16x32_bf16 v[32:35], a[140:143], v[140:143], v[32:35]
    v_exp_f32 v24, v24
    v_mfma_f32_16x16x32_bf16 v[48:51], a[156:159], v[140:143], v[48:51]
    v_exp_f32 v25, v25
    v_mfma_f32_16x16x32_bf16 v[36:39], a[140:143], v[156:159], v[36:39]
    ds_read_b64_tr_b16 a[178:179], v204 offset:1024
    v_mfma_f32_16x16x32_bf16 v[52:55], a[156:159], v[156:159], v[52:55]
    v_cvt_pk_bf16_f32 v74, v24, v25
    ds_read_b64_tr_b16 a[180:181], v205 offset:0
    v_mfma_f32_16x16x32_bf16 v[40:43], a[140:143], v[172:175], v[40:43]
    v_exp_f32 v26, v26
    v_mfma_f32_16x16x32_bf16 v[56:59], a[156:159], v[172:175], v[56:59]
    v_exp_f32 v27, v27
    v_mfma_f32_16x16x32_bf16 v[44:47], a[140:143], v[188:191], v[44:47]
    buffer_load_dwordx4 v211, s[12:15], s75 offen offset:2048 nt lds
    v_mfma_f32_16x16x32_bf16 v[60:63], a[156:159], v[188:191], v[60:63]
    v_cvt_pk_bf16_f32 v75, v26, v27
    ds_read_b128 a[140:143], v199 offset:16384
    v_exp_f32 v28, v28
    v_exp_f32 v29, v29
    ds_read_b64_tr_b16 a[182:183], v205 offset:1024
    v_cvt_pk_bf16_f32 v78, v28, v29
    ds_read_b128 a[156:159], v199 offset:17408
    v_exp_f32 v30, v30
    v_exp_f32 v31, v31
    s_waitcnt lgkmcnt(7)
    buffer_load_dwordx4 v211, s[12:15], s75 offen offset:3072 nt lds
    v_cvt_pk_bf16_f32 v79, v30, v31
    ds_read_b64_tr_b16 a[184:185], v206 offset:0
    v_mfma_f32_16x16x32_bf16 v[0:3], a[128:131], v[128:131], v[96:99]
    v_exp_f32 v32, v32
    v_mfma_f32_16x16x32_bf16 v[16:19], a[144:147], v[128:131], v[96:99]
    v_exp_f32 v33, v33
    v_mfma_f32_16x16x32_bf16 v[4:7], a[128:131], v[144:147], v[100:103]
    ds_read_b64_tr_b16 a[186:187], v206 offset:1024
    v_mfma_f32_16x16x32_bf16 v[20:23], a[144:147], v[144:147], v[100:103]
    v_cvt_pk_bf16_f32 v80, v32, v33
    ds_read_b64_tr_b16 a[188:189], v207 offset:0
    v_mfma_f32_16x16x32_bf16 v[8:11], a[128:131], v[160:163], v[104:107]
    v_exp_f32 v34, v34
    v_mfma_f32_16x16x32_bf16 v[24:27], a[144:147], v[160:163], v[104:107]
    v_exp_f32 v35, v35
    v_mfma_f32_16x16x32_bf16 v[12:15], a[128:131], v[176:179], v[108:111]
    s_add_u32 s34, s34, 16384
    v_mfma_f32_16x16x32_bf16 v[28:31], a[144:147], v[176:179], v[108:111]
    v_cvt_pk_bf16_f32 v81, v34, v35
    ds_read_b128 a[128:131], v196 offset:24576
    v_mfma_f32_16x16x32_bf16 a[4:7], a[160:163], v[68:71], 0
    v_exp_f32 v36, v36
    v_mfma_f32_16x16x32_bf16 a[20:23], a[164:167], v[68:71], 0
    v_exp_f32 v37, v37
    v_mfma_f32_16x16x32_bf16 a[8:11], a[160:163], v[72:75], 0
    ds_read_b64_tr_b16 a[190:191], v207 offset:1024
    v_mfma_f32_16x16x32_bf16 a[24:27], a[164:167], v[72:75], 0
    v_cvt_pk_bf16_f32 v84, v36, v37
    ds_read_b128 a[144:147], v196 offset:25600
    v_mfma_f32_16x16x32_bf16 a[12:15], a[160:163], v[76:79], 0
    v_exp_f32 v38, v38
    v_mfma_f32_16x16x32_bf16 a[28:31], a[164:167], v[76:79], 0
    v_exp_f32 v39, v39
    v_mfma_f32_16x16x32_bf16 a[0:3], a[160:163], v[64:67], 0
    s_add_u32 s75, s75, 16384
    v_mfma_f32_16x16x32_bf16 a[16:19], a[164:167], v[64:67], 0
    v_cvt_pk_bf16_f32 v85, v38, v39
    v_mfma_f32_16x16x32_bf16 v[112:115], v[252:255], v[64:67], 0
    ds_read_b64_tr_b16 a[160:161], v200 offset:8192
    v_mfma_f32_16x16x32_bf16 v[0:3], a[132:135], v[132:135], v[0:3]
    v_exp_f32 v40, v40
    v_mfma_f32_16x16x32_bf16 v[16:19], a[148:151], v[132:135], v[16:19]
    v_exp_f32 v41, v41
    v_mfma_f32_16x16x32_bf16 v[4:7], a[132:135], v[148:151], v[4:7]
    ds_read_b64_tr_b16 a[162:163], v200 offset:9216
    v_mfma_f32_16x16x32_bf16 v[20:23], a[148:151], v[148:151], v[20:23]
    v_cvt_pk_bf16_f32 v88, v40, v41
    ds_read_b64_tr_b16 a[164:165], v201 offset:8192
    v_mfma_f32_16x16x32_bf16 v[8:11], a[132:135], v[164:167], v[8:11]
    v_exp_f32 v42, v42
    v_mfma_f32_16x16x32_bf16 v[24:27], a[148:151], v[164:167], v[24:27]
    v_exp_f32 v43, v43
    v_mfma_f32_16x16x32_bf16 v[12:15], a[132:135], v[180:183], v[12:15]
    v_mfma_f32_16x16x32_bf16 v[28:31], a[148:151], v[180:183], v[28:31]
    v_cvt_pk_bf16_f32 v89, v42, v43
    ds_read_b128 a[132:135], v197 offset:24576
    v_mfma_f32_16x16x32_bf16 a[40:43], a[168:171], v[72:75], 0
    v_exp_f32 v44, v44
    v_mfma_f32_16x16x32_bf16 a[56:59], a[172:175], v[72:75], 0
    v_exp_f32 v45, v45
    v_mfma_f32_16x16x32_bf16 a[44:47], a[168:171], v[76:79], 0
    ds_read_b64_tr_b16 a[166:167], v201 offset:9216
    v_mfma_f32_16x16x32_bf16 a[60:63], a[172:175], v[76:79], 0
    v_cvt_pk_bf16_f32 v92, v44, v45
    ds_read_b128 a[148:151], v197 offset:25600
    v_mfma_f32_16x16x32_bf16 a[32:35], a[168:171], v[64:67], 0
    v_exp_f32 v46, v46
    v_mfma_f32_16x16x32_bf16 a[48:51], a[172:175], v[64:67], 0
    v_exp_f32 v47, v47
    v_mfma_f32_16x16x32_bf16 a[36:39], a[168:171], v[68:71], 0
    s_waitcnt lgkmcnt(7)
    v_mfma_f32_16x16x32_bf16 a[52:55], a[172:175], v[68:71], 0
    v_cvt_pk_bf16_f32 v93, v46, v47
    v_mfma_f32_16x16x32_bf16 v[116:119], v[252:255], v[68:71], 0
    ds_read_b64_tr_b16 a[168:169], v202 offset:8192
    v_mfma_f32_16x16x32_bf16 v[0:3], a[136:139], v[136:139], v[0:3]
    v_exp_f32 v48, v48
    v_mfma_f32_16x16x32_bf16 v[16:19], a[152:155], v[136:139], v[16:19]
    v_exp_f32 v49, v49
    v_mfma_f32_16x16x32_bf16 v[4:7], a[136:139], v[152:155], v[4:7]
    ds_read_b64_tr_b16 a[170:171], v202 offset:9216
    v_mfma_f32_16x16x32_bf16 v[20:23], a[152:155], v[152:155], v[20:23]
    v_cvt_pk_bf16_f32 v82, v48, v49
    ds_read_b64_tr_b16 a[172:173], v203 offset:8192
    v_mfma_f32_16x16x32_bf16 v[8:11], a[136:139], v[168:171], v[8:11]
    v_exp_f32 v50, v50
    v_mfma_f32_16x16x32_bf16 v[24:27], a[152:155], v[168:171], v[24:27]
    v_exp_f32 v51, v51
    v_mfma_f32_16x16x32_bf16 v[12:15], a[136:139], v[184:187], v[12:15]
    v_mfma_f32_16x16x32_bf16 v[28:31], a[152:155], v[184:187], v[28:31]
    v_cvt_pk_bf16_f32 v83, v50, v51
    ds_read_b128 a[136:139], v198 offset:24576
    v_mfma_f32_16x16x32_bf16 a[76:79], a[176:179], v[76:79], 0
    v_exp_f32 v52, v52
    v_mfma_f32_16x16x32_bf16 a[92:95], a[180:183], v[76:79], 0
    v_exp_f32 v53, v53
    v_mfma_f32_16x16x32_bf16 a[64:67], a[176:179], v[64:67], 0
    ds_read_b64_tr_b16 a[174:175], v203 offset:9216
    v_mfma_f32_16x16x32_bf16 a[80:83], a[180:183], v[64:67], 0
    v_cvt_pk_bf16_f32 v86, v52, v53
    ds_read_b128 a[152:155], v198 offset:25600
    v_mfma_f32_16x16x32_bf16 a[68:71], a[176:179], v[68:71], 0
    v_exp_f32 v54, v54
    v_mfma_f32_16x16x32_bf16 a[84:87], a[180:183], v[68:71], 0
    v_exp_f32 v55, v55
    v_mfma_f32_16x16x32_bf16 a[72:75], a[176:179], v[72:75], 0
    v_mfma_f32_16x16x32_bf16 a[88:91], a[180:183], v[72:75], 0
    v_cvt_pk_bf16_f32 v87, v54, v55
    v_mfma_f32_16x16x32_bf16 v[120:123], v[252:255], v[72:75], 0
    ds_read_b64_tr_b16 a[176:177], v204 offset:8192
    v_mfma_f32_16x16x32_bf16 v[0:3], a[140:143], v[140:143], v[0:3]
    v_exp_f32 v56, v56
    v_mfma_f32_16x16x32_bf16 v[16:19], a[156:159], v[140:143], v[16:19]
    v_exp_f32 v57, v57
    v_mfma_f32_16x16x32_bf16 v[4:7], a[140:143], v[156:159], v[4:7]
    ds_read_b64_tr_b16 a[178:179], v204 offset:9216
    v_mfma_f32_16x16x32_bf16 v[20:23], a[156:159], v[156:159], v[20:23]
    v_cvt_pk_bf16_f32 v90, v56, v57
    ds_read_b64_tr_b16 a[180:181], v205 offset:8192
    v_mfma_f32_16x16x32_bf16 v[8:11], a[140:143], v[172:175], v[8:11]
    v_exp_f32 v58, v58
    v_mfma_f32_16x16x32_bf16 v[24:27], a[156:159], v[172:175], v[24:27]
    v_exp_f32 v59, v59
    v_mfma_f32_16x16x32_bf16 v[12:15], a[140:143], v[188:191], v[12:15]
    v_mfma_f32_16x16x32_bf16 v[28:31], a[156:159], v[188:191], v[28:31]
    v_cvt_pk_bf16_f32 v91, v58, v59
    ds_read_b128 a[140:143], v199 offset:24576
    v_mfma_f32_16x16x32_bf16 a[96:99], a[184:187], v[64:67], 0
    v_exp_f32 v60, v60
    v_mfma_f32_16x16x32_bf16 a[112:115], a[188:191], v[64:67], 0
    v_exp_f32 v61, v61
    v_mfma_f32_16x16x32_bf16 a[100:103], a[184:187], v[68:71], 0
    ds_read_b64_tr_b16 a[182:183], v205 offset:9216
    v_mfma_f32_16x16x32_bf16 a[116:119], a[188:191], v[68:71], 0
    v_cvt_pk_bf16_f32 v94, v60, v61
    ds_read_b128 a[156:159], v199 offset:25600
    v_mfma_f32_16x16x32_bf16 a[104:107], a[184:187], v[72:75], 0
    v_exp_f32 v62, v62
    v_mfma_f32_16x16x32_bf16 a[120:123], a[188:191], v[72:75], 0
    v_exp_f32 v63, v63
    v_mfma_f32_16x16x32_bf16 a[108:111], a[184:187], v[76:79], 0
    s_waitcnt lgkmcnt(7)
    v_mfma_f32_16x16x32_bf16 a[124:127], a[188:191], v[76:79], 0
    v_cvt_pk_bf16_f32 v95, v62, v63
    v_mfma_f32_16x16x32_bf16 v[124:127], v[252:255], v[76:79], 0
    ds_read_b64_tr_b16 a[184:185], v206 offset:8192
    s_waitcnt vmcnt(8)
    s_barrier
    s_mov_b32 s44, 3
L_k1_aloop:
    v_mfma_f32_16x16x32_bf16 v[32:35], a[128:131], v[128:131], v[96:99]
    v_exp_f32 v0, v0
    v_mfma_f32_16x16x32_bf16 v[48:51], a[144:147], v[128:131], v[96:99]
    v_exp_f32 v1, v1
    v_mfma_f32_16x16x32_bf16 v[36:39], a[128:131], v[144:147], v[100:103]
    ds_read_b64_tr_b16 a[186:187], v206 offset:9216
    s_mov_b32 m0, s29
    v_mfma_f32_16x16x32_bf16 v[52:55], a[144:147], v[144:147], v[100:103]
    v_cvt_pk_bf16_f32 v64, v0, v1
    ds_read_b64_tr_b16 a[188:189], v207 offset:8192
    v_mfma_f32_16x16x32_bf16 v[40:43], a[128:131], v[160:163], v[104:107]
    v_exp_f32 v2, v2
    v_mfma_f32_16x16x32_bf16 v[56:59], a[144:147], v[160:163], v[104:107]
    v_exp_f32 v3, v3
    v_mfma_f32_16x16x32_bf16 v[44:47], a[128:131], v[176:179], v[108:111]
    buffer_load_dwordx4 v208, s[8:11], s34 offen offset:0 nt lds
    v_mfma_f32_16x16x32_bf16 v[60:63], a[144:147], v[176:179], v[108:111]
    v_cvt_pk_bf16_f32 v65, v2, v3
    ds_read_b128 a[128:131], v196 offset:32768
    v_mfma_f32_16x16x32_bf16 a[4:7], a[160:163], v[84:87], a[4:7]
    v_exp_f32 v4, v4
    v_mfma_f32_16x16x32_bf16 a[20:23], a[164:167], v[84:87], a[20:23]
    v_exp_f32 v5, v5
    v_mfma_f32_16x16x32_bf16 a[8:11], a[160:163], v[88:91], a[8:11]
    ds_read_b64_tr_b16 a[190:191], v207 offset:9216
    v_mfma_f32_16x16x32_bf16 a[24:27], a[164:167], v[88:91], a[24:27]
    v_cvt_pk_bf16_f32 v68, v4, v5
    ds_read_b128 a[144:147], v196 offset:33792
    v_mfma_f32_16x16x32_bf16 a[12:15], a[160:163], v[92:95], a[12:15]
    v_exp_f32 v6, v6
    v_mfma_f32_16x16x32_bf16 a[28:31], a[164:167], v[92:95], a[28:31]
    v_exp_f32 v7, v7
    v_mfma_f32_16x16x32_bf16 a[0:3], a[160:163], v[80:83], a[0:3]
    buffer_load_dwordx4 v208, s[8:11], s34 offen offset:1024 nt lds
    v_mfma_f32_16x16x32_bf16 a[16:19], a[164:167], v[80:83], a[16:19]
    v_cvt_pk_bf16_f32 v69, v6, v7
    v_mfma_f32_16x16x32_bf16 v[112:115], v[252:255], v[80:83], v[112:115]
    ds_read_b64_tr_b16 a[160:161], v200 offset:16384
    v_mfma_f32_16x16x32_bf16 v[32:35], a[132:135], v[132:135], v[32:35]
    v_exp_f32 v8, v8
    v_mfma_f32_16x16x32_bf16 v[48:51], a[148:151], v[132:135], v[48:51]
    v_exp_f32 v9, v9
    v_mfma_f32_16x16x32_bf16 v[36:39], a[132:135], v[148:151], v[36:39]
    ds_read_b64_tr_b16 a[162:163], v200 offset:17408
    v_mfma_f32_16x16x32_bf16 v[52:55], a[148:151], v[148:151], v[52:55]
    v_cvt_pk_bf16_f32 v72, v8, v9
    ds_read_b64_tr_b16 a[164:165], v201 offset:16384
    v_mfma_f32_16x16x32_bf16 v[40:43], a[132:135], v[164:167], v[40:43]
    v_exp_f32 v10, v10
    v_mfma_f32_16x16x32_bf16 v[56:59], a[148:151], v[164:167], v[56:59]
    v_exp_f32 v11, v11
    v_mfma_f32_16x16x32_bf16 v[44:47], a[132:135], v[180:183], v[44:47]
    buffer_load_dwordx4 v209, s[8:11], s34 offen offset:2048 nt lds
    v_mfma_f32_16x16x32_bf16 v[60:63], a[148:151], v[180:183], v[60:63]
    v_cvt_pk_bf16_f32 v73, v10, v11
    ds_read_b128 a[132:135], v197 offset:32768
    v_mfma_f32_16x16x32_bf16 a[40:43], a[168:171], v[88:91], a[40:43]
    v_exp_f32 v12, v12
    v_mfma_f32_16x16x32_bf16 a[56:59], a[172:175], v[88:91], a[56:59]
    v_exp_f32 v13, v13
    v_mfma_f32_16x16x32_bf16 a[44:47], a[168:171], v[92:95], a[44:47]
    ds_read_b64_tr_b16 a[166:167], v201 offset:17408
    v_mfma_f32_16x16x32_bf16 a[60:63], a[172:175], v[92:95], a[60:63]
    v_cvt_pk_bf16_f32 v76, v12, v13
    ds_read_b128 a[148:151], v197 offset:33792
    v_mfma_f32_16x16x32_bf16 a[32:35], a[168:171], v[80:83], a[32:35]
    v_exp_f32 v14, v14
    v_mfma_f32_16x16x32_bf16 a[48:51], a[172:175], v[80:83], a[48:51]
    v_exp_f32 v15, v15
    v_mfma_f32_16x16x32_bf16 a[36:39], a[168:171], v[84:87], a[36:39]
    s_waitcnt lgkmcnt(7)
    buffer_load_dwordx4 v209, s[8:11], s34 offen offset:3072 nt lds
    v_mfma_f32_16x16x32_bf16 a[52:55], a[172:175], v[84:87], a[52:55]
    v_cvt_pk_bf16_f32 v77, v14, v15
    v_mfma_f32_16x16x32_bf16 v[116:119], v[252:255], v[84:87], v[116:119]
    ds_read_b64_tr_b16 a[168:169], v202 offset:16384
    v_mfma_f32_16x16x32_bf16 v[32:35], a[136:139], v[136:139], v[32:35]
    v_exp_f32 v16, v16
    v_mfma_f32_16x16x32_bf16 v[48:51], a[152:155], v[136:139], v[48:51]
    v_exp_f32 v17, v17
    v_mfma_f32_16x16x32_bf16 v[36:39], a[136:139], v[152:155], v[36:39]
    ds_read_b64_tr_b16 a[170:171], v202 offset:17408
    s_add_u32 m0, s29, 114688
    v_mfma_f32_16x16x32_bf16 v[52:55], a[152:155], v[152:155], v[52:55]
    v_cvt_pk_bf16_f32 v66, v16, v17
    ds_read_b64_tr_b16 a[172:173], v203 offset:16384
    v_mfma_f32_16x16x32_bf16 v[40:43], a[136:139], v[168:171], v[40:43]
    v_exp_f32 v18, v18
    v_mfma_f32_16x16x32_bf16 v[56:59], a[152:155], v[168:171], v[56:59]
    v_exp_f32 v19, v19
    v_mfma_f32_16x16x32_bf16 v[44:47], a[136:139], v[184:187], v[44:47]
    buffer_load_dwordx4 v210, s[12:15], s75 offen offset:0 nt lds
    v_mfma_f32_16x16x32_bf16 v[60:63], a[152:155], v[184:187], v[60:63]
    v_cvt_pk_bf16_f32 v67, v18, v19
    ds_read_b128 a[136:139], v198 offset:32768
    v_mfma_f32_16x16x32_bf16 a[76:79], a[176:179], v[92:95], a[76:79]
    v_exp_f32 v20, v20
    v_mfma_f32_16x16x32_bf16 a[92:95], a[180:183], v[92:95], a[92:95]
    v_exp_f32 v21, v21
    v_mfma_f32_16x16x32_bf16 a[64:67], a[176:179], v[80:83], a[64:67]
    ds_read_b64_tr_b16 a[174:175], v203 offset:17408
    v_mfma_f32_16x16x32_bf16 a[80:83], a[180:183], v[80:83], a[80:83]
    v_cvt_pk_bf16_f32 v70, v20, v21
    ds_read_b128 a[152:155], v198 offset:33792
    v_mfma_f32_16x16x32_bf16 a[68:71], a[176:179], v[84:87], a[68:71]
    v_exp_f32 v22, v22
    v_mfma_f32_16x16x32_bf16 a[84:87], a[180:183], v[84:87], a[84:87]
    v_exp_f32 v23, v23
    v_mfma_f32_16x16x32_bf16 a[72:75], a[176:179], v[88:91], a[72:75]
    buffer_load_dwordx4 v210, s[12:15], s75 offen offset:1024 nt lds
    v_mfma_f32_16x16x32_bf16 a[88:91], a[180:183], v[88:91], a[88:91]
    v_cvt_pk_bf16_f32 v71, v22, v23
    v_mfma_f32_16x16x32_bf16 v[120:123], v[252:255], v[88:91], v[120:123]
    ds_read_b64_tr_b16 a[176:177], v204 offset:16384
    v_mfma_f32_16x16x32_bf16 v[32:35], a[140:143], v[140:143], v[32:35]
    v_exp_f32 v24, v24
    v_mfma_f32_16x16x32_bf16 v[48:51], a[156:159], v[140:143], v[48:51]
    v_exp_f32 v25, v25
    v_mfma_f32_16x16x32_bf16 v[36:39], a[140:143], v[156:159], v[36:39]
    ds_read_b64_tr_b16 a[178:179], v204 offset:17408
    v_mfma_f32_16x16x32_bf16 v[52:55], a[156:159], v[156:159], v[52:55]
    v_cvt_pk_bf16_f32 v74, v24, v25
    ds_read_b64_tr_b16 a[180:181], v205 offset:16384
    v_mfma_f32_16x16x32_bf16 v[40:43], a[140:143], v[172:175], v[40:43]
    v_exp_f32 v26, v26
    v_mfma_f32_16x16x32_bf16 v[56:59], a[156:159], v[172:175], v[56:59]
    v_exp_f32 v27, v27
    v_mfma_f32_16x16x32_bf16 v[44:47], a[140:143], v[188:191], v[44:47]
    buffer_load_dwordx4 v211, s[12:15], s75 offen offset:2048 nt lds
    v_mfma_f32_16x16x32_bf16 v[60:63], a[156:159], v[188:191], v[60:63]
    v_cvt_pk_bf16_f32 v75, v26, v27
    ds_read_b128 a[140:143], v199 offset:32768
    v_mfma_f32_16x16x32_bf16 a[96:99], a[184:187], v[80:83], a[96:99]
    v_exp_f32 v28, v28
    v_mfma_f32_16x16x32_bf16 a[112:115], a[188:191], v[80:83], a[112:115]
    v_exp_f32 v29, v29
    v_mfma_f32_16x16x32_bf16 a[100:103], a[184:187], v[84:87], a[100:103]
    ds_read_b64_tr_b16 a[182:183], v205 offset:17408
    v_mfma_f32_16x16x32_bf16 a[116:119], a[188:191], v[84:87], a[116:119]
    v_cvt_pk_bf16_f32 v78, v28, v29
    ds_read_b128 a[156:159], v199 offset:33792
    v_mfma_f32_16x16x32_bf16 a[104:107], a[184:187], v[88:91], a[104:107]
    v_exp_f32 v30, v30
    v_mfma_f32_16x16x32_bf16 a[120:123], a[188:191], v[88:91], a[120:123]
    v_exp_f32 v31, v31
    v_mfma_f32_16x16x32_bf16 a[108:111], a[184:187], v[92:95], a[108:111]
    s_waitcnt lgkmcnt(7)
    buffer_load_dwordx4 v211, s[12:15], s75 offen offset:3072 nt lds
    v_mfma_f32_16x16x32_bf16 a[124:127], a[188:191], v[92:95], a[124:127]
    v_cvt_pk_bf16_f32 v79, v30, v31
    v_mfma_f32_16x16x32_bf16 v[124:127], v[252:255], v[92:95], v[124:127]
    ds_read_b64_tr_b16 a[184:185], v206 offset:16384
    v_mfma_f32_16x16x32_bf16 v[0:3], a[128:131], v[128:131], v[96:99]
    v_exp_f32 v32, v32
    v_mfma_f32_16x16x32_bf16 v[16:19], a[144:147], v[128:131], v[96:99]
    v_exp_f32 v33, v33
    v_mfma_f32_16x16x32_bf16 v[4:7], a[128:131], v[144:147], v[100:103]
    ds_read_b64_tr_b16 a[186:187], v206 offset:17408
    v_mfma_f32_16x16x32_bf16 v[20:23], a[144:147], v[144:147], v[100:103]
    v_cvt_pk_bf16_f32 v80, v32, v33
    ds_read_b64_tr_b16 a[188:189], v207 offset:16384
    v_mfma_f32_16x16x32_bf16 v[8:11], a[128:131], v[160:163], v[104:107]
    v_exp_f32 v34, v34
    v_mfma_f32_16x16x32_bf16 v[24:27], a[144:147], v[160:163], v[104:107]
    v_exp_f32 v35, v35
    v_mfma_f32_16x16x32_bf16 v[12:15], a[128:131], v[176:179], v[108:111]
    s_add_u32 s34, s34, 16384
    v_mfma_f32_16x16x32_bf16 v[28:31], a[144:147], v[176:179], v[108:111]
    v_cvt_pk_bf16_f32 v81, v34, v35
    ds_read_b128 a[128:131], v196 offset:40960
    v_mfma_f32_16x16x32_bf16 a[4:7], a[160:163], v[68:71], a[4:7]
    v_exp_f32 v36, v36
    v_mfma_f32_16x16x32_bf16 a[20:23], a[164:167], v[68:71], a[20:23]
    v_exp_f32 v37, v37
    v_mfma_f32_16x16x32_bf16 a[8:11], a[160:163], v[72:75], a[8:11]
    ds_read_b64_tr_b16 a[190:191], v207 offset:17408
    v_mfma_f32_16x16x32_bf16 a[24:27], a[164:167], v[72:75], a[24:27]
    v_cvt_pk_bf16_f32 v84, v36, v37
    ds_read_b128 a[144:147], v196 offset:41984
    v_mfma_f32_16x16x32_bf16 a[12:15], a[160:163], v[76:79], a[12:15]
    v_exp_f32 v38, v38
    v_mfma_f32_16x16x32_bf16 a[28:31], a[164:167], v[76:79], a[28:31]
    v_exp_f32 v39, v39
    v_mfma_f32_16x16x32_bf16 a[0:3], a[160:163], v[64:67], a[0:3]
    s_add_u32 s75, s75, 16384
    v_mfma_f32_16x16x32_bf16 a[16:19], a[164:167], v[64:67], a[16:19]
    v_cvt_pk_bf16_f32 v85, v38, v39
    v_mfma_f32_16x16x32_bf16 v[112:115], v[252:255], v[64:67], v[112:115]
    ds_read_b64_tr_b16 a[160:161], v200 offset:24576
    v_mfma_f32_16x16x32_bf16 v[0:3], a[132:135], v[132:135], v[0:3]
    v_exp_f32 v40, v40
    v_mfma_f32_16x16x32_bf16 v[16:19], a[148:151], v[132:135], v[16:19]
    v_exp_f32 v41, v41
    v_mfma_f32_16x16x32_bf16 v[4:7], a[132:135], v[148:151], v[4:7]
    ds_read_b64_tr_b16 a[162:163], v200 offset:25600
    v_mfma_f32_16x16x32_bf16 v[20:23], a[148:151], v[148:151], v[20:23]
    v_cvt_pk_bf16_f32 v88, v40, v41
    ds_read_b64_tr_b16 a[164:165], v201 offset:24576
    v_mfma_f32_16x16x32_bf16 v[8:11], a[132:135], v[164:167], v[8:11]
    v_exp_f32 v42, v42
    v_mfma_f32_16x16x32_bf16 v[24:27], a[148:151], v[164:167], v[24:27]
    v_exp_f32 v43, v43
    v_mfma_f32_16x16x32_bf16 v[12:15], a[132:135], v[180:183], v[12:15]
    v_mfma_f32_16x16x32_bf16 v[28:31], a[148:151], v[180:183], v[28:31]
    v_cvt_pk_bf16_f32 v89, v42, v43
    ds_read_b128 a[132:135], v197 offset:40960
    v_mfma_f32_16x16x32_bf16 a[40:43], a[168:171], v[72:75], a[40:43]
    v_exp_f32 v44, v44
    v_mfma_f32_16x16x32_bf16 a[56:59], a[172:175], v[72:75], a[56:59]
    v_exp_f32 v45, v45
    v_mfma_f32_16x16x32_bf16 a[44:47], a[168:171], v[76:79], a[44:47]
    ds_read_b64_tr_b16 a[166:167], v201 offset:25600
    v_mfma_f32_16x16x32_bf16 a[60:63], a[172:175], v[76:79], a[60:63]
    v_cvt_pk_bf16_f32 v92, v44, v45
    ds_read_b128 a[148:151], v197 offset:41984
    v_mfma_f32_16x16x32_bf16 a[32:35], a[168:171], v[64:67], a[32:35]
    v_exp_f32 v46, v46
    v_mfma_f32_16x16x32_bf16 a[48:51], a[172:175], v[64:67], a[48:51]
    v_exp_f32 v47, v47
    v_mfma_f32_16x16x32_bf16 a[36:39], a[168:171], v[68:71], a[36:39]
    s_waitcnt lgkmcnt(7)
    v_mfma_f32_16x16x32_bf16 a[52:55], a[172:175], v[68:71], a[52:55]
    v_cvt_pk_bf16_f32 v93, v46, v47
    v_mfma_f32_16x16x32_bf16 v[116:119], v[252:255], v[68:71], v[116:119]
    ds_read_b64_tr_b16 a[168:169], v202 offset:24576
    v_mfma_f32_16x16x32_bf16 v[0:3], a[136:139], v[136:139], v[0:3]
    v_exp_f32 v48, v48
    v_mfma_f32_16x16x32_bf16 v[16:19], a[152:155], v[136:139], v[16:19]
    v_exp_f32 v49, v49
    v_mfma_f32_16x16x32_bf16 v[4:7], a[136:139], v[152:155], v[4:7]
    ds_read_b64_tr_b16 a[170:171], v202 offset:25600
    v_mfma_f32_16x16x32_bf16 v[20:23], a[152:155], v[152:155], v[20:23]
    v_cvt_pk_bf16_f32 v82, v48, v49
    ds_read_b64_tr_b16 a[172:173], v203 offset:24576
    v_mfma_f32_16x16x32_bf16 v[8:11], a[136:139], v[168:171], v[8:11]
    v_exp_f32 v50, v50
    v_mfma_f32_16x16x32_bf16 v[24:27], a[152:155], v[168:171], v[24:27]
    v_exp_f32 v51, v51
    v_mfma_f32_16x16x32_bf16 v[12:15], a[136:139], v[184:187], v[12:15]
    v_mfma_f32_16x16x32_bf16 v[28:31], a[152:155], v[184:187], v[28:31]
    v_cvt_pk_bf16_f32 v83, v50, v51
    ds_read_b128 a[136:139], v198 offset:40960
    v_mfma_f32_16x16x32_bf16 a[76:79], a[176:179], v[76:79], a[76:79]
    v_exp_f32 v52, v52
    v_mfma_f32_16x16x32_bf16 a[92:95], a[180:183], v[76:79], a[92:95]
    v_exp_f32 v53, v53
    v_mfma_f32_16x16x32_bf16 a[64:67], a[176:179], v[64:67], a[64:67]
    ds_read_b64_tr_b16 a[174:175], v203 offset:25600
    v_mfma_f32_16x16x32_bf16 a[80:83], a[180:183], v[64:67], a[80:83]
    v_cvt_pk_bf16_f32 v86, v52, v53
    ds_read_b128 a[152:155], v198 offset:41984
    v_mfma_f32_16x16x32_bf16 a[68:71], a[176:179], v[68:71], a[68:71]
    v_exp_f32 v54, v54
    v_mfma_f32_16x16x32_bf16 a[84:87], a[180:183], v[68:71], a[84:87]
    v_exp_f32 v55, v55
    v_mfma_f32_16x16x32_bf16 a[72:75], a[176:179], v[72:75], a[72:75]
    v_mfma_f32_16x16x32_bf16 a[88:91], a[180:183], v[72:75], a[88:91]
    v_cvt_pk_bf16_f32 v87, v54, v55
    v_mfma_f32_16x16x32_bf16 v[120:123], v[252:255], v[72:75], v[120:123]
    ds_read_b64_tr_b16 a[176:177], v204 offset:24576
    v_mfma_f32_16x16x32_bf16 v[0:3], a[140:143], v[140:143], v[0:3]
    v_exp_f32 v56, v56
    v_mfma_f32_16x16x32_bf16 v[16:19], a[156:159], v[140:143], v[16:19]
    v_exp_f32 v57, v57
    v_mfma_f32_16x16x32_bf16 v[4:7], a[140:143], v[156:159], v[4:7]
    ds_read_b64_tr_b16 a[178:179], v204 offset:25600
    v_mfma_f32_16x16x32_bf16 v[20:23], a[156:159], v[156:159], v[20:23]
    v_cvt_pk_bf16_f32 v90, v56, v57
    ds_read_b64_tr_b16 a[180:181], v205 offset:24576
    v_mfma_f32_16x16x32_bf16 v[8:11], a[140:143], v[172:175], v[8:11]
    v_exp_f32 v58, v58
    v_mfma_f32_16x16x32_bf16 v[24:27], a[156:159], v[172:175], v[24:27]
    v_exp_f32 v59, v59
    v_mfma_f32_16x16x32_bf16 v[12:15], a[140:143], v[188:191], v[12:15]
    v_mfma_f32_16x16x32_bf16 v[28:31], a[156:159], v[188:191], v[28:31]
    v_cvt_pk_bf16_f32 v91, v58, v59
    ds_read_b128 a[140:143], v199 offset:40960
    v_mfma_f32_16x16x32_bf16 a[96:99], a[184:187], v[64:67], a[96:99]
    v_exp_f32 v60, v60
    v_mfma_f32_16x16x32_bf16 a[112:115], a[188:191], v[64:67], a[112:115]
    v_exp_f32 v61, v61
    v_mfma_f32_16x16x32_bf16 a[100:103], a[184:187], v[68:71], a[100:103]
    ds_read_b64_tr_b16 a[182:183], v205 offset:25600
    v_mfma_f32_16x16x32_bf16 a[116:119], a[188:191], v[68:71], a[116:119]
    v_cvt_pk_bf16_f32 v94, v60, v61
    ds_read_b128 a[156:159], v199 offset:41984
    v_mfma_f32_16x16x32_bf16 a[104:107], a[184:187], v[72:75], a[104:107]
    v_exp_f32 v62, v62
    v_mfma_f32_16x16x32_bf16 a[120:123], a[188:191], v[72:75], a[120:123]
    v_exp_f32 v63, v63
    v_mfma_f32_16x16x32_bf16 a[108:111], a[184:187], v[76:79], a[108:111]
    s_waitcnt lgkmcnt(7)
    v_mfma_f32_16x16x32_bf16 a[124:127], a[188:191], v[76:79], a[124:127]
    v_cvt_pk_bf16_f32 v95, v62, v63
    v_mfma_f32_16x16x32_bf16 v[124:127], v[252:255], v[76:79], v[124:127]
    ds_read_b64_tr_b16 a[184:185], v206 offset:24576
    s_waitcnt vmcnt(8)
    s_barrier
    v_mfma_f32_16x16x32_bf16 v[32:35], a[128:131], v[128:131], v[96:99]
    v_exp_f32 v0, v0
    v_mfma_f32_16x16x32_bf16 v[48:51], a[144:147], v[128:131], v[96:99]
    v_exp_f32 v1, v1
    v_mfma_f32_16x16x32_bf16 v[36:39], a[128:131], v[144:147], v[100:103]
    ds_read_b64_tr_b16 a[186:187], v206 offset:25600
    s_add_u32 m0, s29, 16384
    v_mfma_f32_16x16x32_bf16 v[52:55], a[144:147], v[144:147], v[100:103]
    v_cvt_pk_bf16_f32 v64, v0, v1
    ds_read_b64_tr_b16 a[188:189], v207 offset:24576
    v_mfma_f32_16x16x32_bf16 v[40:43], a[128:131], v[160:163], v[104:107]
    v_exp_f32 v2, v2
    v_mfma_f32_16x16x32_bf16 v[56:59], a[144:147], v[160:163], v[104:107]
    v_exp_f32 v3, v3
    v_mfma_f32_16x16x32_bf16 v[44:47], a[128:131], v[176:179], v[108:111]
    buffer_load_dwordx4 v208, s[8:11], s34 offen offset:0 nt lds
    v_mfma_f32_16x16x32_bf16 v[60:63], a[144:147], v[176:179], v[108:111]
    v_cvt_pk_bf16_f32 v65, v2, v3
    ds_read_b128 a[128:131], v196 offset:49152
    v_mfma_f32_16x16x32_bf16 a[4:7], a[160:163], v[84:87], a[4:7]
    v_exp_f32 v4, v4
    v_mfma_f32_16x16x32_bf16 a[20:23], a[164:167], v[84:87], a[20:23]
    v_exp_f32 v5, v5
    v_mfma_f32_16x16x32_bf16 a[8:11], a[160:163], v[88:91], a[8:11]
    ds_read_b64_tr_b16 a[190:191], v207 offset:25600
    v_mfma_f32_16x16x32_bf16 a[24:27], a[164:167], v[88:91], a[24:27]
    v_cvt_pk_bf16_f32 v68, v4, v5
    ds_read_b128 a[144:147], v196 offset:50176
    v_mfma_f32_16x16x32_bf16 a[12:15], a[160:163], v[92:95], a[12:15]
    v_exp_f32 v6, v6
    v_mfma_f32_16x16x32_bf16 a[28:31], a[164:167], v[92:95], a[28:31]
    v_exp_f32 v7, v7
    v_mfma_f32_16x16x32_bf16 a[0:3], a[160:163], v[80:83], a[0:3]
    buffer_load_dwordx4 v208, s[8:11], s34 offen offset:1024 nt lds
    v_mfma_f32_16x16x32_bf16 a[16:19], a[164:167], v[80:83], a[16:19]
    v_cvt_pk_bf16_f32 v69, v6, v7
    v_mfma_f32_16x16x32_bf16 v[112:115], v[252:255], v[80:83], v[112:115]
    ds_read_b64_tr_b16 a[160:161], v200 offset:32768
    v_mfma_f32_16x16x32_bf16 v[32:35], a[132:135], v[132:135], v[32:35]
    v_exp_f32 v8, v8
    v_mfma_f32_16x16x32_bf16 v[48:51], a[148:151], v[132:135], v[48:51]
    v_exp_f32 v9, v9
    v_mfma_f32_16x16x32_bf16 v[36:39], a[132:135], v[148:151], v[36:39]
    ds_read_b64_tr_b16 a[162:163], v200 offset:33792
    v_mfma_f32_16x16x32_bf16 v[52:55], a[148:151], v[148:151], v[52:55]
    v_cvt_pk_bf16_f32 v72, v8, v9
    ds_read_b64_tr_b16 a[164:165], v201 offset:32768
    v_mfma_f32_16x16x32_bf16 v[40:43], a[132:135], v[164:167], v[40:43]
    v_exp_f32 v10, v10
    v_mfma_f32_16x16x32_bf16 v[56:59], a[148:151], v[164:167], v[56:59]
    v_exp_f32 v11, v11
    v_mfma_f32_16x16x32_bf16 v[44:47], a[132:135], v[180:183], v[44:47]
    buffer_load_dwordx4 v209, s[8:11], s34 offen offset:2048 nt lds
    v_mfma_f32_16x16x32_bf16 v[60:63], a[148:151], v[180:183], v[60:63]
    v_cvt_pk_bf16_f32 v73, v10, v11
    ds_read_b128 a[132:135], v197 offset:49152
    v_mfma_f32_16x16x32_bf16 a[40:43], a[168:171], v[88:91], a[40:43]
    v_exp_f32 v12, v12
    v_mfma_f32_16x16x32_bf16 a[56:59], a[172:175], v[88:91], a[56:59]
    v_exp_f32 v13, v13
    v_mfma_f32_16x16x32_bf16 a[44:47], a[168:171], v[92:95], a[44:47]
    ds_read_b64_tr_b16 a[166:167], v201 offset:33792
    v_mfma_f32_16x16x32_bf16 a[60:63], a[172:175], v[92:95], a[60:63]
    v_cvt_pk_bf16_f32 v76, v12, v13
    ds_read_b128 a[148:151], v197 offset:50176
    v_mfma_f32_16x16x32_bf16 a[32:35], a[168:171], v[80:83], a[32:35]
    v_exp_f32 v14, v14
    v_mfma_f32_16x16x32_bf16 a[48:51], a[172:175], v[80:83], a[48:51]
    v_exp_f32 v15, v15
    v_mfma_f32_16x16x32_bf16 a[36:39], a[168:171], v[84:87], a[36:39]
    s_waitcnt lgkmcnt(7)
    buffer_load_dwordx4 v209, s[8:11], s34 offen offset:3072 nt lds
    v_mfma_f32_16x16x32_bf16 a[52:55], a[172:175], v[84:87], a[52:55]
    v_cvt_pk_bf16_f32 v77, v14, v15
    v_mfma_f32_16x16x32_bf16 v[116:119], v[252:255], v[84:87], v[116:119]
    ds_read_b64_tr_b16 a[168:169], v202 offset:32768
    v_mfma_f32_16x16x32_bf16 v[32:35], a[136:139], v[136:139], v[32:35]
    v_exp_f32 v16, v16
    v_mfma_f32_16x16x32_bf16 v[48:51], a[152:155], v[136:139], v[48:51]
    v_exp_f32 v17, v17
    v_mfma_f32_16x16x32_bf16 v[36:39], a[136:139], v[152:155], v[36:39]
    ds_read_b64_tr_b16 a[170:171], v202 offset:33792
    s_add_u32 m0, s29, 65536
    v_mfma_f32_16x16x32_bf16 v[52:55], a[152:155], v[152:155], v[52:55]
    v_cvt_pk_bf16_f32 v66, v16, v17
    ds_read_b64_tr_b16 a[172:173], v203 offset:32768
    v_mfma_f32_16x16x32_bf16 v[40:43], a[136:139], v[168:171], v[40:43]
    v_exp_f32 v18, v18
    v_mfma_f32_16x16x32_bf16 v[56:59], a[152:155], v[168:171], v[56:59]
    v_exp_f32 v19, v19
    v_mfma_f32_16x16x32_bf16 v[44:47], a[136:139], v[184:187], v[44:47]
    buffer_load_dwordx4 v210, s[12:15], s75 offen offset:0 nt lds
    v_mfma_f32_16x16x32_bf16 v[60:63], a[152:155], v[184:187], v[60:63]
    v_cvt_pk_bf16_f32 v67, v18, v19
    ds_read_b128 a[136:139], v198 offset:49152
    v_mfma_f32_16x16x32_bf16 a[76:79], a[176:179], v[92:95], a[76:79]
    v_exp_f32 v20, v20
    v_mfma_f32_16x16x32_bf16 a[92:95], a[180:183], v[92:95], a[92:95]
    v_exp_f32 v21, v21
    v_mfma_f32_16x16x32_bf16 a[64:67], a[176:179], v[80:83], a[64:67]
    ds_read_b64_tr_b16 a[174:175], v203 offset:33792
    v_mfma_f32_16x16x32_bf16 a[80:83], a[180:183], v[80:83], a[80:83]
    v_cvt_pk_bf16_f32 v70, v20, v21
    ds_read_b128 a[152:155], v198 offset:50176
    v_mfma_f32_16x16x32_bf16 a[68:71], a[176:179], v[84:87], a[68:71]
    v_exp_f32 v22, v22
    v_mfma_f32_16x16x32_bf16 a[84:87], a[180:183], v[84:87], a[84:87]
    v_exp_f32 v23, v23
    v_mfma_f32_16x16x32_bf16 a[72:75], a[176:179], v[88:91], a[72:75]
    buffer_load_dwordx4 v210, s[12:15], s75 offen offset:1024 nt lds
    v_mfma_f32_16x16x32_bf16 a[88:91], a[180:183], v[88:91], a[88:91]
    v_cvt_pk_bf16_f32 v71, v22, v23
    v_mfma_f32_16x16x32_bf16 v[120:123], v[252:255], v[88:91], v[120:123]
    ds_read_b64_tr_b16 a[176:177], v204 offset:32768
    v_mfma_f32_16x16x32_bf16 v[32:35], a[140:143], v[140:143], v[32:35]
    v_exp_f32 v24, v24
    v_mfma_f32_16x16x32_bf16 v[48:51], a[156:159], v[140:143], v[48:51]
    v_exp_f32 v25, v25
    v_mfma_f32_16x16x32_bf16 v[36:39], a[140:143], v[156:159], v[36:39]
    ds_read_b64_tr_b16 a[178:179], v204 offset:33792
    v_mfma_f32_16x16x32_bf16 v[52:55], a[156:159], v[156:159], v[52:55]
    v_cvt_pk_bf16_f32 v74, v24, v25
    ds_read_b64_tr_b16 a[180:181], v205 offset:32768
    v_mfma_f32_16x16x32_bf16 v[40:43], a[140:143], v[172:175], v[40:43]
    v_exp_f32 v26, v26
    v_mfma_f32_16x16x32_bf16 v[56:59], a[156:159], v[172:175], v[56:59]
    v_exp_f32 v27, v27
    v_mfma_f32_16x16x32_bf16 v[44:47], a[140:143], v[188:191], v[44:47]
    buffer_load_dwordx4 v211, s[12:15], s75 offen offset:2048 nt lds
    v_mfma_f32_16x16x32_bf16 v[60:63], a[156:159], v[188:191], v[60:63]
    v_cvt_pk_bf16_f32 v75, v26, v27
    ds_read_b128 a[140:143], v199 offset:49152
    v_mfma_f32_16x16x32_bf16 a[96:99], a[184:187], v[80:83], a[96:99]
    v_exp_f32 v28, v28
    v_mfma_f32_16x16x32_bf16 a[112:115], a[188:191], v[80:83], a[112:115]
    v_exp_f32 v29, v29
    v_mfma_f32_16x16x32_bf16 a[100:103], a[184:187], v[84:87], a[100:103]
    ds_read_b64_tr_b16 a[182:183], v205 offset:33792
    v_mfma_f32_16x16x32_bf16 a[116:119], a[188:191], v[84:87], a[116:119]
    v_cvt_pk_bf16_f32 v78, v28, v29
    ds_read_b128 a[156:159], v199 offset:50176
    v_mfma_f32_16x16x32_bf16 a[104:107], a[184:187], v[88:91], a[104:107]
    v_exp_f32 v30, v30
    v_mfma_f32_16x16x32_bf16 a[120:123], a[188:191], v[88:91], a[120:123]
    v_exp_f32 v31, v31
    v_mfma_f32_16x16x32_bf16 a[108:111], a[184:187], v[92:95], a[108:111]
    s_waitcnt lgkmcnt(7)
    buffer_load_dwordx4 v211, s[12:15], s75 offen offset:3072 nt lds
    v_mfma_f32_16x16x32_bf16 a[124:127], a[188:191], v[92:95], a[124:127]
    v_cvt_pk_bf16_f32 v79, v30, v31
    v_mfma_f32_16x16x32_bf16 v[124:127], v[252:255], v[92:95], v[124:127]
    ds_read_b64_tr_b16 a[184:185], v206 offset:32768
    v_mfma_f32_16x16x32_bf16 v[0:3], a[128:131], v[128:131], v[96:99]
    v_exp_f32 v32, v32
    v_mfma_f32_16x16x32_bf16 v[16:19], a[144:147], v[128:131], v[96:99]
    v_exp_f32 v33, v33
    v_mfma_f32_16x16x32_bf16 v[4:7], a[128:131], v[144:147], v[100:103]
    ds_read_b64_tr_b16 a[186:187], v206 offset:33792
    v_mfma_f32_16x16x32_bf16 v[20:23], a[144:147], v[144:147], v[100:103]
    v_cvt_pk_bf16_f32 v80, v32, v33
    ds_read_b64_tr_b16 a[188:189], v207 offset:32768
    v_mfma_f32_16x16x32_bf16 v[8:11], a[128:131], v[160:163], v[104:107]
    v_exp_f32 v34, v34
    v_mfma_f32_16x16x32_bf16 v[24:27], a[144:147], v[160:163], v[104:107]
    v_exp_f32 v35, v35
    v_mfma_f32_16x16x32_bf16 v[12:15], a[128:131], v[176:179], v[108:111]
    s_add_u32 s34, s34, 16384
    v_mfma_f32_16x16x32_bf16 v[28:31], a[144:147], v[176:179], v[108:111]
    v_cvt_pk_bf16_f32 v81, v34, v35
    ds_read_b128 a[128:131], v196 offset:57344
    v_mfma_f32_16x16x32_bf16 a[4:7], a[160:163], v[68:71], a[4:7]
    v_exp_f32 v36, v36
    v_mfma_f32_16x16x32_bf16 a[20:23], a[164:167], v[68:71], a[20:23]
    v_exp_f32 v37, v37
    v_mfma_f32_16x16x32_bf16 a[8:11], a[160:163], v[72:75], a[8:11]
    ds_read_b64_tr_b16 a[190:191], v207 offset:33792
    v_mfma_f32_16x16x32_bf16 a[24:27], a[164:167], v[72:75], a[24:27]
    v_cvt_pk_bf16_f32 v84, v36, v37
    ds_read_b128 a[144:147], v196 offset:58368
    v_mfma_f32_16x16x32_bf16 a[12:15], a[160:163], v[76:79], a[12:15]
    v_exp_f32 v38, v38
    v_mfma_f32_16x16x32_bf16 a[28:31], a[164:167], v[76:79], a[28:31]
    v_exp_f32 v39, v39
    v_mfma_f32_16x16x32_bf16 a[0:3], a[160:163], v[64:67], a[0:3]
    s_add_u32 s75, s75, 16384
    v_mfma_f32_16x16x32_bf16 a[16:19], a[164:167], v[64:67], a[16:19]
    v_cvt_pk_bf16_f32 v85, v38, v39
    v_mfma_f32_16x16x32_bf16 v[112:115], v[252:255], v[64:67], v[112:115]
    ds_read_b64_tr_b16 a[160:161], v200 offset:40960
    v_mfma_f32_16x16x32_bf16 v[0:3], a[132:135], v[132:135], v[0:3]
    v_exp_f32 v40, v40
    v_mfma_f32_16x16x32_bf16 v[16:19], a[148:151], v[132:135], v[16:19]
    v_exp_f32 v41, v41
    v_mfma_f32_16x16x32_bf16 v[4:7], a[132:135], v[148:151], v[4:7]
    ds_read_b64_tr_b16 a[162:163], v200 offset:41984
    v_mfma_f32_16x16x32_bf16 v[20:23], a[148:151], v[148:151], v[20:23]
    v_cvt_pk_bf16_f32 v88, v40, v41
    ds_read_b64_tr_b16 a[164:165], v201 offset:40960
    v_mfma_f32_16x16x32_bf16 v[8:11], a[132:135], v[164:167], v[8:11]
    v_exp_f32 v42, v42
    v_mfma_f32_16x16x32_bf16 v[24:27], a[148:151], v[164:167], v[24:27]
    v_exp_f32 v43, v43
    v_mfma_f32_16x16x32_bf16 v[12:15], a[132:135], v[180:183], v[12:15]
    v_mfma_f32_16x16x32_bf16 v[28:31], a[148:151], v[180:183], v[28:31]
    v_cvt_pk_bf16_f32 v89, v42, v43
    ds_read_b128 a[132:135], v197 offset:57344
    v_mfma_f32_16x16x32_bf16 a[40:43], a[168:171], v[72:75], a[40:43]
    v_exp_f32 v44, v44
    v_mfma_f32_16x16x32_bf16 a[56:59], a[172:175], v[72:75], a[56:59]
    v_exp_f32 v45, v45
    v_mfma_f32_16x16x32_bf16 a[44:47], a[168:171], v[76:79], a[44:47]
    ds_read_b64_tr_b16 a[166:167], v201 offset:41984
    v_mfma_f32_16x16x32_bf16 a[60:63], a[172:175], v[76:79], a[60:63]
    v_cvt_pk_bf16_f32 v92, v44, v45
    ds_read_b128 a[148:151], v197 offset:58368
    v_mfma_f32_16x16x32_bf16 a[32:35], a[168:171], v[64:67], a[32:35]
    v_exp_f32 v46, v46
    v_mfma_f32_16x16x32_bf16 a[48:51], a[172:175], v[64:67], a[48:51]
    v_exp_f32 v47, v47
    v_mfma_f32_16x16x32_bf16 a[36:39], a[168:171], v[68:71], a[36:39]
    s_waitcnt lgkmcnt(7)
    v_mfma_f32_16x16x32_bf16 a[52:55], a[172:175], v[68:71], a[52:55]
    v_cvt_pk_bf16_f32 v93, v46, v47
    v_mfma_f32_16x16x32_bf16 v[116:119], v[252:255], v[68:71], v[116:119]
    ds_read_b64_tr_b16 a[168:169], v202 offset:40960
    v_mfma_f32_16x16x32_bf16 v[0:3], a[136:139], v[136:139], v[0:3]
    v_exp_f32 v48, v48
    v_mfma_f32_16x16x32_bf16 v[16:19], a[152:155], v[136:139], v[16:19]
    v_exp_f32 v49, v49
    v_mfma_f32_16x16x32_bf16 v[4:7], a[136:139], v[152:155], v[4:7]
    ds_read_b64_tr_b16 a[170:171], v202 offset:41984
    v_mfma_f32_16x16x32_bf16 v[20:23], a[152:155], v[152:155], v[20:23]
    v_cvt_pk_bf16_f32 v82, v48, v49
    ds_read_b64_tr_b16 a[172:173], v203 offset:40960
    v_mfma_f32_16x16x32_bf16 v[8:11], a[136:139], v[168:171], v[8:11]
    v_exp_f32 v50, v50
    v_mfma_f32_16x16x32_bf16 v[24:27], a[152:155], v[168:171], v[24:27]
    v_exp_f32 v51, v51
    v_mfma_f32_16x16x32_bf16 v[12:15], a[136:139], v[184:187], v[12:15]
    v_mfma_f32_16x16x32_bf16 v[28:31], a[152:155], v[184:187], v[28:31]
    v_cvt_pk_bf16_f32 v83, v50, v51
    ds_read_b128 a[136:139], v198 offset:57344
    v_mfma_f32_16x16x32_bf16 a[76:79], a[176:179], v[76:79], a[76:79]
    v_exp_f32 v52, v52
    v_mfma_f32_16x16x32_bf16 a[92:95], a[180:183], v[76:79], a[92:95]
    v_exp_f32 v53, v53
    v_mfma_f32_16x16x32_bf16 a[64:67], a[176:179], v[64:67], a[64:67]
    ds_read_b64_tr_b16 a[174:175], v203 offset:41984
    v_mfma_f32_16x16x32_bf16 a[80:83], a[180:183], v[64:67], a[80:83]
    v_cvt_pk_bf16_f32 v86, v52, v53
    ds_read_b128 a[152:155], v198 offset:58368
    v_mfma_f32_16x16x32_bf16 a[68:71], a[176:179], v[68:71], a[68:71]
    v_exp_f32 v54, v54
    v_mfma_f32_16x16x32_bf16 a[84:87], a[180:183], v[68:71], a[84:87]
    v_exp_f32 v55, v55
    v_mfma_f32_16x16x32_bf16 a[72:75], a[176:179], v[72:75], a[72:75]
    v_mfma_f32_16x16x32_bf16 a[88:91], a[180:183], v[72:75], a[88:91]
    v_cvt_pk_bf16_f32 v87, v54, v55
    v_mfma_f32_16x16x32_bf16 v[120:123], v[252:255], v[72:75], v[120:123]
    ds_read_b64_tr_b16 a[176:177], v204 offset:40960
    v_mfma_f32_16x16x32_bf16 v[0:3], a[140:143], v[140:143], v[0:3]
    v_exp_f32 v56, v56
    v_mfma_f32_16x16x32_bf16 v[16:19], a[156:159], v[140:143], v[16:19]
    v_exp_f32 v57, v57
    v_mfma_f32_16x16x32_bf16 v[4:7], a[140:143], v[156:159], v[4:7]
    ds_read_b64_tr_b16 a[178:179], v204 offset:41984
    v_mfma_f32_16x16x32_bf16 v[20:23], a[156:159], v[156:159], v[20:23]
    v_cvt_pk_bf16_f32 v90, v56, v57
    ds_read_b64_tr_b16 a[180:181], v205 offset:40960
    v_mfma_f32_16x16x32_bf16 v[8:11], a[140:143], v[172:175], v[8:11]
    v_exp_f32 v58, v58
    v_mfma_f32_16x16x32_bf16 v[24:27], a[156:159], v[172:175], v[24:27]
    v_exp_f32 v59, v59
    v_mfma_f32_16x16x32_bf16 v[12:15], a[140:143], v[188:191], v[12:15]
    v_mfma_f32_16x16x32_bf16 v[28:31], a[156:159], v[188:191], v[28:31]
    v_cvt_pk_bf16_f32 v91, v58, v59
    ds_read_b128 a[140:143], v199 offset:57344
    v_mfma_f32_16x16x32_bf16 a[96:99], a[184:187], v[64:67], a[96:99]
    v_exp_f32 v60, v60
    v_mfma_f32_16x16x32_bf16 a[112:115], a[188:191], v[64:67], a[112:115]
    v_exp_f32 v61, v61
    v_mfma_f32_16x16x32_bf16 a[100:103], a[184:187], v[68:71], a[100:103]
    ds_read_b64_tr_b16 a[182:183], v205 offset:41984
    v_mfma_f32_16x16x32_bf16 a[116:119], a[188:191], v[68:71], a[116:119]
    v_cvt_pk_bf16_f32 v94, v60, v61
    ds_read_b128 a[156:159], v199 offset:58368
    v_mfma_f32_16x16x32_bf16 a[104:107], a[184:187], v[72:75], a[104:107]
    v_exp_f32 v62, v62
    v_mfma_f32_16x16x32_bf16 a[120:123], a[188:191], v[72:75], a[120:123]
    v_exp_f32 v63, v63
    v_mfma_f32_16x16x32_bf16 a[108:111], a[184:187], v[76:79], a[108:111]
    s_waitcnt lgkmcnt(7)
    v_mfma_f32_16x16x32_bf16 a[124:127], a[188:191], v[76:79], a[124:127]
    v_cvt_pk_bf16_f32 v95, v62, v63
    v_mfma_f32_16x16x32_bf16 v[124:127], v[252:255], v[76:79], v[124:127]
    ds_read_b64_tr_b16 a[184:185], v206 offset:40960
    s_waitcnt vmcnt(8)
    s_barrier
    v_mfma_f32_16x16x32_bf16 v[32:35], a[128:131], v[128:131], v[96:99]
    v_exp_f32 v0, v0
    v_mfma_f32_16x16x32_bf16 v[48:51], a[144:147], v[128:131], v[96:99]
    v_exp_f32 v1, v1
    v_mfma_f32_16x16x32_bf16 v[36:39], a[128:131], v[144:147], v[100:103]
    ds_read_b64_tr_b16 a[186:187], v206 offset:41984
    s_add_u32 m0, s29, 32768
    v_mfma_f32_16x16x32_bf16 v[52:55], a[144:147], v[144:147], v[100:103]
    v_cvt_pk_bf16_f32 v64, v0, v1
    ds_read_b64_tr_b16 a[188:189], v207 offset:40960
    v_mfma_f32_16x16x32_bf16 v[40:43], a[128:131], v[160:163], v[104:107]
    v_exp_f32 v2, v2
    v_mfma_f32_16x16x32_bf16 v[56:59], a[144:147], v[160:163], v[104:107]
    v_exp_f32 v3, v3
    v_mfma_f32_16x16x32_bf16 v[44:47], a[128:131], v[176:179], v[108:111]
    buffer_load_dwordx4 v208, s[8:11], s34 offen offset:0 nt lds
    v_mfma_f32_16x16x32_bf16 v[60:63], a[144:147], v[176:179], v[108:111]
    v_cvt_pk_bf16_f32 v65, v2, v3
    ds_read_b128 a[128:131], v196 offset:0
    v_mfma_f32_16x16x32_bf16 a[4:7], a[160:163], v[84:87], a[4:7]
    v_exp_f32 v4, v4
    v_mfma_f32_16x16x32_bf16 a[20:23], a[164:167], v[84:87], a[20:23]
    v_exp_f32 v5, v5
    v_mfma_f32_16x16x32_bf16 a[8:11], a[160:163], v[88:91], a[8:11]
    ds_read_b64_tr_b16 a[190:191], v207 offset:41984
    v_mfma_f32_16x16x32_bf16 a[24:27], a[164:167], v[88:91], a[24:27]
    v_cvt_pk_bf16_f32 v68, v4, v5
    ds_read_b128 a[144:147], v196 offset:1024
    v_mfma_f32_16x16x32_bf16 a[12:15], a[160:163], v[92:95], a[12:15]
    v_exp_f32 v6, v6
    v_mfma_f32_16x16x32_bf16 a[28:31], a[164:167], v[92:95], a[28:31]
    v_exp_f32 v7, v7
    v_mfma_f32_16x16x32_bf16 a[0:3], a[160:163], v[80:83], a[0:3]
    buffer_load_dwordx4 v208, s[8:11], s34 offen offset:1024 nt lds
    v_mfma_f32_16x16x32_bf16 a[16:19], a[164:167], v[80:83], a[16:19]
    v_cvt_pk_bf16_f32 v69, v6, v7
    v_mfma_f32_16x16x32_bf16 v[112:115], v[252:255], v[80:83], v[112:115]
    ds_read_b64_tr_b16 a[160:161], v200 offset:49152
    v_mfma_f32_16x16x32_bf16 v[32:35], a[132:135], v[132:135], v[32:35]
    v_exp_f32 v8, v8
    v_mfma_f32_16x16x32_bf16 v[48:51], a[148:151], v[132:135], v[48:51]
    v_exp_f32 v9, v9
    v_mfma_f32_16x16x32_bf16 v[36:39], a[132:135], v[148:151], v[36:39]
    ds_read_b64_tr_b16 a[162:163], v200 offset:50176
    v_mfma_f32_16x16x32_bf16 v[52:55], a[148:151], v[148:151], v[52:55]
    v_cvt_pk_bf16_f32 v72, v8, v9
    ds_read_b64_tr_b16 a[164:165], v201 offset:49152
    v_mfma_f32_16x16x32_bf16 v[40:43], a[132:135], v[164:167], v[40:43]
    v_exp_f32 v10, v10
    v_mfma_f32_16x16x32_bf16 v[56:59], a[148:151], v[164:167], v[56:59]
    v_exp_f32 v11, v11
    v_mfma_f32_16x16x32_bf16 v[44:47], a[132:135], v[180:183], v[44:47]
    buffer_load_dwordx4 v209, s[8:11], s34 offen offset:2048 nt lds
    v_mfma_f32_16x16x32_bf16 v[60:63], a[148:151], v[180:183], v[60:63]
    v_cvt_pk_bf16_f32 v73, v10, v11
    ds_read_b128 a[132:135], v197 offset:0
    v_mfma_f32_16x16x32_bf16 a[40:43], a[168:171], v[88:91], a[40:43]
    v_exp_f32 v12, v12
    v_mfma_f32_16x16x32_bf16 a[56:59], a[172:175], v[88:91], a[56:59]
    v_exp_f32 v13, v13
    v_mfma_f32_16x16x32_bf16 a[44:47], a[168:171], v[92:95], a[44:47]
    ds_read_b64_tr_b16 a[166:167], v201 offset:50176
    v_mfma_f32_16x16x32_bf16 a[60:63], a[172:175], v[92:95], a[60:63]
    v_cvt_pk_bf16_f32 v76, v12, v13
    ds_read_b128 a[148:151], v197 offset:1024
    v_mfma_f32_16x16x32_bf16 a[32:35], a[168:171], v[80:83], a[32:35]
    v_exp_f32 v14, v14
    v_mfma_f32_16x16x32_bf16 a[48:51], a[172:175], v[80:83], a[48:51]
    v_exp_f32 v15, v15
    v_mfma_f32_16x16x32_bf16 a[36:39], a[168:171], v[84:87], a[36:39]
    s_waitcnt lgkmcnt(7)
    buffer_load_dwordx4 v209, s[8:11], s34 offen offset:3072 nt lds
    v_mfma_f32_16x16x32_bf16 a[52:55], a[172:175], v[84:87], a[52:55]
    v_cvt_pk_bf16_f32 v77, v14, v15
    v_mfma_f32_16x16x32_bf16 v[116:119], v[252:255], v[84:87], v[116:119]
    ds_read_b64_tr_b16 a[168:169], v202 offset:49152
    v_mfma_f32_16x16x32_bf16 v[32:35], a[136:139], v[136:139], v[32:35]
    v_exp_f32 v16, v16
    v_mfma_f32_16x16x32_bf16 v[48:51], a[152:155], v[136:139], v[48:51]
    v_exp_f32 v17, v17
    v_mfma_f32_16x16x32_bf16 v[36:39], a[136:139], v[152:155], v[36:39]
    ds_read_b64_tr_b16 a[170:171], v202 offset:50176
    s_add_u32 m0, s29, 81920
    v_mfma_f32_16x16x32_bf16 v[52:55], a[152:155], v[152:155], v[52:55]
    v_cvt_pk_bf16_f32 v66, v16, v17
    ds_read_b64_tr_b16 a[172:173], v203 offset:49152
    v_mfma_f32_16x16x32_bf16 v[40:43], a[136:139], v[168:171], v[40:43]
    v_exp_f32 v18, v18
    v_mfma_f32_16x16x32_bf16 v[56:59], a[152:155], v[168:171], v[56:59]
    v_exp_f32 v19, v19
    v_mfma_f32_16x16x32_bf16 v[44:47], a[136:139], v[184:187], v[44:47]
    buffer_load_dwordx4 v210, s[12:15], s75 offen offset:0 nt lds
    v_mfma_f32_16x16x32_bf16 v[60:63], a[152:155], v[184:187], v[60:63]
    v_cvt_pk_bf16_f32 v67, v18, v19
    ds_read_b128 a[136:139], v198 offset:0
    v_mfma_f32_16x16x32_bf16 a[76:79], a[176:179], v[92:95], a[76:79]
    v_exp_f32 v20, v20
    v_mfma_f32_16x16x32_bf16 a[92:95], a[180:183], v[92:95], a[92:95]
    v_exp_f32 v21, v21
    v_mfma_f32_16x16x32_bf16 a[64:67], a[176:179], v[80:83], a[64:67]
    ds_read_b64_tr_b16 a[174:175], v203 offset:50176
    v_mfma_f32_16x16x32_bf16 a[80:83], a[180:183], v[80:83], a[80:83]
    v_cvt_pk_bf16_f32 v70, v20, v21
    ds_read_b128 a[152:155], v198 offset:1024
    v_mfma_f32_16x16x32_bf16 a[68:71], a[176:179], v[84:87], a[68:71]
    v_exp_f32 v22, v22
    v_mfma_f32_16x16x32_bf16 a[84:87], a[180:183], v[84:87], a[84:87]
    v_exp_f32 v23, v23
    v_mfma_f32_16x16x32_bf16 a[72:75], a[176:179], v[88:91], a[72:75]
    buffer_load_dwordx4 v210, s[12:15], s75 offen offset:1024 nt lds
    v_mfma_f32_16x16x32_bf16 a[88:91], a[180:183], v[88:91], a[88:91]
    v_cvt_pk_bf16_f32 v71, v22, v23
    v_mfma_f32_16x16x32_bf16 v[120:123], v[252:255], v[88:91], v[120:123]
    ds_read_b64_tr_b16 a[176:177], v204 offset:49152
    v_mfma_f32_16x16x32_bf16 v[32:35], a[140:143], v[140:143], v[32:35]
    v_exp_f32 v24, v24
    v_mfma_f32_16x16x32_bf16 v[48:51], a[156:159], v[140:143], v[48:51]
    v_exp_f32 v25, v25
    v_mfma_f32_16x16x32_bf16 v[36:39], a[140:143], v[156:159], v[36:39]
    ds_read_b64_tr_b16 a[178:179], v204 offset:50176
    v_mfma_f32_16x16x32_bf16 v[52:55], a[156:159], v[156:159], v[52:55]
    v_cvt_pk_bf16_f32 v74, v24, v25
    ds_read_b64_tr_b16 a[180:181], v205 offset:49152
    v_mfma_f32_16x16x32_bf16 v[40:43], a[140:143], v[172:175], v[40:43]
    v_exp_f32 v26, v26
    v_mfma_f32_16x16x32_bf16 v[56:59], a[156:159], v[172:175], v[56:59]
    v_exp_f32 v27, v27
    v_mfma_f32_16x16x32_bf16 v[44:47], a[140:143], v[188:191], v[44:47]
    buffer_load_dwordx4 v211, s[12:15], s75 offen offset:2048 nt lds
    v_mfma_f32_16x16x32_bf16 v[60:63], a[156:159], v[188:191], v[60:63]
    v_cvt_pk_bf16_f32 v75, v26, v27
    ds_read_b128 a[140:143], v199 offset:0
    v_mfma_f32_16x16x32_bf16 a[96:99], a[184:187], v[80:83], a[96:99]
    v_exp_f32 v28, v28
    v_mfma_f32_16x16x32_bf16 a[112:115], a[188:191], v[80:83], a[112:115]
    v_exp_f32 v29, v29
    v_mfma_f32_16x16x32_bf16 a[100:103], a[184:187], v[84:87], a[100:103]
    ds_read_b64_tr_b16 a[182:183], v205 offset:50176
    v_mfma_f32_16x16x32_bf16 a[116:119], a[188:191], v[84:87], a[116:119]
    v_cvt_pk_bf16_f32 v78, v28, v29
    ds_read_b128 a[156:159], v199 offset:1024
    v_mfma_f32_16x16x32_bf16 a[104:107], a[184:187], v[88:91], a[104:107]
    v_exp_f32 v30, v30
    v_mfma_f32_16x16x32_bf16 a[120:123], a[188:191], v[88:91], a[120:123]
    v_exp_f32 v31, v31
    v_mfma_f32_16x16x32_bf16 a[108:111], a[184:187], v[92:95], a[108:111]
    s_waitcnt lgkmcnt(7)
    buffer_load_dwordx4 v211, s[12:15], s75 offen offset:3072 nt lds
    v_mfma_f32_16x16x32_bf16 a[124:127], a[188:191], v[92:95], a[124:127]
    v_cvt_pk_bf16_f32 v79, v30, v31
    v_mfma_f32_16x16x32_bf16 v[124:127], v[252:255], v[92:95], v[124:127]
    ds_read_b64_tr_b16 a[184:185], v206 offset:49152
    v_mfma_f32_16x16x32_bf16 v[0:3], a[128:131], v[128:131], v[96:99]
    v_exp_f32 v32, v32
    v_mfma_f32_16x16x32_bf16 v[16:19], a[144:147], v[128:131], v[96:99]
    v_exp_f32 v33, v33
    v_mfma_f32_16x16x32_bf16 v[4:7], a[128:131], v[144:147], v[100:103]
    ds_read_b64_tr_b16 a[186:187], v206 offset:50176
    v_mfma_f32_16x16x32_bf16 v[20:23], a[144:147], v[144:147], v[100:103]
    v_cvt_pk_bf16_f32 v80, v32, v33
    ds_read_b64_tr_b16 a[188:189], v207 offset:49152
    v_mfma_f32_16x16x32_bf16 v[8:11], a[128:131], v[160:163], v[104:107]
    v_exp_f32 v34, v34
    v_mfma_f32_16x16x32_bf16 v[24:27], a[144:147], v[160:163], v[104:107]
    v_exp_f32 v35, v35
    v_mfma_f32_16x16x32_bf16 v[12:15], a[128:131], v[176:179], v[108:111]
    s_add_u32 s34, s34, 16384
    v_mfma_f32_16x16x32_bf16 v[28:31], a[144:147], v[176:179], v[108:111]
    v_cvt_pk_bf16_f32 v81, v34, v35
    ds_read_b128 a[128:131], v196 offset:8192
    v_mfma_f32_16x16x32_bf16 a[4:7], a[160:163], v[68:71], a[4:7]
    v_exp_f32 v36, v36
    v_mfma_f32_16x16x32_bf16 a[20:23], a[164:167], v[68:71], a[20:23]
    v_exp_f32 v37, v37
    v_mfma_f32_16x16x32_bf16 a[8:11], a[160:163], v[72:75], a[8:11]
    ds_read_b64_tr_b16 a[190:191], v207 offset:50176
    v_mfma_f32_16x16x32_bf16 a[24:27], a[164:167], v[72:75], a[24:27]
    v_cvt_pk_bf16_f32 v84, v36, v37
    ds_read_b128 a[144:147], v196 offset:9216
    v_mfma_f32_16x16x32_bf16 a[12:15], a[160:163], v[76:79], a[12:15]
    v_exp_f32 v38, v38
    v_mfma_f32_16x16x32_bf16 a[28:31], a[164:167], v[76:79], a[28:31]
    v_exp_f32 v39, v39
    v_mfma_f32_16x16x32_bf16 a[0:3], a[160:163], v[64:67], a[0:3]
    s_add_u32 s75, s75, 16384
    v_mfma_f32_16x16x32_bf16 a[16:19], a[164:167], v[64:67], a[16:19]
    v_cvt_pk_bf16_f32 v85, v38, v39
    v_mfma_f32_16x16x32_bf16 v[112:115], v[252:255], v[64:67], v[112:115]
    ds_read_b64_tr_b16 a[160:161], v200 offset:57344
    v_mfma_f32_16x16x32_bf16 v[0:3], a[132:135], v[132:135], v[0:3]
    v_exp_f32 v40, v40
    v_mfma_f32_16x16x32_bf16 v[16:19], a[148:151], v[132:135], v[16:19]
    v_exp_f32 v41, v41
    v_mfma_f32_16x16x32_bf16 v[4:7], a[132:135], v[148:151], v[4:7]
    ds_read_b64_tr_b16 a[162:163], v200 offset:58368
    v_mfma_f32_16x16x32_bf16 v[20:23], a[148:151], v[148:151], v[20:23]
    v_cvt_pk_bf16_f32 v88, v40, v41
    ds_read_b64_tr_b16 a[164:165], v201 offset:57344
    v_mfma_f32_16x16x32_bf16 v[8:11], a[132:135], v[164:167], v[8:11]
    v_exp_f32 v42, v42
    v_mfma_f32_16x16x32_bf16 v[24:27], a[148:151], v[164:167], v[24:27]
    v_exp_f32 v43, v43
    v_mfma_f32_16x16x32_bf16 v[12:15], a[132:135], v[180:183], v[12:15]
    v_mfma_f32_16x16x32_bf16 v[28:31], a[148:151], v[180:183], v[28:31]
    v_cvt_pk_bf16_f32 v89, v42, v43
    ds_read_b128 a[132:135], v197 offset:8192
    v_mfma_f32_16x16x32_bf16 a[40:43], a[168:171], v[72:75], a[40:43]
    v_exp_f32 v44, v44
    v_mfma_f32_16x16x32_bf16 a[56:59], a[172:175], v[72:75], a[56:59]
    v_exp_f32 v45, v45
    v_mfma_f32_16x16x32_bf16 a[44:47], a[168:171], v[76:79], a[44:47]
    ds_read_b64_tr_b16 a[166:167], v201 offset:58368
    v_mfma_f32_16x16x32_bf16 a[60:63], a[172:175], v[76:79], a[60:63]
    v_cvt_pk_bf16_f32 v92, v44, v45
    ds_read_b128 a[148:151], v197 offset:9216
    v_mfma_f32_16x16x32_bf16 a[32:35], a[168:171], v[64:67], a[32:35]
    v_exp_f32 v46, v46
    v_mfma_f32_16x16x32_bf16 a[48:51], a[172:175], v[64:67], a[48:51]
    v_exp_f32 v47, v47
    v_mfma_f32_16x16x32_bf16 a[36:39], a[168:171], v[68:71], a[36:39]
    s_waitcnt lgkmcnt(7)
    v_mfma_f32_16x16x32_bf16 a[52:55], a[172:175], v[68:71], a[52:55]
    v_cvt_pk_bf16_f32 v93, v46, v47
    v_mfma_f32_16x16x32_bf16 v[116:119], v[252:255], v[68:71], v[116:119]
    ds_read_b64_tr_b16 a[168:169], v202 offset:57344
    v_mfma_f32_16x16x32_bf16 v[0:3], a[136:139], v[136:139], v[0:3]
    v_exp_f32 v48, v48
    v_mfma_f32_16x16x32_bf16 v[16:19], a[152:155], v[136:139], v[16:19]
    v_exp_f32 v49, v49
    v_mfma_f32_16x16x32_bf16 v[4:7], a[136:139], v[152:155], v[4:7]
    ds_read_b64_tr_b16 a[170:171], v202 offset:58368
    v_mfma_f32_16x16x32_bf16 v[20:23], a[152:155], v[152:155], v[20:23]
    v_cvt_pk_bf16_f32 v82, v48, v49
    ds_read_b64_tr_b16 a[172:173], v203 offset:57344
    v_mfma_f32_16x16x32_bf16 v[8:11], a[136:139], v[168:171], v[8:11]
    v_exp_f32 v50, v50
    v_mfma_f32_16x16x32_bf16 v[24:27], a[152:155], v[168:171], v[24:27]
    v_exp_f32 v51, v51
    v_mfma_f32_16x16x32_bf16 v[12:15], a[136:139], v[184:187], v[12:15]
    v_mfma_f32_16x16x32_bf16 v[28:31], a[152:155], v[184:187], v[28:31]
    v_cvt_pk_bf16_f32 v83, v50, v51
    ds_read_b128 a[136:139], v198 offset:8192
    v_mfma_f32_16x16x32_bf16 a[76:79], a[176:179], v[76:79], a[76:79]
    v_exp_f32 v52, v52
    v_mfma_f32_16x16x32_bf16 a[92:95], a[180:183], v[76:79], a[92:95]
    v_exp_f32 v53, v53
    v_mfma_f32_16x16x32_bf16 a[64:67], a[176:179], v[64:67], a[64:67]
    ds_read_b64_tr_b16 a[174:175], v203 offset:58368
    v_mfma_f32_16x16x32_bf16 a[80:83], a[180:183], v[64:67], a[80:83]
    v_cvt_pk_bf16_f32 v86, v52, v53
    ds_read_b128 a[152:155], v198 offset:9216
    v_mfma_f32_16x16x32_bf16 a[68:71], a[176:179], v[68:71], a[68:71]
    v_exp_f32 v54, v54
    v_mfma_f32_16x16x32_bf16 a[84:87], a[180:183], v[68:71], a[84:87]
    v_exp_f32 v55, v55
    v_mfma_f32_16x16x32_bf16 a[72:75], a[176:179], v[72:75], a[72:75]
    v_mfma_f32_16x16x32_bf16 a[88:91], a[180:183], v[72:75], a[88:91]
    v_cvt_pk_bf16_f32 v87, v54, v55
    v_mfma_f32_16x16x32_bf16 v[120:123], v[252:255], v[72:75], v[120:123]
    ds_read_b64_tr_b16 a[176:177], v204 offset:57344
    v_mfma_f32_16x16x32_bf16 v[0:3], a[140:143], v[140:143], v[0:3]
    v_exp_f32 v56, v56
    v_mfma_f32_16x16x32_bf16 v[16:19], a[156:159], v[140:143], v[16:19]
    v_exp_f32 v57, v57
    v_mfma_f32_16x16x32_bf16 v[4:7], a[140:143], v[156:159], v[4:7]
    ds_read_b64_tr_b16 a[178:179], v204 offset:58368
    v_mfma_f32_16x16x32_bf16 v[20:23], a[156:159], v[156:159], v[20:23]
    v_cvt_pk_bf16_f32 v90, v56, v57
    ds_read_b64_tr_b16 a[180:181], v205 offset:57344
    v_mfma_f32_16x16x32_bf16 v[8:11], a[140:143], v[172:175], v[8:11]
    v_exp_f32 v58, v58
    v_mfma_f32_16x16x32_bf16 v[24:27], a[156:159], v[172:175], v[24:27]
    v_exp_f32 v59, v59
    v_mfma_f32_16x16x32_bf16 v[12:15], a[140:143], v[188:191], v[12:15]
    v_mfma_f32_16x16x32_bf16 v[28:31], a[156:159], v[188:191], v[28:31]
    v_cvt_pk_bf16_f32 v91, v58, v59
    ds_read_b128 a[140:143], v199 offset:8192
    v_mfma_f32_16x16x32_bf16 a[96:99], a[184:187], v[64:67], a[96:99]
    v_exp_f32 v60, v60
    v_mfma_f32_16x16x32_bf16 a[112:115], a[188:191], v[64:67], a[112:115]
    v_exp_f32 v61, v61
    v_mfma_f32_16x16x32_bf16 a[100:103], a[184:187], v[68:71], a[100:103]
    ds_read_b64_tr_b16 a[182:183], v205 offset:58368
    v_mfma_f32_16x16x32_bf16 a[116:119], a[188:191], v[68:71], a[116:119]
    v_cvt_pk_bf16_f32 v94, v60, v61
    ds_read_b128 a[156:159], v199 offset:9216
    v_mfma_f32_16x16x32_bf16 a[104:107], a[184:187], v[72:75], a[104:107]
    v_exp_f32 v62, v62
    v_mfma_f32_16x16x32_bf16 a[120:123], a[188:191], v[72:75], a[120:123]
    v_exp_f32 v63, v63
    v_mfma_f32_16x16x32_bf16 a[108:111], a[184:187], v[76:79], a[108:111]
    s_waitcnt lgkmcnt(7)
    v_mfma_f32_16x16x32_bf16 a[124:127], a[188:191], v[76:79], a[124:127]
    v_cvt_pk_bf16_f32 v95, v62, v63
    v_mfma_f32_16x16x32_bf16 v[124:127], v[252:255], v[76:79], v[124:127]
    ds_read_b64_tr_b16 a[184:185], v206 offset:57344
    s_waitcnt vmcnt(8)
    s_barrier
    v_mfma_f32_16x16x32_bf16 v[32:35], a[128:131], v[128:131], v[96:99]
    v_exp_f32 v0, v0
    v_mfma_f32_16x16x32_bf16 v[48:51], a[144:147], v[128:131], v[96:99]
    v_exp_f32 v1, v1
    v_mfma_f32_16x16x32_bf16 v[36:39], a[128:131], v[144:147], v[100:103]
    ds_read_b64_tr_b16 a[186:187], v206 offset:58368
    s_add_u32 m0, s29, 49152
    v_mfma_f32_16x16x32_bf16 v[52:55], a[144:147], v[144:147], v[100:103]
    v_cvt_pk_bf16_f32 v64, v0, v1
    ds_read_b64_tr_b16 a[188:189], v207 offset:57344
    v_mfma_f32_16x16x32_bf16 v[40:43], a[128:131], v[160:163], v[104:107]
    v_exp_f32 v2, v2
    v_mfma_f32_16x16x32_bf16 v[56:59], a[144:147], v[160:163], v[104:107]
    v_exp_f32 v3, v3
    v_mfma_f32_16x16x32_bf16 v[44:47], a[128:131], v[176:179], v[108:111]
    buffer_load_dwordx4 v208, s[8:11], s34 offen offset:0 nt lds
    v_mfma_f32_16x16x32_bf16 v[60:63], a[144:147], v[176:179], v[108:111]
    v_cvt_pk_bf16_f32 v65, v2, v3
    ds_read_b128 a[128:131], v196 offset:16384
    v_mfma_f32_16x16x32_bf16 a[4:7], a[160:163], v[84:87], a[4:7]
    v_exp_f32 v4, v4
    v_mfma_f32_16x16x32_bf16 a[20:23], a[164:167], v[84:87], a[20:23]
    v_exp_f32 v5, v5
    v_mfma_f32_16x16x32_bf16 a[8:11], a[160:163], v[88:91], a[8:11]
    ds_read_b64_tr_b16 a[190:191], v207 offset:58368
    v_mfma_f32_16x16x32_bf16 a[24:27], a[164:167], v[88:91], a[24:27]
    v_cvt_pk_bf16_f32 v68, v4, v5
    ds_read_b128 a[144:147], v196 offset:17408
    v_mfma_f32_16x16x32_bf16 a[12:15], a[160:163], v[92:95], a[12:15]
    v_exp_f32 v6, v6
    v_mfma_f32_16x16x32_bf16 a[28:31], a[164:167], v[92:95], a[28:31]
    v_exp_f32 v7, v7
    v_mfma_f32_16x16x32_bf16 a[0:3], a[160:163], v[80:83], a[0:3]
    buffer_load_dwordx4 v208, s[8:11], s34 offen offset:1024 nt lds
    v_mfma_f32_16x16x32_bf16 a[16:19], a[164:167], v[80:83], a[16:19]
    v_cvt_pk_bf16_f32 v69, v6, v7
    v_mfma_f32_16x16x32_bf16 v[112:115], v[252:255], v[80:83], v[112:115]
    ds_read_b64_tr_b16 a[160:161], v200 offset:0
    v_mfma_f32_16x16x32_bf16 v[32:35], a[132:135], v[132:135], v[32:35]
    v_exp_f32 v8, v8
    v_mfma_f32_16x16x32_bf16 v[48:51], a[148:151], v[132:135], v[48:51]
    v_exp_f32 v9, v9
    v_mfma_f32_16x16x32_bf16 v[36:39], a[132:135], v[148:151], v[36:39]
    ds_read_b64_tr_b16 a[162:163], v200 offset:1024
    v_mfma_f32_16x16x32_bf16 v[52:55], a[148:151], v[148:151], v[52:55]
    v_cvt_pk_bf16_f32 v72, v8, v9
    ds_read_b64_tr_b16 a[164:165], v201 offset:0
    v_mfma_f32_16x16x32_bf16 v[40:43], a[132:135], v[164:167], v[40:43]
    v_exp_f32 v10, v10
    v_mfma_f32_16x16x32_bf16 v[56:59], a[148:151], v[164:167], v[56:59]
    v_exp_f32 v11, v11
    v_mfma_f32_16x16x32_bf16 v[44:47], a[132:135], v[180:183], v[44:47]
    buffer_load_dwordx4 v209, s[8:11], s34 offen offset:2048 nt lds
    v_mfma_f32_16x16x32_bf16 v[60:63], a[148:151], v[180:183], v[60:63]
    v_cvt_pk_bf16_f32 v73, v10, v11
    ds_read_b128 a[132:135], v197 offset:16384
    v_mfma_f32_16x16x32_bf16 a[40:43], a[168:171], v[88:91], a[40:43]
    v_exp_f32 v12, v12
    v_mfma_f32_16x16x32_bf16 a[56:59], a[172:175], v[88:91], a[56:59]
    v_exp_f32 v13, v13
    v_mfma_f32_16x16x32_bf16 a[44:47], a[168:171], v[92:95], a[44:47]
    ds_read_b64_tr_b16 a[166:167], v201 offset:1024
    v_mfma_f32_16x16x32_bf16 a[60:63], a[172:175], v[92:95], a[60:63]
    v_cvt_pk_bf16_f32 v76, v12, v13
    ds_read_b128 a[148:151], v197 offset:17408
    v_mfma_f32_16x16x32_bf16 a[32:35], a[168:171], v[80:83], a[32:35]
    v_exp_f32 v14, v14
    v_mfma_f32_16x16x32_bf16 a[48:51], a[172:175], v[80:83], a[48:51]
    v_exp_f32 v15, v15
    v_mfma_f32_16x16x32_bf16 a[36:39], a[168:171], v[84:87], a[36:39]
    s_waitcnt lgkmcnt(7)
    buffer_load_dwordx4 v209, s[8:11], s34 offen offset:3072 nt lds
    v_mfma_f32_16x16x32_bf16 a[52:55], a[172:175], v[84:87], a[52:55]
    v_cvt_pk_bf16_f32 v77, v14, v15
    v_mfma_f32_16x16x32_bf16 v[116:119], v[252:255], v[84:87], v[116:119]
    ds_read_b64_tr_b16 a[168:169], v202 offset:0
    v_mfma_f32_16x16x32_bf16 v[32:35], a[136:139], v[136:139], v[32:35]
    v_exp_f32 v16, v16
    v_mfma_f32_16x16x32_bf16 v[48:51], a[152:155], v[136:139], v[48:51]
    v_exp_f32 v17, v17
    v_mfma_f32_16x16x32_bf16 v[36:39], a[136:139], v[152:155], v[36:39]
    ds_read_b64_tr_b16 a[170:171], v202 offset:1024
    s_add_u32 m0, s29, 98304
    v_mfma_f32_16x16x32_bf16 v[52:55], a[152:155], v[152:155], v[52:55]
    v_cvt_pk_bf16_f32 v66, v16, v17
    ds_read_b64_tr_b16 a[172:173], v203 offset:0
    v_mfma_f32_16x16x32_bf16 v[40:43], a[136:139], v[168:171], v[40:43]
    v_exp_f32 v18, v18
    v_mfma_f32_16x16x32_bf16 v[56:59], a[152:155], v[168:171], v[56:59]
    v_exp_f32 v19, v19
    v_mfma_f32_16x16x32_bf16 v[44:47], a[136:139], v[184:187], v[44:47]
    buffer_load_dwordx4 v210, s[12:15], s75 offen offset:0 nt lds
    v_mfma_f32_16x16x32_bf16 v[60:63], a[152:155], v[184:187], v[60:63]
    v_cvt_pk_bf16_f32 v67, v18, v19
    ds_read_b128 a[136:139], v198 offset:16384
    v_mfma_f32_16x16x32_bf16 a[76:79], a[176:179], v[92:95], a[76:79]
    v_exp_f32 v20, v20
    v_mfma_f32_16x16x32_bf16 a[92:95], a[180:183], v[92:95], a[92:95]
    v_exp_f32 v21, v21
    v_mfma_f32_16x16x32_bf16 a[64:67], a[176:179], v[80:83], a[64:67]
    ds_read_b64_tr_b16 a[174:175], v203 offset:1024
    v_mfma_f32_16x16x32_bf16 a[80:83], a[180:183], v[80:83], a[80:83]
    v_cvt_pk_bf16_f32 v70, v20, v21
    ds_read_b128 a[152:155], v198 offset:17408
    v_mfma_f32_16x16x32_bf16 a[68:71], a[176:179], v[84:87], a[68:71]
    v_exp_f32 v22, v22
    v_mfma_f32_16x16x32_bf16 a[84:87], a[180:183], v[84:87], a[84:87]
    v_exp_f32 v23, v23
    v_mfma_f32_16x16x32_bf16 a[72:75], a[176:179], v[88:91], a[72:75]
    buffer_load_dwordx4 v210, s[12:15], s75 offen offset:1024 nt lds
    v_mfma_f32_16x16x32_bf16 a[88:91], a[180:183], v[88:91], a[88:91]
    v_cvt_pk_bf16_f32 v71, v22, v23
    v_mfma_f32_16x16x32_bf16 v[120:123], v[252:255], v[88:91], v[120:123]
    ds_read_b64_tr_b16 a[176:177], v204 offset:0
    v_mfma_f32_16x16x32_bf16 v[32:35], a[140:143], v[140:143], v[32:35]
    v_exp_f32 v24, v24
    v_mfma_f32_16x16x32_bf16 v[48:51], a[156:159], v[140:143], v[48:51]
    v_exp_f32 v25, v25
    v_mfma_f32_16x16x32_bf16 v[36:39], a[140:143], v[156:159], v[36:39]
    ds_read_b64_tr_b16 a[178:179], v204 offset:1024
    v_mfma_f32_16x16x32_bf16 v[52:55], a[156:159], v[156:159], v[52:55]
    v_cvt_pk_bf16_f32 v74, v24, v25
    ds_read_b64_tr_b16 a[180:181], v205 offset:0
    v_mfma_f32_16x16x32_bf16 v[40:43], a[140:143], v[172:175], v[40:43]
    v_exp_f32 v26, v26
    v_mfma_f32_16x16x32_bf16 v[56:59], a[156:159], v[172:175], v[56:59]
    v_exp_f32 v27, v27
    v_mfma_f32_16x16x32_bf16 v[44:47], a[140:143], v[188:191], v[44:47]
    buffer_load_dwordx4 v211, s[12:15], s75 offen offset:2048 nt lds
    v_mfma_f32_16x16x32_bf16 v[60:63], a[156:159], v[188:191], v[60:63]
    v_cvt_pk_bf16_f32 v75, v26, v27
    ds_read_b128 a[140:143], v199 offset:16384
    v_mfma_f32_16x16x32_bf16 a[96:99], a[184:187], v[80:83], a[96:99]
    v_exp_f32 v28, v28
    v_mfma_f32_16x16x32_bf16 a[112:115], a[188:191], v[80:83], a[112:115]
    v_exp_f32 v29, v29
    v_mfma_f32_16x16x32_bf16 a[100:103], a[184:187], v[84:87], a[100:103]
    ds_read_b64_tr_b16 a[182:183], v205 offset:1024
    v_mfma_f32_16x16x32_bf16 a[116:119], a[188:191], v[84:87], a[116:119]
    v_cvt_pk_bf16_f32 v78, v28, v29
    ds_read_b128 a[156:159], v199 offset:17408
    v_mfma_f32_16x16x32_bf16 a[104:107], a[184:187], v[88:91], a[104:107]
    v_exp_f32 v30, v30
    v_mfma_f32_16x16x32_bf16 a[120:123], a[188:191], v[88:91], a[120:123]
    v_exp_f32 v31, v31
    v_mfma_f32_16x16x32_bf16 a[108:111], a[184:187], v[92:95], a[108:111]
    s_waitcnt lgkmcnt(7)
    buffer_load_dwordx4 v211, s[12:15], s75 offen offset:3072 nt lds
    v_mfma_f32_16x16x32_bf16 a[124:127], a[188:191], v[92:95], a[124:127]
    v_cvt_pk_bf16_f32 v79, v30, v31
    v_mfma_f32_16x16x32_bf16 v[124:127], v[252:255], v[92:95], v[124:127]
    ds_read_b64_tr_b16 a[184:185], v206 offset:0
    v_mfma_f32_16x16x32_bf16 v[0:3], a[128:131], v[128:131], v[96:99]
    v_exp_f32 v32, v32
    v_mfma_f32_16x16x32_bf16 v[16:19], a[144:147], v[128:131], v[96:99]
    v_exp_f32 v33, v33
    v_mfma_f32_16x16x32_bf16 v[4:7], a[128:131], v[144:147], v[100:103]
    ds_read_b64_tr_b16 a[186:187], v206 offset:1024
    v_mfma_f32_16x16x32_bf16 v[20:23], a[144:147], v[144:147], v[100:103]
    v_cvt_pk_bf16_f32 v80, v32, v33
    ds_read_b64_tr_b16 a[188:189], v207 offset:0
    v_mfma_f32_16x16x32_bf16 v[8:11], a[128:131], v[160:163], v[104:107]
    v_exp_f32 v34, v34
    v_mfma_f32_16x16x32_bf16 v[24:27], a[144:147], v[160:163], v[104:107]
    v_exp_f32 v35, v35
    v_mfma_f32_16x16x32_bf16 v[12:15], a[128:131], v[176:179], v[108:111]
    s_add_u32 s34, s34, 16384
    v_mfma_f32_16x16x32_bf16 v[28:31], a[144:147], v[176:179], v[108:111]
    v_cvt_pk_bf16_f32 v81, v34, v35
    ds_read_b128 a[128:131], v196 offset:24576
    v_mfma_f32_16x16x32_bf16 a[4:7], a[160:163], v[68:71], a[4:7]
    v_exp_f32 v36, v36
    v_mfma_f32_16x16x32_bf16 a[20:23], a[164:167], v[68:71], a[20:23]
    v_exp_f32 v37, v37
    v_mfma_f32_16x16x32_bf16 a[8:11], a[160:163], v[72:75], a[8:11]
    ds_read_b64_tr_b16 a[190:191], v207 offset:1024
    v_mfma_f32_16x16x32_bf16 a[24:27], a[164:167], v[72:75], a[24:27]
    v_cvt_pk_bf16_f32 v84, v36, v37
    ds_read_b128 a[144:147], v196 offset:25600
    v_mfma_f32_16x16x32_bf16 a[12:15], a[160:163], v[76:79], a[12:15]
    v_exp_f32 v38, v38
    v_mfma_f32_16x16x32_bf16 a[28:31], a[164:167], v[76:79], a[28:31]
    v_exp_f32 v39, v39
    v_mfma_f32_16x16x32_bf16 a[0:3], a[160:163], v[64:67], a[0:3]
    s_add_u32 s75, s75, 16384
    v_mfma_f32_16x16x32_bf16 a[16:19], a[164:167], v[64:67], a[16:19]
    v_cvt_pk_bf16_f32 v85, v38, v39
    v_mfma_f32_16x16x32_bf16 v[112:115], v[252:255], v[64:67], v[112:115]
    ds_read_b64_tr_b16 a[160:161], v200 offset:8192
    v_mfma_f32_16x16x32_bf16 v[0:3], a[132:135], v[132:135], v[0:3]
    v_exp_f32 v40, v40
    v_mfma_f32_16x16x32_bf16 v[16:19], a[148:151], v[132:135], v[16:19]
    v_exp_f32 v41, v41
    v_mfma_f32_16x16x32_bf16 v[4:7], a[132:135], v[148:151], v[4:7]
    ds_read_b64_tr_b16 a[162:163], v200 offset:9216
    v_mfma_f32_16x16x32_bf16 v[20:23], a[148:151], v[148:151], v[20:23]
    v_cvt_pk_bf16_f32 v88, v40, v41
    ds_read_b64_tr_b16 a[164:165], v201 offset:8192
    v_mfma_f32_16x16x32_bf16 v[8:11], a[132:135], v[164:167], v[8:11]
    v_exp_f32 v42, v42
    v_mfma_f32_16x16x32_bf16 v[24:27], a[148:151], v[164:167], v[24:27]
    v_exp_f32 v43, v43
    v_mfma_f32_16x16x32_bf16 v[12:15], a[132:135], v[180:183], v[12:15]
    v_mfma_f32_16x16x32_bf16 v[28:31], a[148:151], v[180:183], v[28:31]
    v_cvt_pk_bf16_f32 v89, v42, v43
    ds_read_b128 a[132:135], v197 offset:24576
    v_mfma_f32_16x16x32_bf16 a[40:43], a[168:171], v[72:75], a[40:43]
    v_exp_f32 v44, v44
    v_mfma_f32_16x16x32_bf16 a[56:59], a[172:175], v[72:75], a[56:59]
    v_exp_f32 v45, v45
    v_mfma_f32_16x16x32_bf16 a[44:47], a[168:171], v[76:79], a[44:47]
    ds_read_b64_tr_b16 a[166:167], v201 offset:9216
    v_mfma_f32_16x16x32_bf16 a[60:63], a[172:175], v[76:79], a[60:63]
    v_cvt_pk_bf16_f32 v92, v44, v45
    ds_read_b128 a[148:151], v197 offset:25600
    v_mfma_f32_16x16x32_bf16 a[32:35], a[168:171], v[64:67], a[32:35]
    v_exp_f32 v46, v46
    v_mfma_f32_16x16x32_bf16 a[48:51], a[172:175], v[64:67], a[48:51]
    v_exp_f32 v47, v47
    v_mfma_f32_16x16x32_bf16 a[36:39], a[168:171], v[68:71], a[36:39]
    s_waitcnt lgkmcnt(7)
    v_mfma_f32_16x16x32_bf16 a[52:55], a[172:175], v[68:71], a[52:55]
    v_cvt_pk_bf16_f32 v93, v46, v47
    v_mfma_f32_16x16x32_bf16 v[116:119], v[252:255], v[68:71], v[116:119]
    ds_read_b64_tr_b16 a[168:169], v202 offset:8192
    v_mfma_f32_16x16x32_bf16 v[0:3], a[136:139], v[136:139], v[0:3]
    v_exp_f32 v48, v48
    v_mfma_f32_16x16x32_bf16 v[16:19], a[152:155], v[136:139], v[16:19]
    v_exp_f32 v49, v49
    v_mfma_f32_16x16x32_bf16 v[4:7], a[136:139], v[152:155], v[4:7]
    ds_read_b64_tr_b16 a[170:171], v202 offset:9216
    v_mfma_f32_16x16x32_bf16 v[20:23], a[152:155], v[152:155], v[20:23]
    v_cvt_pk_bf16_f32 v82, v48, v49
    ds_read_b64_tr_b16 a[172:173], v203 offset:8192
    v_mfma_f32_16x16x32_bf16 v[8:11], a[136:139], v[168:171], v[8:11]
    v_exp_f32 v50, v50
    v_mfma_f32_16x16x32_bf16 v[24:27], a[152:155], v[168:171], v[24:27]
    v_exp_f32 v51, v51
    v_mfma_f32_16x16x32_bf16 v[12:15], a[136:139], v[184:187], v[12:15]
    v_mfma_f32_16x16x32_bf16 v[28:31], a[152:155], v[184:187], v[28:31]
    v_cvt_pk_bf16_f32 v83, v50, v51
    ds_read_b128 a[136:139], v198 offset:24576
    v_mfma_f32_16x16x32_bf16 a[76:79], a[176:179], v[76:79], a[76:79]
    v_exp_f32 v52, v52
    v_mfma_f32_16x16x32_bf16 a[92:95], a[180:183], v[76:79], a[92:95]
    v_exp_f32 v53, v53
    v_mfma_f32_16x16x32_bf16 a[64:67], a[176:179], v[64:67], a[64:67]
    ds_read_b64_tr_b16 a[174:175], v203 offset:9216
    v_mfma_f32_16x16x32_bf16 a[80:83], a[180:183], v[64:67], a[80:83]
    v_cvt_pk_bf16_f32 v86, v52, v53
    ds_read_b128 a[152:155], v198 offset:25600
    v_mfma_f32_16x16x32_bf16 a[68:71], a[176:179], v[68:71], a[68:71]
    v_exp_f32 v54, v54
    v_mfma_f32_16x16x32_bf16 a[84:87], a[180:183], v[68:71], a[84:87]
    v_exp_f32 v55, v55
    v_mfma_f32_16x16x32_bf16 a[72:75], a[176:179], v[72:75], a[72:75]
    v_mfma_f32_16x16x32_bf16 a[88:91], a[180:183], v[72:75], a[88:91]
    v_cvt_pk_bf16_f32 v87, v54, v55
    v_mfma_f32_16x16x32_bf16 v[120:123], v[252:255], v[72:75], v[120:123]
    ds_read_b64_tr_b16 a[176:177], v204 offset:8192
    v_mfma_f32_16x16x32_bf16 v[0:3], a[140:143], v[140:143], v[0:3]
    v_exp_f32 v56, v56
    v_mfma_f32_16x16x32_bf16 v[16:19], a[156:159], v[140:143], v[16:19]
    v_exp_f32 v57, v57
    v_mfma_f32_16x16x32_bf16 v[4:7], a[140:143], v[156:159], v[4:7]
    ds_read_b64_tr_b16 a[178:179], v204 offset:9216
    v_mfma_f32_16x16x32_bf16 v[20:23], a[156:159], v[156:159], v[20:23]
    v_cvt_pk_bf16_f32 v90, v56, v57
    ds_read_b64_tr_b16 a[180:181], v205 offset:8192
    v_mfma_f32_16x16x32_bf16 v[8:11], a[140:143], v[172:175], v[8:11]
    v_exp_f32 v58, v58
    v_mfma_f32_16x16x32_bf16 v[24:27], a[156:159], v[172:175], v[24:27]
    v_exp_f32 v59, v59
    v_mfma_f32_16x16x32_bf16 v[12:15], a[140:143], v[188:191], v[12:15]
    v_mfma_f32_16x16x32_bf16 v[28:31], a[156:159], v[188:191], v[28:31]
    v_cvt_pk_bf16_f32 v91, v58, v59
    ds_read_b128 a[140:143], v199 offset:24576
    v_mfma_f32_16x16x32_bf16 a[96:99], a[184:187], v[64:67], a[96:99]
    v_exp_f32 v60, v60
    v_mfma_f32_16x16x32_bf16 a[112:115], a[188:191], v[64:67], a[112:115]
    v_exp_f32 v61, v61
    v_mfma_f32_16x16x32_bf16 a[100:103], a[184:187], v[68:71], a[100:103]
    ds_read_b64_tr_b16 a[182:183], v205 offset:9216
    v_mfma_f32_16x16x32_bf16 a[116:119], a[188:191], v[68:71], a[116:119]
    v_cvt_pk_bf16_f32 v94, v60, v61
    ds_read_b128 a[156:159], v199 offset:25600
    v_mfma_f32_16x16x32_bf16 a[104:107], a[184:187], v[72:75], a[104:107]
    v_exp_f32 v62, v62
    v_mfma_f32_16x16x32_bf16 a[120:123], a[188:191], v[72:75], a[120:123]
    v_exp_f32 v63, v63
    v_mfma_f32_16x16x32_bf16 a[108:111], a[184:187], v[76:79], a[108:111]
    s_waitcnt lgkmcnt(7)
    v_mfma_f32_16x16x32_bf16 a[124:127], a[188:191], v[76:79], a[124:127]
    v_cvt_pk_bf16_f32 v95, v62, v63
    v_mfma_f32_16x16x32_bf16 v[124:127], v[252:255], v[76:79], v[124:127]
    ds_read_b64_tr_b16 a[184:185], v206 offset:8192
    s_sub_u32 s44, s44, 1
    s_cmp_lg_u32 s44, 0
    s_waitcnt vmcnt(8)
    s_barrier
    s_cbranch_scc1 L_k1_aloop
    v_mfma_f32_16x16x32_bf16 v[32:35], a[128:131], v[128:131], v[96:99]
    v_exp_f32 v0, v0
    v_mfma_f32_16x16x32_bf16 v[48:51], a[144:147], v[128:131], v[96:99]
    v_exp_f32 v1, v1
    v_mfma_f32_16x16x32_bf16 v[36:39], a[128:131], v[144:147], v[100:103]
    ds_read_b64_tr_b16 a[186:187], v206 offset:9216
    s_add_u32 m0, s29, 114688
    v_mfma_f32_16x16x32_bf16 v[52:55], a[144:147], v[144:147], v[100:103]
    v_cvt_pk_bf16_f32 v64, v0, v1
    ds_read_b64_tr_b16 a[188:189], v207 offset:8192
    v_mfma_f32_16x16x32_bf16 v[40:43], a[128:131], v[160:163], v[104:107]
    v_exp_f32 v2, v2
    v_mfma_f32_16x16x32_bf16 v[56:59], a[144:147], v[160:163], v[104:107]
    v_exp_f32 v3, v3
    v_mfma_f32_16x16x32_bf16 v[44:47], a[128:131], v[176:179], v[108:111]
    buffer_load_dwordx4 v210, s[12:15], s75 offen offset:0 nt lds
    v_mfma_f32_16x16x32_bf16 v[60:63], a[144:147], v[176:179], v[108:111]
    v_cvt_pk_bf16_f32 v65, v2, v3
    ds_read_b128 a[128:131], v196 offset:32768
    v_mfma_f32_16x16x32_bf16 a[4:7], a[160:163], v[84:87], a[4:7]
    v_exp_f32 v4, v4
    v_mfma_f32_16x16x32_bf16 a[20:23], a[164:167], v[84:87], a[20:23]
    v_exp_f32 v5, v5
    v_mfma_f32_16x16x32_bf16 a[8:11], a[160:163], v[88:91], a[8:11]
    ds_read_b64_tr_b16 a[190:191], v207 offset:9216
    v_mfma_f32_16x16x32_bf16 a[24:27], a[164:167], v[88:91], a[24:27]
    v_cvt_pk_bf16_f32 v68, v4, v5
    ds_read_b128 a[144:147], v196 offset:33792
    v_mfma_f32_16x16x32_bf16 a[12:15], a[160:163], v[92:95], a[12:15]
    v_exp_f32 v6, v6
    v_mfma_f32_16x16x32_bf16 a[28:31], a[164:167], v[92:95], a[28:31]
    v_exp_f32 v7, v7
    v_mfma_f32_16x16x32_bf16 a[0:3], a[160:163], v[80:83], a[0:3]
    buffer_load_dwordx4 v210, s[12:15], s75 offen offset:1024 nt lds
    v_mfma_f32_16x16x32_bf16 a[16:19], a[164:167], v[80:83], a[16:19]
    v_cvt_pk_bf16_f32 v69, v6, v7
    v_mfma_f32_16x16x32_bf16 v[112:115], v[252:255], v[80:83], v[112:115]
    ds_read_b64_tr_b16 a[160:161], v200 offset:16384
    v_mfma_f32_16x16x32_bf16 v[32:35], a[132:135], v[132:135], v[32:35]
    v_exp_f32 v8, v8
    v_mfma_f32_16x16x32_bf16 v[48:51], a[148:151], v[132:135], v[48:51]
    v_exp_f32 v9, v9
    v_mfma_f32_16x16x32_bf16 v[36:39], a[132:135], v[148:151], v[36:39]
    ds_read_b64_tr_b16 a[162:163], v200 offset:17408
    v_mfma_f32_16x16x32_bf16 v[52:55], a[148:151], v[148:151], v[52:55]
    v_cvt_pk_bf16_f32 v72, v8, v9
    ds_read_b64_tr_b16 a[164:165], v201 offset:16384
    v_mfma_f32_16x16x32_bf16 v[40:43], a[132:135], v[164:167], v[40:43]
    v_exp_f32 v10, v10
    v_mfma_f32_16x16x32_bf16 v[56:59], a[148:151], v[164:167], v[56:59]
    v_exp_f32 v11, v11
    v_mfma_f32_16x16x32_bf16 v[44:47], a[132:135], v[180:183], v[44:47]
    buffer_load_dwordx4 v211, s[12:15], s75 offen offset:2048 nt lds
    v_mfma_f32_16x16x32_bf16 v[60:63], a[148:151], v[180:183], v[60:63]
    v_cvt_pk_bf16_f32 v73, v10, v11
    ds_read_b128 a[132:135], v197 offset:32768
    v_mfma_f32_16x16x32_bf16 a[40:43], a[168:171], v[88:91], a[40:43]
    v_exp_f32 v12, v12
    v_mfma_f32_16x16x32_bf16 a[56:59], a[172:175], v[88:91], a[56:59]
    v_exp_f32 v13, v13
    v_mfma_f32_16x16x32_bf16 a[44:47], a[168:171], v[92:95], a[44:47]
    ds_read_b64_tr_b16 a[166:167], v201 offset:17408
    v_mfma_f32_16x16x32_bf16 a[60:63], a[172:175], v[92:95], a[60:63]
    v_cvt_pk_bf16_f32 v76, v12, v13
    ds_read_b128 a[148:151], v197 offset:33792
    v_mfma_f32_16x16x32_bf16 a[32:35], a[168:171], v[80:83], a[32:35]
    v_exp_f32 v14, v14
    v_mfma_f32_16x16x32_bf16 a[48:51], a[172:175], v[80:83], a[48:51]
    v_exp_f32 v15, v15
    v_mfma_f32_16x16x32_bf16 a[36:39], a[168:171], v[84:87], a[36:39]
    s_waitcnt lgkmcnt(7)
    buffer_load_dwordx4 v211, s[12:15], s75 offen offset:3072 nt lds
    v_mfma_f32_16x16x32_bf16 a[52:55], a[172:175], v[84:87], a[52:55]
    v_cvt_pk_bf16_f32 v77, v14, v15
    v_mfma_f32_16x16x32_bf16 v[116:119], v[252:255], v[84:87], v[116:119]
    ds_read_b64_tr_b16 a[168:169], v202 offset:16384
    v_mfma_f32_16x16x32_bf16 v[32:35], a[136:139], v[136:139], v[32:35]
    v_exp_f32 v16, v16
    v_mfma_f32_16x16x32_bf16 v[48:51], a[152:155], v[136:139], v[48:51]
    v_exp_f32 v17, v17
    v_mfma_f32_16x16x32_bf16 v[36:39], a[136:139], v[152:155], v[36:39]
    ds_read_b64_tr_b16 a[170:171], v202 offset:17408
    s_add_u32 m0, s30, 131072
    v_mfma_f32_16x16x32_bf16 v[52:55], a[152:155], v[152:155], v[52:55]
    v_cvt_pk_bf16_f32 v66, v16, v17
    ds_read_b64_tr_b16 a[172:173], v203 offset:16384
    v_mfma_f32_16x16x32_bf16 v[40:43], a[136:139], v[168:171], v[40:43]
    v_exp_f32 v18, v18
    v_mfma_f32_16x16x32_bf16 v[56:59], a[152:155], v[168:171], v[56:59]
    v_exp_f32 v19, v19
    v_mfma_f32_16x16x32_bf16 v[44:47], a[136:139], v[184:187], v[44:47]
    buffer_load_dwordx4 v216, s[16:19], s36 offen offset:0 lds
    v_mfma_f32_16x16x32_bf16 v[60:63], a[152:155], v[184:187], v[60:63]
    v_cvt_pk_bf16_f32 v67, v18, v19
    ds_read_b128 a[136:139], v198 offset:32768
    v_mfma_f32_16x16x32_bf16 a[76:79], a[176:179], v[92:95], a[76:79]
    v_exp_f32 v20, v20
    v_mfma_f32_16x16x32_bf16 a[92:95], a[180:183], v[92:95], a[92:95]
    v_exp_f32 v21, v21
    v_mfma_f32_16x16x32_bf16 a[64:67], a[176:179], v[80:83], a[64:67]
    ds_read_b64_tr_b16 a[174:175], v203 offset:17408
    v_mfma_f32_16x16x32_bf16 a[80:83], a[180:183], v[80:83], a[80:83]
    v_cvt_pk_bf16_f32 v70, v20, v21
    ds_read_b128 a[152:155], v198 offset:33792
    v_mfma_f32_16x16x32_bf16 a[68:71], a[176:179], v[84:87], a[68:71]
    v_exp_f32 v22, v22
    v_mfma_f32_16x16x32_bf16 a[84:87], a[180:183], v[84:87], a[84:87]
    v_exp_f32 v23, v23
    v_mfma_f32_16x16x32_bf16 a[72:75], a[176:179], v[88:91], a[72:75]
    buffer_load_dwordx4 v217, s[16:19], s36 offen offset:1024 lds
    v_mfma_f32_16x16x32_bf16 a[88:91], a[180:183], v[88:91], a[88:91]
    v_cvt_pk_bf16_f32 v71, v22, v23
    v_mfma_f32_16x16x32_bf16 v[120:123], v[252:255], v[88:91], v[120:123]
    ds_read_b64_tr_b16 a[176:177], v204 offset:16384
    v_mfma_f32_16x16x32_bf16 v[32:35], a[140:143], v[140:143], v[32:35]
    v_exp_f32 v24, v24
    v_mfma_f32_16x16x32_bf16 v[48:51], a[156:159], v[140:143], v[48:51]
    v_exp_f32 v25, v25
    v_mfma_f32_16x16x32_bf16 v[36:39], a[140:143], v[156:159], v[36:39]
    ds_read_b64_tr_b16 a[178:179], v204 offset:17408
    v_mfma_f32_16x16x32_bf16 v[52:55], a[156:159], v[156:159], v[52:55]
    v_cvt_pk_bf16_f32 v74, v24, v25
    ds_read_b64_tr_b16 a[180:181], v205 offset:16384
    v_mfma_f32_16x16x32_bf16 v[40:43], a[140:143], v[172:175], v[40:43]
    v_exp_f32 v26, v26
    v_mfma_f32_16x16x32_bf16 v[56:59], a[156:159], v[172:175], v[56:59]
    v_exp_f32 v27, v27
    v_mfma_f32_16x16x32_bf16 v[44:47], a[140:143], v[188:191], v[44:47]
    buffer_load_dwordx4 v218, s[16:19], s36 offen offset:2048 lds
    v_mfma_f32_16x16x32_bf16 v[60:63], a[156:159], v[188:191], v[60:63]
    v_cvt_pk_bf16_f32 v75, v26, v27
    ds_read_b128 a[140:143], v199 offset:32768
    v_mfma_f32_16x16x32_bf16 a[96:99], a[184:187], v[80:83], a[96:99]
    v_exp_f32 v28, v28
    v_mfma_f32_16x16x32_bf16 a[112:115], a[188:191], v[80:83], a[112:115]
    v_exp_f32 v29, v29
    v_mfma_f32_16x16x32_bf16 a[100:103], a[184:187], v[84:87], a[100:103]
    ds_read_b64_tr_b16 a[182:183], v205 offset:17408
    v_mfma_f32_16x16x32_bf16 a[116:119], a[188:191], v[84:87], a[116:119]
    v_cvt_pk_bf16_f32 v78, v28, v29
    ds_read_b128 a[156:159], v199 offset:33792
    v_mfma_f32_16x16x32_bf16 a[104:107], a[184:187], v[88:91], a[104:107]
    v_exp_f32 v30, v30
    v_mfma_f32_16x16x32_bf16 a[120:123], a[188:191], v[88:91], a[120:123]
    v_exp_f32 v31, v31
    v_mfma_f32_16x16x32_bf16 a[108:111], a[184:187], v[92:95], a[108:111]
    s_waitcnt lgkmcnt(7)
    buffer_load_dwordx4 v219, s[16:19], s36 offen offset:3072 lds
    v_mfma_f32_16x16x32_bf16 a[124:127], a[188:191], v[92:95], a[124:127]
    v_cvt_pk_bf16_f32 v79, v30, v31
    v_mfma_f32_16x16x32_bf16 v[124:127], v[252:255], v[92:95], v[124:127]
    ds_read_b64_tr_b16 a[184:185], v206 offset:16384
    v_mfma_f32_16x16x32_bf16 v[0:3], a[128:131], v[128:131], v[96:99]
    v_exp_f32 v32, v32
    v_mfma_f32_16x16x32_bf16 v[16:19], a[144:147], v[128:131], v[96:99]
    v_exp_f32 v33, v33
    v_mfma_f32_16x16x32_bf16 v[4:7], a[128:131], v[144:147], v[100:103]
    ds_read_b64_tr_b16 a[186:187], v206 offset:17408
    s_add_u32 m0, m0, s67
    v_mfma_f32_16x16x32_bf16 v[20:23], a[144:147], v[144:147], v[100:103]
    v_cvt_pk_bf16_f32 v80, v32, v33
    ds_read_b64_tr_b16 a[188:189], v207 offset:16384
    v_mfma_f32_16x16x32_bf16 v[8:11], a[128:131], v[160:163], v[104:107]
    v_exp_f32 v34, v34
    v_mfma_f32_16x16x32_bf16 v[24:27], a[144:147], v[160:163], v[104:107]
    v_exp_f32 v35, v35
    v_mfma_f32_16x16x32_bf16 v[12:15], a[128:131], v[176:179], v[108:111]
    buffer_load_dwordx4 v216, s[16:19], s37 offen offset:0 lds
    v_mfma_f32_16x16x32_bf16 v[28:31], a[144:147], v[176:179], v[108:111]
    v_cvt_pk_bf16_f32 v81, v34, v35
    ds_read_b128 a[128:131], v196 offset:40960
    v_mfma_f32_16x16x32_bf16 a[4:7], a[160:163], v[68:71], a[4:7]
    v_exp_f32 v36, v36
    v_mfma_f32_16x16x32_bf16 a[20:23], a[164:167], v[68:71], a[20:23]
    v_exp_f32 v37, v37
    v_mfma_f32_16x16x32_bf16 a[8:11], a[160:163], v[72:75], a[8:11]
    ds_read_b64_tr_b16 a[190:191], v207 offset:17408
    v_mfma_f32_16x16x32_bf16 a[24:27], a[164:167], v[72:75], a[24:27]
    v_cvt_pk_bf16_f32 v84, v36, v37
    ds_read_b128 a[144:147], v196 offset:41984
    v_mfma_f32_16x16x32_bf16 a[12:15], a[160:163], v[76:79], a[12:15]
    v_exp_f32 v38, v38
    v_mfma_f32_16x16x32_bf16 a[28:31], a[164:167], v[76:79], a[28:31]
    v_exp_f32 v39, v39
    v_mfma_f32_16x16x32_bf16 a[0:3], a[160:163], v[64:67], a[0:3]
    buffer_load_dwordx4 v217, s[16:19], s37 offen offset:1024 lds
    v_mfma_f32_16x16x32_bf16 a[16:19], a[164:167], v[64:67], a[16:19]
    v_cvt_pk_bf16_f32 v85, v38, v39
    v_mfma_f32_16x16x32_bf16 v[112:115], v[252:255], v[64:67], v[112:115]
    ds_read_b64_tr_b16 a[160:161], v200 offset:24576
    v_mfma_f32_16x16x32_bf16 v[0:3], a[132:135], v[132:135], v[0:3]
    v_exp_f32 v40, v40
    v_mfma_f32_16x16x32_bf16 v[16:19], a[148:151], v[132:135], v[16:19]
    v_exp_f32 v41, v41
    v_mfma_f32_16x16x32_bf16 v[4:7], a[132:135], v[148:151], v[4:7]
    ds_read_b64_tr_b16 a[162:163], v200 offset:25600
    v_mfma_f32_16x16x32_bf16 v[20:23], a[148:151], v[148:151], v[20:23]
    v_cvt_pk_bf16_f32 v88, v40, v41
    ds_read_b64_tr_b16 a[164:165], v201 offset:24576
    v_mfma_f32_16x16x32_bf16 v[8:11], a[132:135], v[164:167], v[8:11]
    v_exp_f32 v42, v42
    v_mfma_f32_16x16x32_bf16 v[24:27], a[148:151], v[164:167], v[24:27]
    v_exp_f32 v43, v43
    v_mfma_f32_16x16x32_bf16 v[12:15], a[132:135], v[180:183], v[12:15]
    buffer_load_dwordx4 v218, s[16:19], s37 offen offset:2048 lds
    v_mfma_f32_16x16x32_bf16 v[28:31], a[148:151], v[180:183], v[28:31]
    v_cvt_pk_bf16_f32 v89, v42, v43
    ds_read_b128 a[132:135], v197 offset:40960
    v_mfma_f32_16x16x32_bf16 a[40:43], a[168:171], v[72:75], a[40:43]
    v_exp_f32 v44, v44
    v_mfma_f32_16x16x32_bf16 a[56:59], a[172:175], v[72:75], a[56:59]
    v_exp_f32 v45, v45
    v_mfma_f32_16x16x32_bf16 a[44:47], a[168:171], v[76:79], a[44:47]
    ds_read_b64_tr_b16 a[166:167], v201 offset:25600
    v_mfma_f32_16x16x32_bf16 a[60:63], a[172:175], v[76:79], a[60:63]
    v_cvt_pk_bf16_f32 v92, v44, v45
    ds_read_b128 a[148:151], v197 offset:41984
    v_mfma_f32_16x16x32_bf16 a[32:35], a[168:171], v[64:67], a[32:35]
    v_exp_f32 v46, v46
    v_mfma_f32_16x16x32_bf16 a[48:51], a[172:175], v[64:67], a[48:51]
    v_exp_f32 v47, v47
    v_mfma_f32_16x16x32_bf16 a[36:39], a[168:171], v[68:71], a[36:39]
    s_waitcnt lgkmcnt(7)
    buffer_load_dwordx4 v219, s[16:19], s37 offen offset:3072 lds
    v_mfma_f32_16x16x32_bf16 a[52:55], a[172:175], v[68:71], a[52:55]
    v_cvt_pk_bf16_f32 v93, v46, v47
    v_mfma_f32_16x16x32_bf16 v[116:119], v[252:255], v[68:71], v[116:119]
    ds_read_b64_tr_b16 a[168:169], v202 offset:24576
    v_mfma_f32_16x16x32_bf16 v[0:3], a[136:139], v[136:139], v[0:3]
    v_exp_f32 v48, v48
    v_mfma_f32_16x16x32_bf16 v[16:19], a[152:155], v[136:139], v[16:19]
    v_exp_f32 v49, v49
    v_mfma_f32_16x16x32_bf16 v[4:7], a[136:139], v[152:155], v[4:7]
    ds_read_b64_tr_b16 a[170:171], v202 offset:25600
    v_mfma_f32_16x16x32_bf16 v[20:23], a[152:155], v[152:155], v[20:23]
    v_cvt_pk_bf16_f32 v82, v48, v49
    ds_read_b64_tr_b16 a[172:173], v203 offset:24576
    v_mfma_f32_16x16x32_bf16 v[8:11], a[136:139], v[168:171], v[8:11]
    v_exp_f32 v50, v50
    v_mfma_f32_16x16x32_bf16 v[24:27], a[152:155], v[168:171], v[24:27]
    v_exp_f32 v51, v51
    v_mfma_f32_16x16x32_bf16 v[12:15], a[136:139], v[184:187], v[12:15]
    s_add_u32 s36, s36, 128
    s_bitset0_b32 s36, 11
    v_mfma_f32_16x16x32_bf16 v[28:31], a[152:155], v[184:187], v[28:31]
    v_cvt_pk_bf16_f32 v83, v50, v51
    ds_read_b128 a[136:139], v198 offset:40960
    v_mfma_f32_16x16x32_bf16 a[76:79], a[176:179], v[76:79], a[76:79]
    v_exp_f32 v52, v52
    v_mfma_f32_16x16x32_bf16 a[92:95], a[180:183], v[76:79], a[92:95]
    v_exp_f32 v53, v53
    v_mfma_f32_16x16x32_bf16 a[64:67], a[176:179], v[64:67], a[64:67]
    ds_read_b64_tr_b16 a[174:175], v203 offset:25600
    v_mfma_f32_16x16x32_bf16 a[80:83], a[180:183], v[64:67], a[80:83]
    v_cvt_pk_bf16_f32 v86, v52, v53
    ds_read_b128 a[152:155], v198 offset:41984
    v_mfma_f32_16x16x32_bf16 a[68:71], a[176:179], v[68:71], a[68:71]
    v_exp_f32 v54, v54
    v_mfma_f32_16x16x32_bf16 a[84:87], a[180:183], v[68:71], a[84:87]
    v_exp_f32 v55, v55
    v_mfma_f32_16x16x32_bf16 a[72:75], a[176:179], v[72:75], a[72:75]
    s_add_u32 s37, s37, 128
    s_bitset0_b32 s37, 11
    v_mfma_f32_16x16x32_bf16 a[88:91], a[180:183], v[72:75], a[88:91]
    v_cvt_pk_bf16_f32 v87, v54, v55
    v_mfma_f32_16x16x32_bf16 v[120:123], v[252:255], v[72:75], v[120:123]
    ds_read_b64_tr_b16 a[176:177], v204 offset:24576
    v_mfma_f32_16x16x32_bf16 v[0:3], a[140:143], v[140:143], v[0:3]
    v_exp_f32 v56, v56
    v_mfma_f32_16x16x32_bf16 v[16:19], a[156:159], v[140:143], v[16:19]
    v_exp_f32 v57, v57
    v_mfma_f32_16x16x32_bf16 v[4:7], a[140:143], v[156:159], v[4:7]
    ds_read_b64_tr_b16 a[178:179], v204 offset:25600
    v_mfma_f32_16x16x32_bf16 v[20:23], a[156:159], v[156:159], v[20:23]
    v_cvt_pk_bf16_f32 v90, v56, v57
    ds_read_b64_tr_b16 a[180:181], v205 offset:24576
    v_mfma_f32_16x16x32_bf16 v[8:11], a[140:143], v[172:175], v[8:11]
    v_exp_f32 v58, v58
    v_mfma_f32_16x16x32_bf16 v[24:27], a[156:159], v[172:175], v[24:27]
    v_exp_f32 v59, v59
    v_mfma_f32_16x16x32_bf16 v[12:15], a[140:143], v[188:191], v[12:15]
    v_mfma_f32_16x16x32_bf16 v[28:31], a[156:159], v[188:191], v[28:31]
    v_cvt_pk_bf16_f32 v91, v58, v59
    ds_read_b128 a[140:143], v199 offset:40960
    v_mfma_f32_16x16x32_bf16 a[96:99], a[184:187], v[64:67], a[96:99]
    v_exp_f32 v60, v60
    v_mfma_f32_16x16x32_bf16 a[112:115], a[188:191], v[64:67], a[112:115]
    v_exp_f32 v61, v61
    v_mfma_f32_16x16x32_bf16 a[100:103], a[184:187], v[68:71], a[100:103]
    ds_read_b64_tr_b16 a[182:183], v205 offset:25600
    v_mfma_f32_16x16x32_bf16 a[116:119], a[188:191], v[68:71], a[116:119]
    v_cvt_pk_bf16_f32 v94, v60, v61
    ds_read_b128 a[156:159], v199 offset:41984
    v_mfma_f32_16x16x32_bf16 a[104:107], a[184:187], v[72:75], a[104:107]
    v_exp_f32 v62, v62
    v_mfma_f32_16x16x32_bf16 a[120:123], a[188:191], v[72:75], a[120:123]
    v_exp_f32 v63, v63
    v_mfma_f32_16x16x32_bf16 a[108:111], a[184:187], v[76:79], a[108:111]
    s_waitcnt lgkmcnt(7)
    v_mfma_f32_16x16x32_bf16 a[124:127], a[188:191], v[76:79], a[124:127]
    v_cvt_pk_bf16_f32 v95, v62, v63
    v_mfma_f32_16x16x32_bf16 v[124:127], v[252:255], v[76:79], v[124:127]
    ds_read_b64_tr_b16 a[184:185], v206 offset:24576
    s_waitcnt vmcnt(12)
    s_barrier
    v_mfma_f32_16x16x32_bf16 v[32:35], a[128:131], v[128:131], v[96:99]
    v_exp_f32 v0, v0
    v_mfma_f32_16x16x32_bf16 v[48:51], a[144:147], v[128:131], v[96:99]
    v_exp_f32 v1, v1
    buffer_load_dword v192, v233, s[4:7], s69 offen
    v_mfma_f32_16x16x32_bf16 v[36:39], a[128:131], v[144:147], v[100:103]
    ds_read_b64_tr_b16 a[186:187], v206 offset:25600
    s_add_u32 m0, s29, 65536
    v_mfma_f32_16x16x32_bf16 v[52:55], a[144:147], v[144:147], v[100:103]
    v_cvt_pk_bf16_f32 v64, v0, v1
    ds_read_b64_tr_b16 a[188:189], v207 offset:24576
    v_mov_b32 v246, 0
    v_mfma_f32_16x16x32_bf16 v[40:43], a[128:131], v[160:163], v[104:107]
    v_exp_f32 v2, v2
    global_load_dword v244, v195, s[62:63] sc1
    v_mbcnt_lo_u32_b32 v250, -1, 0
    v_mfma_f32_16x16x32_bf16 v[56:59], a[144:147], v[160:163], v[104:107]
    v_exp_f32 v3, v3
    v_mfma_f32_16x16x32_bf16 v[44:47], a[128:131], v[176:179], v[108:111]
    buffer_load_dwordx4 v212, s[20:23], s35 offen offset:0 lds
    v_mfma_f32_16x16x32_bf16 v[60:63], a[144:147], v[176:179], v[108:111]
    v_cvt_pk_bf16_f32 v65, v2, v3
    ds_read_b128 a[128:131], v196 offset:49152
    v_mfma_f32_16x16x32_bf16 a[4:7], a[160:163], v[84:87], a[4:7]
    v_exp_f32 v4, v4
    v_mfma_f32_16x16x32_bf16 a[20:23], a[164:167], v[84:87], a[20:23]
    v_exp_f32 v5, v5
    v_mfma_f32_16x16x32_bf16 a[8:11], a[160:163], v[88:91], a[8:11]
    ds_read_b64_tr_b16 a[190:191], v207 offset:25600
    v_mfma_f32_16x16x32_bf16 a[24:27], a[164:167], v[88:91], a[24:27]
    v_cvt_pk_bf16_f32 v68, v4, v5
    ds_read_b128 a[144:147], v196 offset:50176
    v_mov_b32 v247, 0
    v_mfma_f32_16x16x32_bf16 a[12:15], a[160:163], v[92:95], a[12:15]
    v_exp_f32 v6, v6
    v_mbcnt_hi_u32_b32 v250, -1, v250
    v_mfma_f32_16x16x32_bf16 a[28:31], a[164:167], v[92:95], a[28:31]
    v_exp_f32 v7, v7
    v_mfma_f32_16x16x32_bf16 a[0:3], a[160:163], v[80:83], a[0:3]
    buffer_load_dwordx4 v213, s[20:23], s35 offen offset:1024 lds
    v_mfma_f32_16x16x32_bf16 a[16:19], a[164:167], v[80:83], a[16:19]
    v_cvt_pk_bf16_f32 v69, v6, v7
    v_mfma_f32_16x16x32_bf16 v[112:115], v[252:255], v[80:83], v[112:115]
    ds_read_b64_tr_b16 a[160:161], v200 offset:32768
    v_mfma_f32_16x16x32_bf16 v[32:35], a[132:135], v[132:135], v[32:35]
    v_exp_f32 v8, v8
    v_mfma_f32_16x16x32_bf16 v[48:51], a[148:151], v[132:135], v[48:51]
    v_exp_f32 v9, v9
    v_mfma_f32_16x16x32_bf16 v[36:39], a[132:135], v[148:151], v[36:39]
    ds_read_b64_tr_b16 a[162:163], v200 offset:33792
    v_mfma_f32_16x16x32_bf16 v[52:55], a[148:151], v[148:151], v[52:55]
    v_cvt_pk_bf16_f32 v72, v8, v9
    ds_read_b64_tr_b16 a[164:165], v201 offset:32768
    v_mov_b32 v248, 0
    v_mfma_f32_16x16x32_bf16 v[40:43], a[132:135], v[164:167], v[40:43]
    v_exp_f32 v10, v10
    v_lshlrev_b32 v250, 4, v250
    v_mfma_f32_16x16x32_bf16 v[56:59], a[148:151], v[164:167], v[56:59]
    v_exp_f32 v11, v11
    v_mfma_f32_16x16x32_bf16 v[44:47], a[132:135], v[180:183], v[44:47]
    buffer_load_dwordx4 v214, s[20:23], s35 offen offset:2048 lds
    v_mfma_f32_16x16x32_bf16 v[60:63], a[148:151], v[180:183], v[60:63]
    v_cvt_pk_bf16_f32 v73, v10, v11
    ds_read_b128 a[132:135], v197 offset:49152
    v_mfma_f32_16x16x32_bf16 a[40:43], a[168:171], v[88:91], a[40:43]
    v_exp_f32 v12, v12
    v_mfma_f32_16x16x32_bf16 a[56:59], a[172:175], v[88:91], a[56:59]
    v_exp_f32 v13, v13
    v_mfma_f32_16x16x32_bf16 a[44:47], a[168:171], v[92:95], a[44:47]
    ds_read_b64_tr_b16 a[166:167], v201 offset:33792
    v_mfma_f32_16x16x32_bf16 a[60:63], a[172:175], v[92:95], a[60:63]
    v_cvt_pk_bf16_f32 v76, v12, v13
    ds_read_b128 a[148:151], v197 offset:50176
    v_mov_b32 v249, 0
    v_mfma_f32_16x16x32_bf16 a[32:35], a[168:171], v[80:83], a[32:35]
    v_exp_f32 v14, v14
    v_mfma_f32_16x16x32_bf16 a[48:51], a[172:175], v[80:83], a[48:51]
    v_exp_f32 v15, v15
    v_mfma_f32_16x16x32_bf16 a[36:39], a[168:171], v[84:87], a[36:39]
    s_waitcnt lgkmcnt(7)
    buffer_load_dwordx4 v215, s[20:23], s35 offen offset:3072 lds
    v_mfma_f32_16x16x32_bf16 a[52:55], a[172:175], v[84:87], a[52:55]
    v_cvt_pk_bf16_f32 v77, v14, v15
    v_mfma_f32_16x16x32_bf16 v[116:119], v[252:255], v[84:87], v[116:119]
    ds_read_b64_tr_b16 a[168:169], v202 offset:32768
    v_mfma_f32_16x16x32_bf16 v[32:35], a[136:139], v[136:139], v[32:35]
    v_exp_f32 v16, v16
    v_mfma_f32_16x16x32_bf16 v[48:51], a[152:155], v[136:139], v[48:51]
    v_exp_f32 v17, v17
    v_mfma_f32_16x16x32_bf16 v[36:39], a[136:139], v[152:155], v[36:39]
    ds_read_b64_tr_b16 a[170:171], v202 offset:33792
    s_mov_b32 m0, s30
    v_mfma_f32_16x16x32_bf16 v[52:55], a[152:155], v[152:155], v[52:55]
    v_cvt_pk_bf16_f32 v66, v16, v17
    ds_read_b64_tr_b16 a[172:173], v203 offset:32768
    v_mfma_f32_16x16x32_bf16 v[40:43], a[136:139], v[168:171], v[40:43]
    v_exp_f32 v18, v18
    ds_write_b128 v250, v[246:249] offset:30720
    v_mfma_f32_16x16x32_bf16 v[56:59], a[152:155], v[168:171], v[56:59]
    v_exp_f32 v19, v19
    v_mfma_f32_16x16x32_bf16 v[44:47], a[136:139], v[184:187], v[44:47]
    buffer_load_dwordx4 v216, s[16:19], s36 offen offset:0 lds
    v_mfma_f32_16x16x32_bf16 v[60:63], a[152:155], v[184:187], v[60:63]
    v_cvt_pk_bf16_f32 v67, v18, v19
    ds_read_b128 a[136:139], v198 offset:49152
    v_mfma_f32_16x16x32_bf16 a[76:79], a[176:179], v[92:95], a[76:79]
    v_exp_f32 v20, v20
    v_mfma_f32_16x16x32_bf16 a[92:95], a[180:183], v[92:95], a[92:95]
    v_exp_f32 v21, v21
    v_mfma_f32_16x16x32_bf16 a[64:67], a[176:179], v[80:83], a[64:67]
    ds_read_b64_tr_b16 a[174:175], v203 offset:33792
    v_mfma_f32_16x16x32_bf16 a[80:83], a[180:183], v[80:83], a[80:83]
    v_cvt_pk_bf16_f32 v70, v20, v21
    ds_read_b128 a[152:155], v198 offset:50176
    v_mfma_f32_16x16x32_bf16 a[68:71], a[176:179], v[84:87], a[68:71]
    v_exp_f32 v22, v22
    ds_write_b128 v250, v[246:249] offset:31744
    v_mfma_f32_16x16x32_bf16 a[84:87], a[180:183], v[84:87], a[84:87]
    v_exp_f32 v23, v23
    v_mfma_f32_16x16x32_bf16 a[72:75], a[176:179], v[88:91], a[72:75]
    buffer_load_dwordx4 v217, s[16:19], s36 offen offset:1024 lds
    v_mfma_f32_16x16x32_bf16 a[88:91], a[180:183], v[88:91], a[88:91]
    v_cvt_pk_bf16_f32 v71, v22, v23
    v_mfma_f32_16x16x32_bf16 v[120:123], v[252:255], v[88:91], v[120:123]
    ds_read_b64_tr_b16 a[176:177], v204 offset:32768
    v_mfma_f32_16x16x32_bf16 v[32:35], a[140:143], v[140:143], v[32:35]
    v_exp_f32 v24, v24
    v_mfma_f32_16x16x32_bf16 v[48:51], a[156:159], v[140:143], v[48:51]
    v_exp_f32 v25, v25
    v_mfma_f32_16x16x32_bf16 v[36:39], a[140:143], v[156:159], v[36:39]
    ds_read_b64_tr_b16 a[178:179], v204 offset:33792
    v_mfma_f32_16x16x32_bf16 v[52:55], a[156:159], v[156:159], v[52:55]
    v_cvt_pk_bf16_f32 v74, v24, v25
    ds_read_b64_tr_b16 a[180:181], v205 offset:32768
    v_mfma_f32_16x16x32_bf16 v[40:43], a[140:143], v[172:175], v[40:43]
    v_exp_f32 v26, v26
    v_mfma_f32_16x16x32_bf16 v[56:59], a[156:159], v[172:175], v[56:59]
    v_exp_f32 v27, v27
    v_mfma_f32_16x16x32_bf16 v[44:47], a[140:143], v[188:191], v[44:47]
    buffer_load_dwordx4 v218, s[16:19], s36 offen offset:2048 lds
    v_mfma_f32_16x16x32_bf16 v[60:63], a[156:159], v[188:191], v[60:63]
    v_cvt_pk_bf16_f32 v75, v26, v27
    ds_read_b128 a[140:143], v199 offset:49152
    v_mfma_f32_16x16x32_bf16 a[96:99], a[184:187], v[80:83], a[96:99]
    v_exp_f32 v28, v28
    v_mfma_f32_16x16x32_bf16 a[112:115], a[188:191], v[80:83], a[112:115]
    v_exp_f32 v29, v29
    v_mfma_f32_16x16x32_bf16 a[100:103], a[184:187], v[84:87], a[100:103]
    ds_read_b64_tr_b16 a[182:183], v205 offset:33792
    v_mfma_f32_16x16x32_bf16 a[116:119], a[188:191], v[84:87], a[116:119]
    v_cvt_pk_bf16_f32 v78, v28, v29
    ds_read_b128 a[156:159], v199 offset:50176
    v_mfma_f32_16x16x32_bf16 a[104:107], a[184:187], v[88:91], a[104:107]
    v_exp_f32 v30, v30
    v_mfma_f32_16x16x32_bf16 a[120:123], a[188:191], v[88:91], a[120:123]
    v_exp_f32 v31, v31
    v_mfma_f32_16x16x32_bf16 a[108:111], a[184:187], v[92:95], a[108:111]
    s_waitcnt lgkmcnt(8)
    buffer_load_dwordx4 v219, s[16:19], s36 offen offset:3072 lds
    v_mfma_f32_16x16x32_bf16 a[124:127], a[188:191], v[92:95], a[124:127]
    v_cvt_pk_bf16_f32 v79, v30, v31
    v_mfma_f32_16x16x32_bf16 v[124:127], v[252:255], v[92:95], v[124:127]
    ds_read_b64_tr_b16 a[184:185], v206 offset:32768
    v_mfma_f32_16x16x32_bf16 v[0:3], a[128:131], v[128:131], v[96:99]
    v_exp_f32 v32, v32
    v_mfma_f32_16x16x32_bf16 v[16:19], a[144:147], v[128:131], v[96:99]
    v_exp_f32 v33, v33
    v_mfma_f32_16x16x32_bf16 v[4:7], a[128:131], v[144:147], v[100:103]
    ds_read_b64_tr_b16 a[186:187], v206 offset:33792
    s_add_u32 m0, m0, s67
    v_mfma_f32_16x16x32_bf16 v[20:23], a[144:147], v[144:147], v[100:103]
    v_cvt_pk_bf16_f32 v80, v32, v33
    ds_read_b64_tr_b16 a[188:189], v207 offset:32768
    v_mfma_f32_16x16x32_bf16 v[8:11], a[128:131], v[160:163], v[104:107]
    v_exp_f32 v34, v34
    v_mfma_f32_16x16x32_bf16 v[24:27], a[144:147], v[160:163], v[104:107]
    v_exp_f32 v35, v35
    v_mfma_f32_16x16x32_bf16 v[12:15], a[128:131], v[176:179], v[108:111]
    buffer_load_dwordx4 v216, s[16:19], s37 offen offset:0 lds
    v_mfma_f32_16x16x32_bf16 v[28:31], a[144:147], v[176:179], v[108:111]
    v_cvt_pk_bf16_f32 v81, v34, v35
    ds_read_b128 a[128:131], v196 offset:57344
    v_mfma_f32_16x16x32_bf16 a[4:7], a[160:163], v[68:71], a[4:7]
    v_exp_f32 v36, v36
    v_mfma_f32_16x16x32_bf16 a[20:23], a[164:167], v[68:71], a[20:23]
    v_exp_f32 v37, v37
    v_mfma_f32_16x16x32_bf16 a[8:11], a[160:163], v[72:75], a[8:11]
    ds_read_b64_tr_b16 a[190:191], v207 offset:33792
    v_mfma_f32_16x16x32_bf16 a[24:27], a[164:167], v[72:75], a[24:27]
    v_cvt_pk_bf16_f32 v84, v36, v37
    ds_read_b128 a[144:147], v196 offset:58368
    v_mfma_f32_16x16x32_bf16 a[12:15], a[160:163], v[76:79], a[12:15]
    v_exp_f32 v38, v38
    v_mfma_f32_16x16x32_bf16 a[28:31], a[164:167], v[76:79], a[28:31]
    v_exp_f32 v39, v39
    v_mfma_f32_16x16x32_bf16 a[0:3], a[160:163], v[64:67], a[0:3]
    buffer_load_dwordx4 v217, s[16:19], s37 offen offset:1024 lds
    v_mfma_f32_16x16x32_bf16 a[16:19], a[164:167], v[64:67], a[16:19]
    v_cvt_pk_bf16_f32 v85, v38, v39
    v_mfma_f32_16x16x32_bf16 v[112:115], v[252:255], v[64:67], v[112:115]
    ds_read_b64_tr_b16 a[160:161], v200 offset:40960
    v_mfma_f32_16x16x32_bf16 v[0:3], a[132:135], v[132:135], v[0:3]
    v_exp_f32 v40, v40
    v_mfma_f32_16x16x32_bf16 v[16:19], a[148:151], v[132:135], v[16:19]
    v_exp_f32 v41, v41
    v_mfma_f32_16x16x32_bf16 v[4:7], a[132:135], v[148:151], v[4:7]
    ds_read_b64_tr_b16 a[162:163], v200 offset:41984
    v_mfma_f32_16x16x32_bf16 v[20:23], a[148:151], v[148:151], v[20:23]
    v_cvt_pk_bf16_f32 v88, v40, v41
    ds_read_b64_tr_b16 a[164:165], v201 offset:40960
    v_mfma_f32_16x16x32_bf16 v[8:11], a[132:135], v[164:167], v[8:11]
    v_exp_f32 v42, v42
    v_mfma_f32_16x16x32_bf16 v[24:27], a[148:151], v[164:167], v[24:27]
    v_exp_f32 v43, v43
    v_mfma_f32_16x16x32_bf16 v[12:15], a[132:135], v[180:183], v[12:15]
    buffer_load_dwordx4 v218, s[16:19], s37 offen offset:2048 lds
    v_mfma_f32_16x16x32_bf16 v[28:31], a[148:151], v[180:183], v[28:31]
    v_cvt_pk_bf16_f32 v89, v42, v43
    ds_read_b128 a[132:135], v197 offset:57344
    v_mfma_f32_16x16x32_bf16 a[40:43], a[168:171], v[72:75], a[40:43]
    v_exp_f32 v44, v44
    v_mfma_f32_16x16x32_bf16 a[56:59], a[172:175], v[72:75], a[56:59]
    v_exp_f32 v45, v45
    v_mfma_f32_16x16x32_bf16 a[44:47], a[168:171], v[76:79], a[44:47]
    ds_read_b64_tr_b16 a[166:167], v201 offset:41984
    v_mfma_f32_16x16x32_bf16 a[60:63], a[172:175], v[76:79], a[60:63]
    v_cvt_pk_bf16_f32 v92, v44, v45
    ds_read_b128 a[148:151], v197 offset:58368
    v_mfma_f32_16x16x32_bf16 a[32:35], a[168:171], v[64:67], a[32:35]
    v_exp_f32 v46, v46
    v_mfma_f32_16x16x32_bf16 a[48:51], a[172:175], v[64:67], a[48:51]
    v_exp_f32 v47, v47
    v_mfma_f32_16x16x32_bf16 a[36:39], a[168:171], v[68:71], a[36:39]
    s_waitcnt lgkmcnt(7)
    buffer_load_dwordx4 v219, s[16:19], s37 offen offset:3072 lds
    v_mfma_f32_16x16x32_bf16 a[52:55], a[172:175], v[68:71], a[52:55]
    v_cvt_pk_bf16_f32 v93, v46, v47
    v_mfma_f32_16x16x32_bf16 v[116:119], v[252:255], v[68:71], v[116:119]
    ds_read_b64_tr_b16 a[168:169], v202 offset:40960
    v_mfma_f32_16x16x32_bf16 v[0:3], a[136:139], v[136:139], v[0:3]
    v_exp_f32 v48, v48
    v_mfma_f32_16x16x32_bf16 v[16:19], a[152:155], v[136:139], v[16:19]
    v_exp_f32 v49, v49
    v_mfma_f32_16x16x32_bf16 v[4:7], a[136:139], v[152:155], v[4:7]
    ds_read_b64_tr_b16 a[170:171], v202 offset:41984
    v_mfma_f32_16x16x32_bf16 v[20:23], a[152:155], v[152:155], v[20:23]
    v_cvt_pk_bf16_f32 v82, v48, v49
    ds_read_b64_tr_b16 a[172:173], v203 offset:40960
    v_mfma_f32_16x16x32_bf16 v[8:11], a[136:139], v[168:171], v[8:11]
    v_exp_f32 v50, v50
    v_mfma_f32_16x16x32_bf16 v[24:27], a[152:155], v[168:171], v[24:27]
    v_exp_f32 v51, v51
    v_mfma_f32_16x16x32_bf16 v[12:15], a[136:139], v[184:187], v[12:15]
    s_add_u32 s36, s36, 128
    s_bitset0_b32 s36, 11
    v_mfma_f32_16x16x32_bf16 v[28:31], a[152:155], v[184:187], v[28:31]
    v_cvt_pk_bf16_f32 v83, v50, v51
    ds_read_b128 a[136:139], v198 offset:57344
    v_mfma_f32_16x16x32_bf16 a[76:79], a[176:179], v[76:79], a[76:79]
    v_exp_f32 v52, v52
    v_mfma_f32_16x16x32_bf16 a[92:95], a[180:183], v[76:79], a[92:95]
    v_exp_f32 v53, v53
    v_mfma_f32_16x16x32_bf16 a[64:67], a[176:179], v[64:67], a[64:67]
    ds_read_b64_tr_b16 a[174:175], v203 offset:41984
    buffer_load_dword v192, v233, s[96:99], s69 offen
    v_mfma_f32_16x16x32_bf16 a[80:83], a[180:183], v[64:67], a[80:83]
    v_cvt_pk_bf16_f32 v86, v52, v53
    ds_read_b128 a[152:155], v198 offset:58368
    v_mfma_f32_16x16x32_bf16 a[68:71], a[176:179], v[68:71], a[68:71]
    v_exp_f32 v54, v54
    v_mfma_f32_16x16x32_bf16 a[84:87], a[180:183], v[68:71], a[84:87]
    v_exp_f32 v55, v55
    v_mfma_f32_16x16x32_bf16 a[72:75], a[176:179], v[72:75], a[72:75]
    s_add_u32 s37, s37, 128
    s_bitset0_b32 s37, 11
    v_mfma_f32_16x16x32_bf16 a[88:91], a[180:183], v[72:75], a[88:91]
    v_cvt_pk_bf16_f32 v87, v54, v55
    v_mfma_f32_16x16x32_bf16 v[120:123], v[252:255], v[72:75], v[120:123]
    ds_read_b64_tr_b16 a[176:177], v204 offset:40960
    v_mfma_f32_16x16x32_bf16 v[0:3], a[140:143], v[140:143], v[0:3]
    v_exp_f32 v56, v56
    v_mfma_f32_16x16x32_bf16 v[16:19], a[156:159], v[140:143], v[16:19]
    v_exp_f32 v57, v57
    v_mfma_f32_16x16x32_bf16 v[4:7], a[140:143], v[156:159], v[4:7]
    ds_read_b64_tr_b16 a[178:179], v204 offset:41984
    v_mfma_f32_16x16x32_bf16 v[20:23], a[156:159], v[156:159], v[20:23]
    v_cvt_pk_bf16_f32 v90, v56, v57
    ds_read_b64_tr_b16 a[180:181], v205 offset:40960
    v_mfma_f32_16x16x32_bf16 v[8:11], a[140:143], v[172:175], v[8:11]
    v_exp_f32 v58, v58
    v_mfma_f32_16x16x32_bf16 v[24:27], a[156:159], v[172:175], v[24:27]
    v_exp_f32 v59, v59
    v_mfma_f32_16x16x32_bf16 v[12:15], a[140:143], v[188:191], v[12:15]
    s_add_u32 s35, s35, s100
    s_bitset0_b32 s35, s42
    v_mfma_f32_16x16x32_bf16 v[28:31], a[156:159], v[188:191], v[28:31]
    v_cvt_pk_bf16_f32 v91, v58, v59
    ds_read_b128 a[140:143], v199 offset:57344
    v_mfma_f32_16x16x32_bf16 a[96:99], a[184:187], v[64:67], a[96:99]
    v_exp_f32 v60, v60
    v_mfma_f32_16x16x32_bf16 a[112:115], a[188:191], v[64:67], a[112:115]
    v_exp_f32 v61, v61
    v_mfma_f32_16x16x32_bf16 a[100:103], a[184:187], v[68:71], a[100:103]
    ds_read_b64_tr_b16 a[182:183], v205 offset:41984
    v_mfma_f32_16x16x32_bf16 a[116:119], a[188:191], v[68:71], a[116:119]
    v_cvt_pk_bf16_f32 v94, v60, v61
    ds_read_b128 a[156:159], v199 offset:58368
    v_mfma_f32_16x16x32_bf16 a[104:107], a[184:187], v[72:75], a[104:107]
    v_exp_f32 v62, v62
    v_mfma_f32_16x16x32_bf16 a[120:123], a[188:191], v[72:75], a[120:123]
    v_exp_f32 v63, v63
    v_mfma_f32_16x16x32_bf16 a[108:111], a[184:187], v[76:79], a[108:111]
    s_waitcnt lgkmcnt(7)
    v_mfma_f32_16x16x32_bf16 a[124:127], a[188:191], v[76:79], a[124:127]
    v_cvt_pk_bf16_f32 v95, v62, v63
    v_mfma_f32_16x16x32_bf16 v[124:127], v[252:255], v[76:79], v[124:127]
    ds_read_b64_tr_b16 a[184:185], v206 offset:40960
    s_waitcnt vmcnt(23)
    s_barrier
    v_mfma_f32_16x16x32_bf16 v[32:35], a[128:131], v[128:131], v[96:99]
    v_exp_f32 v0, v0
    v_mfma_f32_16x16x32_bf16 v[48:51], a[144:147], v[128:131], v[96:99]
    v_exp_f32 v1, v1
    v_mfma_f32_16x16x32_bf16 v[36:39], a[128:131], v[144:147], v[100:103]
    ds_read_b64_tr_b16 a[186:187], v206 offset:41984
    s_add_u32 m0, s29, 81920
    v_mfma_f32_16x16x32_bf16 v[52:55], a[144:147], v[144:147], v[100:103]
    v_cvt_pk_bf16_f32 v64, v0, v1
    ds_read_b64_tr_b16 a[188:189], v207 offset:40960
    v_mfma_f32_16x16x32_bf16 v[40:43], a[128:131], v[160:163], v[104:107]
    v_exp_f32 v2, v2
    v_mfma_f32_16x16x32_bf16 v[56:59], a[144:147], v[160:163], v[104:107]
    v_exp_f32 v3, v3
    v_mfma_f32_16x16x32_bf16 v[44:47], a[128:131], v[176:179], v[108:111]
    buffer_load_dwordx4 v212, s[20:23], s35 offen offset:0 lds
    v_mfma_f32_16x16x32_bf16 v[60:63], a[144:147], v[176:179], v[108:111]
    v_cvt_pk_bf16_f32 v65, v2, v3
    v_mfma_f32_16x16x32_bf16 a[4:7], a[160:163], v[84:87], a[4:7]
    v_exp_f32 v4, v4
    v_mfma_f32_16x16x32_bf16 a[20:23], a[164:167], v[84:87], a[20:23]
    v_exp_f32 v5, v5
    v_mfma_f32_16x16x32_bf16 a[8:11], a[160:163], v[88:91], a[8:11]
    ds_read_b64_tr_b16 a[190:191], v207 offset:41984
    v_mfma_f32_16x16x32_bf16 a[24:27], a[164:167], v[88:91], a[24:27]
    v_cvt_pk_bf16_f32 v68, v4, v5
    v_mfma_f32_16x16x32_bf16 a[12:15], a[160:163], v[92:95], a[12:15]
    v_exp_f32 v6, v6
    v_mfma_f32_16x16x32_bf16 a[28:31], a[164:167], v[92:95], a[28:31]
    v_exp_f32 v7, v7
    v_mfma_f32_16x16x32_bf16 a[0:3], a[160:163], v[80:83], a[0:3]
    buffer_load_dwordx4 v213, s[20:23], s35 offen offset:1024 lds
    v_mfma_f32_16x16x32_bf16 a[16:19], a[164:167], v[80:83], a[16:19]
    v_cvt_pk_bf16_f32 v69, v6, v7
    v_mfma_f32_16x16x32_bf16 v[112:115], v[252:255], v[80:83], v[112:115]
    ds_read_b64_tr_b16 a[160:161], v200 offset:49152
    v_mfma_f32_16x16x32_bf16 v[32:35], a[132:135], v[132:135], v[32:35]
    v_exp_f32 v8, v8
    v_mfma_f32_16x16x32_bf16 v[48:51], a[148:151], v[132:135], v[48:51]
    v_exp_f32 v9, v9
    v_mfma_f32_16x16x32_bf16 v[36:39], a[132:135], v[148:151], v[36:39]
    ds_read_b64_tr_b16 a[162:163], v200 offset:50176
    v_mfma_f32_16x16x32_bf16 v[52:55], a[148:151], v[148:151], v[52:55]
    v_cvt_pk_bf16_f32 v72, v8, v9
    ds_read_b64_tr_b16 a[164:165], v201 offset:49152
    v_mfma_f32_16x16x32_bf16 v[40:43], a[132:135], v[164:167], v[40:43]
    v_exp_f32 v10, v10
    v_mfma_f32_16x16x32_bf16 v[56:59], a[148:151], v[164:167], v[56:59]
    v_exp_f32 v11, v11
    v_mfma_f32_16x16x32_bf16 v[44:47], a[132:135], v[180:183], v[44:47]
    buffer_load_dwordx4 v214, s[20:23], s35 offen offset:2048 lds
    v_mfma_f32_16x16x32_bf16 v[60:63], a[148:151], v[180:183], v[60:63]
    v_cvt_pk_bf16_f32 v73, v10, v11
    v_mfma_f32_16x16x32_bf16 a[40:43], a[168:171], v[88:91], a[40:43]
    v_exp_f32 v12, v12
    v_mfma_f32_16x16x32_bf16 a[56:59], a[172:175], v[88:91], a[56:59]
    v_exp_f32 v13, v13
    v_mfma_f32_16x16x32_bf16 a[44:47], a[168:171], v[92:95], a[44:47]
    ds_read_b64_tr_b16 a[166:167], v201 offset:50176
    v_mfma_f32_16x16x32_bf16 a[60:63], a[172:175], v[92:95], a[60:63]
    v_cvt_pk_bf16_f32 v76, v12, v13
    v_mfma_f32_16x16x32_bf16 a[32:35], a[168:171], v[80:83], a[32:35]
    v_exp_f32 v14, v14
    v_mfma_f32_16x16x32_bf16 a[48:51], a[172:175], v[80:83], a[48:51]
    v_exp_f32 v15, v15
    v_mfma_f32_16x16x32_bf16 a[36:39], a[168:171], v[84:87], a[36:39]
    s_waitcnt lgkmcnt(4)
    buffer_load_dwordx4 v215, s[20:23], s35 offen offset:3072 lds
    v_mfma_f32_16x16x32_bf16 a[52:55], a[172:175], v[84:87], a[52:55]
    v_cvt_pk_bf16_f32 v77, v14, v15
    v_mfma_f32_16x16x32_bf16 v[116:119], v[252:255], v[84:87], v[116:119]
    ds_read_b64_tr_b16 a[168:169], v202 offset:49152
    v_mfma_f32_16x16x32_bf16 v[32:35], a[136:139], v[136:139], v[32:35]
    v_exp_f32 v16, v16
    v_mfma_f32_16x16x32_bf16 v[48:51], a[152:155], v[136:139], v[48:51]
    v_exp_f32 v17, v17
    v_mfma_f32_16x16x32_bf16 v[36:39], a[136:139], v[152:155], v[36:39]
    ds_read_b64_tr_b16 a[170:171], v202 offset:50176
    v_mfma_f32_16x16x32_bf16 v[52:55], a[152:155], v[152:155], v[52:55]
    v_cvt_pk_bf16_f32 v66, v16, v17
    ds_read_b64_tr_b16 a[172:173], v203 offset:49152
    v_mfma_f32_16x16x32_bf16 v[40:43], a[136:139], v[168:171], v[40:43]
    v_exp_f32 v18, v18
    v_mfma_f32_16x16x32_bf16 v[56:59], a[152:155], v[168:171], v[56:59]
    v_exp_f32 v19, v19
    v_mfma_f32_16x16x32_bf16 v[44:47], a[136:139], v[184:187], v[44:47]
    v_mfma_f32_16x16x32_bf16 v[60:63], a[152:155], v[184:187], v[60:63]
    v_cvt_pk_bf16_f32 v67, v18, v19
    v_mfma_f32_16x16x32_bf16 a[76:79], a[176:179], v[92:95], a[76:79]
    v_exp_f32 v20, v20
    v_mfma_f32_16x16x32_bf16 a[92:95], a[180:183], v[92:95], a[92:95]
    v_exp_f32 v21, v21
    v_mfma_f32_16x16x32_bf16 a[64:67], a[176:179], v[80:83], a[64:67]
    ds_read_b64_tr_b16 a[174:175], v203 offset:50176
    v_mfma_f32_16x16x32_bf16 a[80:83], a[180:183], v[80:83], a[80:83]
    v_cvt_pk_bf16_f32 v70, v20, v21
    v_mfma_f32_16x16x32_bf16 a[68:71], a[176:179], v[84:87], a[68:71]
    v_exp_f32 v22, v22
    v_mfma_f32_16x16x32_bf16 a[84:87], a[180:183], v[84:87], a[84:87]
    v_exp_f32 v23, v23
    v_mfma_f32_16x16x32_bf16 a[72:75], a[176:179], v[88:91], a[72:75]
    v_mfma_f32_16x16x32_bf16 a[88:91], a[180:183], v[88:91], a[88:91]
    v_cvt_pk_bf16_f32 v71, v22, v23
    v_mfma_f32_16x16x32_bf16 v[120:123], v[252:255], v[88:91], v[120:123]
    ds_read_b64_tr_b16 a[176:177], v204 offset:49152
    v_mfma_f32_16x16x32_bf16 v[32:35], a[140:143], v[140:143], v[32:35]
    v_exp_f32 v24, v24
    v_mfma_f32_16x16x32_bf16 v[48:51], a[156:159], v[140:143], v[48:51]
    v_exp_f32 v25, v25
    v_mfma_f32_16x16x32_bf16 v[36:39], a[140:143], v[156:159], v[36:39]
    ds_read_b64_tr_b16 a[178:179], v204 offset:50176
    v_mfma_f32_16x16x32_bf16 v[52:55], a[156:159], v[156:159], v[52:55]
    v_cvt_pk_bf16_f32 v74, v24, v25
    ds_read_b64_tr_b16 a[180:181], v205 offset:49152
    v_mfma_f32_16x16x32_bf16 v[40:43], a[140:143], v[172:175], v[40:43]
    v_exp_f32 v26, v26
    v_mfma_f32_16x16x32_bf16 v[56:59], a[156:159], v[172:175], v[56:59]
    v_exp_f32 v27, v27
    v_mfma_f32_16x16x32_bf16 v[44:47], a[140:143], v[188:191], v[44:47]
    v_mfma_f32_16x16x32_bf16 v[60:63], a[156:159], v[188:191], v[60:63]
    v_cvt_pk_bf16_f32 v75, v26, v27
    v_mfma_f32_16x16x32_bf16 a[96:99], a[184:187], v[80:83], a[96:99]
    v_exp_f32 v28, v28
    v_mfma_f32_16x16x32_bf16 a[112:115], a[188:191], v[80:83], a[112:115]
    v_exp_f32 v29, v29
    v_mfma_f32_16x16x32_bf16 a[100:103], a[184:187], v[84:87], a[100:103]
    ds_read_b64_tr_b16 a[182:183], v205 offset:50176
    v_mfma_f32_16x16x32_bf16 a[116:119], a[188:191], v[84:87], a[116:119]
    v_cvt_pk_bf16_f32 v78, v28, v29
    v_mfma_f32_16x16x32_bf16 a[104:107], a[184:187], v[88:91], a[104:107]
    v_exp_f32 v30, v30
    v_mfma_f32_16x16x32_bf16 a[120:123], a[188:191], v[88:91], a[120:123]
    v_exp_f32 v31, v31
    v_mfma_f32_16x16x32_bf16 a[108:111], a[184:187], v[92:95], a[108:111]
    s_waitcnt lgkmcnt(4)
    v_mfma_f32_16x16x32_bf16 a[124:127], a[188:191], v[92:95], a[124:127]
    v_cvt_pk_bf16_f32 v79, v30, v31
    v_mfma_f32_16x16x32_bf16 v[124:127], v[252:255], v[92:95], v[124:127]
    ds_read_b64_tr_b16 a[184:185], v206 offset:49152
    v_exp_f32 v32, v32
    v_exp_f32 v33, v33
    ds_read_b64_tr_b16 a[186:187], v206 offset:50176
    v_cvt_pk_bf16_f32 v80, v32, v33
    ds_read_b64_tr_b16 a[188:189], v207 offset:49152
    v_exp_f32 v34, v34
    v_exp_f32 v35, v35
    s_add_u32 s35, s35, s100
    s_bitset0_b32 s35, s42
    v_cvt_pk_bf16_f32 v81, v34, v35
    v_mfma_f32_16x16x32_bf16 a[4:7], a[160:163], v[68:71], a[4:7]
    v_exp_f32 v36, v36
    v_mfma_f32_16x16x32_bf16 a[20:23], a[164:167], v[68:71], a[20:23]
    v_exp_f32 v37, v37
    v_mfma_f32_16x16x32_bf16 a[8:11], a[160:163], v[72:75], a[8:11]
    ds_read_b64_tr_b16 a[190:191], v207 offset:50176
    v_mfma_f32_16x16x32_bf16 a[24:27], a[164:167], v[72:75], a[24:27]
    v_cvt_pk_bf16_f32 v84, v36, v37
    v_mfma_f32_16x16x32_bf16 a[12:15], a[160:163], v[76:79], a[12:15]
    v_exp_f32 v38, v38
    v_mfma_f32_16x16x32_bf16 a[28:31], a[164:167], v[76:79], a[28:31]
    v_exp_f32 v39, v39
    v_mfma_f32_16x16x32_bf16 a[0:3], a[160:163], v[64:67], a[0:3]
    v_mfma_f32_16x16x32_bf16 a[16:19], a[164:167], v[64:67], a[16:19]
    v_cvt_pk_bf16_f32 v85, v38, v39
    v_mfma_f32_16x16x32_bf16 v[112:115], v[252:255], v[64:67], v[112:115]
    ds_read_b64_tr_b16 a[160:161], v200 offset:57344
    v_exp_f32 v40, v40
    v_exp_f32 v41, v41
    ds_read_b64_tr_b16 a[162:163], v200 offset:58368
    v_cvt_pk_bf16_f32 v88, v40, v41
    ds_read_b64_tr_b16 a[164:165], v201 offset:57344
    v_exp_f32 v42, v42
    v_exp_f32 v43, v43
    s_nop 0
    v_cvt_pk_bf16_f32 v89, v42, v43
    v_mfma_f32_16x16x32_bf16 a[40:43], a[168:171], v[72:75], a[40:43]
    v_exp_f32 v44, v44
    v_mfma_f32_16x16x32_bf16 a[56:59], a[172:175], v[72:75], a[56:59]
    v_exp_f32 v45, v45
    v_mfma_f32_16x16x32_bf16 a[44:47], a[168:171], v[76:79], a[44:47]
    ds_read_b64_tr_b16 a[166:167], v201 offset:58368
    v_mfma_f32_16x16x32_bf16 a[60:63], a[172:175], v[76:79], a[60:63]
    v_cvt_pk_bf16_f32 v92, v44, v45
    v_mfma_f32_16x16x32_bf16 a[32:35], a[168:171], v[64:67], a[32:35]
    v_exp_f32 v46, v46
    v_mfma_f32_16x16x32_bf16 a[48:51], a[172:175], v[64:67], a[48:51]
    v_exp_f32 v47, v47
    v_mfma_f32_16x16x32_bf16 a[36:39], a[168:171], v[68:71], a[36:39]
    s_waitcnt lgkmcnt(4)
    v_mfma_f32_16x16x32_bf16 a[52:55], a[172:175], v[68:71], a[52:55]
    v_cvt_pk_bf16_f32 v93, v46, v47
    v_mfma_f32_16x16x32_bf16 v[116:119], v[252:255], v[68:71], v[116:119]
    ds_read_b64_tr_b16 a[168:169], v202 offset:57344
    v_exp_f32 v48, v48
    v_exp_f32 v49, v49
    ds_read_b64_tr_b16 a[170:171], v202 offset:58368
    v_cvt_pk_bf16_f32 v82, v48, v49
    ds_read_b64_tr_b16 a[172:173], v203 offset:57344
    v_exp_f32 v50, v50
    v_exp_f32 v51, v51
    s_nop 0
    v_cvt_pk_bf16_f32 v83, v50, v51
    v_mfma_f32_16x16x32_bf16 a[76:79], a[176:179], v[76:79], a[76:79]
    v_exp_f32 v52, v52
    v_mfma_f32_16x16x32_bf16 a[92:95], a[180:183], v[76:79], a[92:95]
    v_exp_f32 v53, v53
    v_mfma_f32_16x16x32_bf16 a[64:67], a[176:179], v[64:67], a[64:67]
    ds_read_b64_tr_b16 a[174:175], v203 offset:58368
    v_mfma_f32_16x16x32_bf16 a[80:83], a[180:183], v[64:67], a[80:83]
    v_cvt_pk_bf16_f32 v86, v52, v53
    v_mfma_f32_16x16x32_bf16 a[68:71], a[176:179], v[68:71], a[68:71]
    v_exp_f32 v54, v54
    v_mfma_f32_16x16x32_bf16 a[84:87], a[180:183], v[68:71], a[84:87]
    v_exp_f32 v55, v55
    v_mfma_f32_16x16x32_bf16 a[72:75], a[176:179], v[72:75], a[72:75]
    v_mfma_f32_16x16x32_bf16 a[88:91], a[180:183], v[72:75], a[88:91]
    v_cvt_pk_bf16_f32 v87, v54, v55
    v_mfma_f32_16x16x32_bf16 v[120:123], v[252:255], v[72:75], v[120:123]
    ds_read_b64_tr_b16 a[176:177], v204 offset:57344
    v_exp_f32 v56, v56
    v_exp_f32 v57, v57
    ds_read_b64_tr_b16 a[178:179], v204 offset:58368
    v_cvt_pk_bf16_f32 v90, v56, v57
    ds_read_b64_tr_b16 a[180:181], v205 offset:57344
    v_exp_f32 v58, v58
    v_exp_f32 v59, v59
    s_nop 0
    v_cvt_pk_bf16_f32 v91, v58, v59
    v_mfma_f32_16x16x32_bf16 a[96:99], a[184:187], v[64:67], a[96:99]
    v_exp_f32 v60, v60
    v_mfma_f32_16x16x32_bf16 a[112:115], a[188:191], v[64:67], a[112:115]
    v_exp_f32 v61, v61
    v_mfma_f32_16x16x32_bf16 a[100:103], a[184:187], v[68:71], a[100:103]
    ds_read_b64_tr_b16 a[182:183], v205 offset:58368
    v_mfma_f32_16x16x32_bf16 a[116:119], a[188:191], v[68:71], a[116:119]
    v_cvt_pk_bf16_f32 v94, v60, v61
    v_mfma_f32_16x16x32_bf16 a[104:107], a[184:187], v[72:75], a[104:107]
    v_exp_f32 v62, v62
    v_mfma_f32_16x16x32_bf16 a[120:123], a[188:191], v[72:75], a[120:123]
    v_exp_f32 v63, v63
    v_mfma_f32_16x16x32_bf16 a[108:111], a[184:187], v[76:79], a[108:111]
    s_waitcnt lgkmcnt(12)
    v_mfma_f32_16x16x32_bf16 a[124:127], a[188:191], v[76:79], a[124:127]
    v_cvt_pk_bf16_f32 v95, v62, v63
    v_mfma_f32_16x16x32_bf16 v[124:127], v[252:255], v[76:79], v[124:127]
    ds_read_b64_tr_b16 a[184:185], v206 offset:57344
    s_waitcnt vmcnt(13)
    s_barrier
    s_mov_b32 s40, 131072
    s_mov_b32 s41, 0
    s_mov_b32 s42, 32768
    s_mov_b32 s43, 0
    s_add_u32 s39, s29, 114688
    v_mov_b32 v224, v200
    v_mov_b32 v225, v201
    v_mov_b32 v226, v202
    v_mov_b32 v227, v203
    v_mov_b32 v228, v204
    v_mov_b32 v229, v205
    v_mov_b32 v230, v206
    v_mov_b32 v231, v207
    v_add_u32 v222, 131072, v220
    v_add_u32 v223, 131072, v221
    s_waitcnt lgkmcnt(0)
    ds_read_b64_tr_b16 a[186:187], v206 offset:58368
    ds_read_b64_tr_b16 a[188:189], v207 offset:57344
    ds_read_b128 a[192:195], v222 offset:0
    v_mfma_f32_16x16x32_bf16 a[4:7], a[160:163], v[84:87], a[4:7]
    v_mfma_f32_16x16x32_bf16 a[20:23], a[164:167], v[84:87], a[20:23]
    v_mfma_f32_16x16x32_bf16 a[8:11], a[160:163], v[88:91], a[8:11]
    ds_read_b64_tr_b16 a[190:191], v207 offset:58368
    v_mfma_f32_16x16x32_bf16 a[24:27], a[164:167], v[88:91], a[24:27]
    v_mfma_f32_16x16x32_bf16 a[12:15], a[160:163], v[92:95], a[12:15]
    v_mfma_f32_16x16x32_bf16 a[28:31], a[164:167], v[92:95], a[28:31]
    ds_read_b128 a[196:199], v222 offset:2048
    v_mfma_f32_16x16x32_bf16 a[0:3], a[160:163], v[80:83], a[0:3]
    v_mfma_f32_16x16x32_bf16 a[16:19], a[164:167], v[80:83], a[16:19]
    v_mfma_f32_16x16x32_bf16 v[112:115], v[252:255], v[80:83], v[112:115]
    ds_read_b64_tr_b16 a[160:161], v224 offset:0
    ds_read_b64_tr_b16 a[162:163], v224 offset:1024
    ds_read_b64_tr_b16 a[164:165], v225 offset:0
    ds_read_b64_tr_b16 a[166:167], v225 offset:1024
    ds_read_b128 a[200:203], v222 offset:4096
    v_mfma_f32_16x16x32_bf16 a[40:43], a[168:171], v[88:91], a[40:43]
    v_mfma_f32_16x16x32_bf16 a[56:59], a[172:175], v[88:91], a[56:59]
    v_mfma_f32_16x16x32_bf16 a[44:47], a[168:171], v[92:95], a[44:47]
    v_mfma_f32_16x16x32_bf16 a[60:63], a[172:175], v[92:95], a[60:63]
    v_mfma_f32_16x16x32_bf16 a[32:35], a[168:171], v[80:83], a[32:35]
    v_mfma_f32_16x16x32_bf16 a[48:51], a[172:175], v[80:83], a[48:51]
    ds_read_b128 a[204:207], v222 offset:6144
    v_mfma_f32_16x16x32_bf16 a[36:39], a[168:171], v[84:87], a[36:39]
    v_mfma_f32_16x16x32_bf16 a[52:55], a[172:175], v[84:87], a[52:55]
    v_mfma_f32_16x16x32_bf16 v[116:119], v[252:255], v[84:87], v[116:119]
    ds_read_b64_tr_b16 a[168:169], v226 offset:0
    ds_read_b64_tr_b16 a[170:171], v226 offset:1024
    ds_read_b64_tr_b16 a[172:173], v227 offset:0
    ds_read_b64_tr_b16 a[174:175], v227 offset:1024
    ds_write_b128 v250, v[246:249] offset:63488
    v_mfma_f32_16x16x32_bf16 a[76:79], a[176:179], v[92:95], a[76:79]
    v_mfma_f32_16x16x32_bf16 a[92:95], a[180:183], v[92:95], a[92:95]
    v_mfma_f32_16x16x32_bf16 a[64:67], a[176:179], v[80:83], a[64:67]
    v_mfma_f32_16x16x32_bf16 a[80:83], a[180:183], v[80:83], a[80:83]
    v_mfma_f32_16x16x32_bf16 a[68:71], a[176:179], v[84:87], a[68:71]
    v_mfma_f32_16x16x32_bf16 a[84:87], a[180:183], v[84:87], a[84:87]
    ds_write_b128 v250, v[246:249] offset:64512
    v_mfma_f32_16x16x32_bf16 a[72:75], a[176:179], v[88:91], a[72:75]
    v_mfma_f32_16x16x32_bf16 a[88:91], a[180:183], v[88:91], a[88:91]
    v_mfma_f32_16x16x32_bf16 v[120:123], v[252:255], v[88:91], v[120:123]
    ds_read_b64_tr_b16 a[176:177], v228 offset:0
    ds_read_b64_tr_b16 a[178:179], v228 offset:1024
    ds_read_b64_tr_b16 a[180:181], v229 offset:0
    ds_read_b64_tr_b16 a[182:183], v229 offset:1024
    s_waitcnt lgkmcnt(15)
    v_mfma_f32_16x16x32_bf16 a[96:99], a[184:187], v[80:83], a[96:99]
    v_mfma_f32_16x16x32_bf16 a[112:115], a[188:191], v[80:83], a[112:115]
    v_mfma_f32_16x16x32_bf16 a[100:103], a[184:187], v[84:87], a[100:103]
    v_mfma_f32_16x16x32_bf16 a[116:119], a[188:191], v[84:87], a[116:119]
    v_mfma_f32_16x16x32_bf16 a[104:107], a[184:187], v[88:91], a[104:107]
    v_mfma_f32_16x16x32_bf16 a[120:123], a[188:191], v[88:91], a[120:123]
    v_mfma_f32_16x16x32_bf16 a[108:111], a[184:187], v[92:95], a[108:111]
    v_mfma_f32_16x16x32_bf16 a[124:127], a[188:191], v[92:95], a[124:127]
    v_mfma_f32_16x16x32_bf16 v[124:127], v[252:255], v[92:95], v[124:127]
    ds_read_b64_tr_b16 a[184:185], v230 offset:0
    ds_read_b64_tr_b16 a[186:187], v230 offset:1024
    ds_read_b64_tr_b16 a[188:189], v231 offset:0
    ds_read_b64_tr_b16 a[190:191], v231 offset:1024
L_w3e_A:
    s_nop 7
    s_mov_b32 s70, 0x33800000
    s_mov_b32 s71, 0x4b800000
    s_mov_b64 s[72:73], 0
    v_cmp_nle_f32 vcc, s70, v112
    s_or_b64 s[72:73], s[72:73], vcc
    v_cmp_nge_f32 vcc, s71, v112
    s_or_b64 s[72:73], s[72:73], vcc
    v_cmp_nle_f32 vcc, s70, v116
    s_or_b64 s[72:73], s[72:73], vcc
    v_cmp_nge_f32 vcc, s71, v116
    s_or_b64 s[72:73], s[72:73], vcc
    v_cmp_nle_f32 vcc, s70, v120
    s_or_b64 s[72:73], s[72:73], vcc
    v_cmp_nge_f32 vcc, s71, v120
    s_or_b64 s[72:73], s[72:73], vcc
    s_cmp_eq_u32 s28, 3
    s_cbranch_scc1 L_k1_chk3
    v_cmp_nle_f32 vcc, s70, v124
    s_or_b64 s[72:73], s[72:73], vcc
    v_cmp_nge_f32 vcc, s71, v124
    s_or_b64 s[72:73], s[72:73], vcc
L_k1_chk3:
    s_cmp_lg_u64 s[72:73], 0
    s_cselect_b32 s70, 1, 0
    v_mov_b32 v237, s70
    s_lshl_b32 s71, s28, 2
    s_add_u32 s71, s71, 161792
    v_mov_b32 v238, s71
    s_nop 0
    ds_write_b32 v238, v237
    v_rcp_f32 v232, v112
    v_rcp_f32 v233, v116
    v_rcp_f32 v234, v120
    v_rcp_f32 v235, v124
    s_mul_i32 s74, s45, 7864320
    s_cmp_eq_u32 s45, 0
    s_cselect_b32 s26, 0, 31457280
    s_waitcnt lgkmcnt(0)
    s_barrier
    v_mov_b32 v238, 161792
    s_nop 0
    ds_read_b128 v[240:243], v238
    s_cmp_eq_u32 s45, 1
    s_cbranch_scc0 L_k1_nopre
    v_readlane_b32 s70, v244, s101
    v_readlane_b32 s71, v244, s59
    s_min_u32 s70, s70, s71
    s_cmp_ge_u32 s70, 16
    s_cbranch_scc0 L_k2_spin0
L_k2_go0:
    s_mov_b32 s36, 0
    s_mov_b32 s37, 122880
    s_add_u32 s41, s68, 0
    s_and_b32 s41, s41, 3
    s_or_b32 s41, s41, 0
    s_mul_i32 s36, s41, 245760
    s_add_u32 s37, s36, 122880
    buffer_load_dwordx4 v[0:3], v193, s[24:27], s36 offen offset:0 sc1
    buffer_load_dwordx4 v[4:7], v193, s[24:27], s36 offen offset:256 sc1
    buffer_load_dwordx4 v[8:11], v193, s[24:27], s37 offen offset:0 sc1
    buffer_load_dwordx4 v[12:15], v193, s[24:27], s37 offen offset:256 sc1
    s_add_u32 s41, s68, 1
    s_and_b32 s41, s41, 3
    s_or_b32 s41, s41, 0
    s_mul_i32 s36, s41, 245760
    s_add_u32 s37, s36, 122880
    buffer_load_dwordx4 v[16:19], v193, s[24:27], s36 offen offset:0 sc1
    buffer_load_dwordx4 v[20:23], v193, s[24:27], s36 offen offset:256 sc1
    buffer_load_dwordx4 v[24:27], v193, s[24:27], s37 offen offset:0 sc1
    buffer_load_dwordx4 v[28:31], v193, s[24:27], s37 offen offset:256 sc1
    s_add_u32 m0, s29, 98304
    s_nop 0
    buffer_load_dwordx4 v212, s[20:23], s35 offen offset:0 lds
    buffer_load_dwordx4 v213, s[20:23], s35 offen offset:1024 lds
    buffer_load_dwordx4 v214, s[20:23], s35 offen offset:2048 lds
    buffer_load_dwordx4 v215, s[20:23], s35 offen offset:3072 lds
    s_add_u32 s35, s35, 131072
    s_bitset0_b32 s35, 19
    s_add_u32 s41, s68, 2
    s_and_b32 s41, s41, 3
    s_or_b32 s41, s41, 0
    s_mul_i32 s36, s41, 245760
    s_add_u32 s37, s36, 122880
    buffer_load_dwordx4 v[32:35], v193, s[24:27], s36 offen offset:0 sc1
    buffer_load_dwordx4 v[36:39], v193, s[24:27], s36 offen offset:256 sc1
    buffer_load_dwordx4 v[40:43], v193, s[24:27], s37 offen offset:0 sc1
    buffer_load_dwordx4 v[44:47], v193, s[24:27], s37 offen offset:256 sc1
    s_add_u32 m0, s29, 114688
    s_nop 0
    buffer_load_dwordx4 v212, s[20:23], s35 offen offset:0 lds
    buffer_load_dwordx4 v213, s[20:23], s35 offen offset:1024 lds
    buffer_load_dwordx4 v214, s[20:23], s35 offen offset:2048 lds
    buffer_load_dwordx4 v215, s[20:23], s35 offen offset:3072 lds
    s_add_u32 s35, s35, 131072
    s_bitset0_b32 s35, 19
    s_add_u32 s41, s68, 3
    s_and_b32 s41, s41, 3
    s_or_b32 s41, s41, 0
    s_mul_i32 s36, s41, 245760
    s_add_u32 s37, s36, 122880
    buffer_load_dwordx4 v[48:51], v193, s[24:27], s36 offen offset:0 sc1
    buffer_load_dwordx4 v[52:55], v193, s[24:27], s36 offen offset:256 sc1
    buffer_load_dwordx4 v[56:59], v193, s[24:27], s37 offen offset:0 sc1
    buffer_load_dwordx4 v[60:63], v193, s[24:27], s37 offen offset:256 sc1
    s_mov_b32 s40, 3
L_k1_nopre:
    s_waitcnt lgkmcnt(0)
    v_or_b32 v240, v240, v241
    v_or_b32 v242, v242, v243
    v_or_b32 v240, v240, v242
    s_nop 0
    v_readfirstlane_b32 s70, v240
    s_cmp_eq_u32 s46, 0
    s_cselect_b32 s70, s70, 0
    s_cmp_lg_u32 s70, 0
    s_cbranch_scc1 L_k1_redo
    v_accvgpr_read_b32 v240, a0
    v_accvgpr_read_b32 v241, a1
    v_accvgpr_read_b32 v242, a2
    v_accvgpr_read_b32 v243, a3
    v_accvgpr_read_b32 v244, a16
    v_accvgpr_read_b32 v245, a17
    v_accvgpr_read_b32 v246, a18
    v_accvgpr_read_b32 v247, a19
    v_mul_f32 v240, v232, v240
    v_mul_f32 v241, v232, v241
    v_mul_f32 v242, v232, v242
    v_mul_f32 v243, v232, v243
    v_mul_f32 v244, v232, v244
    v_mul_f32 v245, v232, v245
    v_mul_f32 v246, v232, v246
    v_mul_f32 v247, v232, v247
    v_cvt_pk_bf16_f32 v128, v240, v241
    v_cvt_pk_bf16_f32 v129, v242, v243
    v_cvt_pk_bf16_f32 v130, v244, v245
    v_cvt_pk_bf16_f32 v131, v246, v247
    s_add_u32 s70, s74, 0
    buffer_store_dwordx4 v[128:131], v236, s[24:27], s70 offen offset:0 sc1
    v_accvgpr_read_b32 v248, a32
    v_accvgpr_read_b32 v249, a33
    v_accvgpr_read_b32 v250, a34
    v_accvgpr_read_b32 v251, a35
    v_accvgpr_read_b32 v252, a48
    v_accvgpr_read_b32 v253, a49
    v_accvgpr_read_b32 v254, a50
    v_accvgpr_read_b32 v255, a51
    v_mul_f32 v248, v232, v248
    v_mul_f32 v249, v232, v249
    v_mul_f32 v250, v232, v250
    v_mul_f32 v251, v232, v251
    v_mul_f32 v252, v232, v252
    v_mul_f32 v253, v232, v253
    v_mul_f32 v254, v232, v254
    v_mul_f32 v255, v232, v255
    v_cvt_pk_bf16_f32 v132, v248, v249
    v_cvt_pk_bf16_f32 v133, v250, v251
    v_cvt_pk_bf16_f32 v134, v252, v253
    v_cvt_pk_bf16_f32 v135, v254, v255
    s_add_u32 s70, s74, 122880
    buffer_store_dwordx4 v[132:135], v236, s[24:27], s70 offen offset:0 sc1
    v_accvgpr_read_b32 v240, a64
    v_accvgpr_read_b32 v241, a65
    v_accvgpr_read_b32 v242, a66
    v_accvgpr_read_b32 v243, a67
    v_accvgpr_read_b32 v244, a80
    v_accvgpr_read_b32 v245, a81
    v_accvgpr_read_b32 v246, a82
    v_accvgpr_read_b32 v247, a83
    v_mul_f32 v240, v232, v240
    v_mul_f32 v241, v232, v241
    v_mul_f32 v242, v232, v242
    v_mul_f32 v243, v232, v243
    v_mul_f32 v244, v232, v244
    v_mul_f32 v245, v232, v245
    v_mul_f32 v246, v232, v246
    v_mul_f32 v247, v232, v247
    v_cvt_pk_bf16_f32 v136, v240, v241
    v_cvt_pk_bf16_f32 v137, v242, v243
    v_cvt_pk_bf16_f32 v138, v244, v245
    v_cvt_pk_bf16_f32 v139, v246, v247
    s_add_u32 s70, s74, 245760
    buffer_store_dwordx4 v[136:139], v236, s[24:27], s70 offen offset:0 sc1
    v_accvgpr_read_b32 v248, a96
    v_accvgpr_read_b32 v249, a97
    v_accvgpr_read_b32 v250, a98
    v_accvgpr_read_b32 v251, a99
    v_accvgpr_read_b32 v252, a112
    v_accvgpr_read_b32 v253, a113
    v_accvgpr_read_b32 v254, a114
    v_accvgpr_read_b32 v255, a115
    v_mul_f32 v248, v232, v248
    v_mul_f32 v249, v232, v249
    v_mul_f32 v250, v232, v250
    v_mul_f32 v251, v232, v251
    v_mul_f32 v252, v232, v252
    v_mul_f32 v253, v232, v253
    v_mul_f32 v254, v232, v254
    v_mul_f32 v255, v232, v255
    v_cvt_pk_bf16_f32 v140, v248, v249
    v_cvt_pk_bf16_f32 v141, v250, v251
    v_cvt_pk_bf16_f32 v142, v252, v253
    v_cvt_pk_bf16_f32 v143, v254, v255
    s_add_u32 s70, s74, 368640
    buffer_store_dwordx4 v[140:143], v236, s[24:27], s70 offen offset:0 sc1
    v_accvgpr_read_b32 v240, a4
    v_accvgpr_read_b32 v241, a5
    v_accvgpr_read_b32 v242, a6
    v_accvgpr_read_b32 v243, a7
    v_accvgpr_read_b32 v244, a20
    v_accvgpr_read_b32 v245, a21
    v_accvgpr_read_b32 v246, a22
    v_accvgpr_read_b32 v247, a23
    v_mul_f32 v240, v233, v240
    v_mul_f32 v241, v233, v241
    v_mul_f32 v242, v233, v242
    v_mul_f32 v243, v233, v243
    v_mul_f32 v244, v233, v244
    v_mul_f32 v245, v233, v245
    v_mul_f32 v246, v233, v246
    v_mul_f32 v247, v233, v247
    v_cvt_pk_bf16_f32 v144, v240, v241
    v_cvt_pk_bf16_f32 v145, v242, v243
    v_cvt_pk_bf16_f32 v146, v244, v245
    v_cvt_pk_bf16_f32 v147, v246, v247
    s_add_u32 s70, s74, 0
    buffer_store_dwordx4 v[144:147], v236, s[24:27], s70 offen offset:256 sc1
    v_accvgpr_read_b32 v248, a36
    v_accvgpr_read_b32 v249, a37
    v_accvgpr_read_b32 v250, a38
    v_accvgpr_read_b32 v251, a39
    v_accvgpr_read_b32 v252, a52
    v_accvgpr_read_b32 v253, a53
    v_accvgpr_read_b32 v254, a54
    v_accvgpr_read_b32 v255, a55
    v_mul_f32 v248, v233, v248
    v_mul_f32 v249, v233, v249
    v_mul_f32 v250, v233, v250
    v_mul_f32 v251, v233, v251
    v_mul_f32 v252, v233, v252
    v_mul_f32 v253, v233, v253
    v_mul_f32 v254, v233, v254
    v_mul_f32 v255, v233, v255
    v_cvt_pk_bf16_f32 v148, v248, v249
    v_cvt_pk_bf16_f32 v149, v250, v251
    v_cvt_pk_bf16_f32 v150, v252, v253
    v_cvt_pk_bf16_f32 v151, v254, v255
    s_add_u32 s70, s74, 122880
    buffer_store_dwordx4 v[148:151], v236, s[24:27], s70 offen offset:256 sc1
    v_accvgpr_read_b32 v240, a68
    v_accvgpr_read_b32 v241, a69
    v_accvgpr_read_b32 v242, a70
    v_accvgpr_read_b32 v243, a71
    v_accvgpr_read_b32 v244, a84
    v_accvgpr_read_b32 v245, a85
    v_accvgpr_read_b32 v246, a86
    v_accvgpr_read_b32 v247, a87
    v_mul_f32 v240, v233, v240
    v_mul_f32 v241, v233, v241
    v_mul_f32 v242, v233, v242
    v_mul_f32 v243, v233, v243
    v_mul_f32 v244, v233, v244
    v_mul_f32 v245, v233, v245
    v_mul_f32 v246, v233, v246
    v_mul_f32 v247, v233, v247
    v_cvt_pk_bf16_f32 v152, v240, v241
    v_cvt_pk_bf16_f32 v153, v242, v243
    v_cvt_pk_bf16_f32 v154, v244, v245
    v_cvt_pk_bf16_f32 v155, v246, v247
    s_add_u32 s70, s74, 245760
    buffer_store_dwordx4 v[152:155], v236, s[24:27], s70 offen offset:256 sc1
    v_accvgpr_read_b32 v248, a100
    v_accvgpr_read_b32 v249, a101
    v_accvgpr_read_b32 v250, a102
    v_accvgpr_read_b32 v251, a103
    v_accvgpr_read_b32 v252, a116
    v_accvgpr_read_b32 v253, a117
    v_accvgpr_read_b32 v254, a118
    v_accvgpr_read_b32 v255, a119
    v_mul_f32 v248, v233, v248
    v_mul_f32 v249, v233, v249
    v_mul_f32 v250, v233, v250
    v_mul_f32 v251, v233, v251
    v_mul_f32 v252, v233, v252
    v_mul_f32 v253, v233, v253
    v_mul_f32 v254, v233, v254
    v_mul_f32 v255, v233, v255
    v_cvt_pk_bf16_f32 v156, v248, v249
    v_cvt_pk_bf16_f32 v157, v250, v251
    v_cvt_pk_bf16_f32 v158, v252, v253
    v_cvt_pk_bf16_f32 v159, v254, v255
    s_add_u32 s70, s74, 368640
    buffer_store_dwordx4 v[156:159], v236, s[24:27], s70 offen offset:256 sc1
    v_accvgpr_read_b32 v240, a8
    v_accvgpr_read_b32 v241, a9
    v_accvgpr_read_b32 v242, a10
    v_accvgpr_read_b32 v243, a11
    v_accvgpr_read_b32 v244, a24
    v_accvgpr_read_b32 v245, a25
    v_accvgpr_read_b32 v246, a26
    v_accvgpr_read_b32 v247, a27
    v_mul_f32 v240, v234, v240
    v_mul_f32 v241, v234, v241
    v_mul_f32 v242, v234, v242
    v_mul_f32 v243, v234, v243
    v_mul_f32 v244, v234, v244
    v_mul_f32 v245, v234, v245
    v_mul_f32 v246, v234, v246
    v_mul_f32 v247, v234, v247
    v_cvt_pk_bf16_f32 v160, v240, v241
    v_cvt_pk_bf16_f32 v161, v242, v243
    v_cvt_pk_bf16_f32 v162, v244, v245
    v_cvt_pk_bf16_f32 v163, v246, v247
    s_add_u32 s70, s74, 0
    buffer_store_dwordx4 v[160:163], v236, s[24:27], s70 offen offset:512 sc1
    v_accvgpr_read_b32 v248, a40
    v_accvgpr_read_b32 v249, a41
    v_accvgpr_read_b32 v250, a42
    v_accvgpr_read_b32 v251, a43
    v_accvgpr_read_b32 v252, a56
    v_accvgpr_read_b32 v253, a57
    v_accvgpr_read_b32 v254, a58
    v_accvgpr_read_b32 v255, a59
    v_mul_f32 v248, v234, v248
    v_mul_f32 v249, v234, v249
    v_mul_f32 v250, v234, v250
    v_mul_f32 v251, v234, v251
    v_mul_f32 v252, v234, v252
    v_mul_f32 v253, v234, v253
    v_mul_f32 v254, v234, v254
    v_mul_f32 v255, v234, v255
    v_cvt_pk_bf16_f32 v164, v248, v249
    v_cvt_pk_bf16_f32 v165, v250, v251
    v_cvt_pk_bf16_f32 v166, v252, v253
    v_cvt_pk_bf16_f32 v167, v254, v255
    s_add_u32 s70, s74, 122880
    buffer_store_dwordx4 v[164:167], v236, s[24:27], s70 offen offset:512 sc1
    v_accvgpr_read_b32 v240, a72
    v_accvgpr_read_b32 v241, a73
    v_accvgpr_read_b32 v242, a74
    v_accvgpr_read_b32 v243, a75
    v_accvgpr_read_b32 v244, a88
    v_accvgpr_read_b32 v245, a89
    v_accvgpr_read_b32 v246, a90
    v_accvgpr_read_b32 v247, a91
    v_mul_f32 v240, v234, v240
    v_mul_f32 v241, v234, v241
    v_mul_f32 v242, v234, v242
    v_mul_f32 v243, v234, v243
    v_mul_f32 v244, v234, v244
    v_mul_f32 v245, v234, v245
    v_mul_f32 v246, v234, v246
    v_mul_f32 v247, v234, v247
    v_cvt_pk_bf16_f32 v168, v240, v241
    v_cvt_pk_bf16_f32 v169, v242, v243
    v_cvt_pk_bf16_f32 v170, v244, v245
    v_cvt_pk_bf16_f32 v171, v246, v247
    s_add_u32 s70, s74, 245760
    buffer_store_dwordx4 v[168:171], v236, s[24:27], s70 offen offset:512 sc1
    v_accvgpr_read_b32 v248, a104
    v_accvgpr_read_b32 v249, a105
    v_accvgpr_read_b32 v250, a106
    v_accvgpr_read_b32 v251, a107
    v_accvgpr_read_b32 v252, a120
    v_accvgpr_read_b32 v253, a121
    v_accvgpr_read_b32 v254, a122
    v_accvgpr_read_b32 v255, a123
    v_mul_f32 v248, v234, v248
    v_mul_f32 v249, v234, v249
    v_mul_f32 v250, v234, v250
    v_mul_f32 v251, v234, v251
    v_mul_f32 v252, v234, v252
    v_mul_f32 v253, v234, v253
    v_mul_f32 v254, v234, v254
    v_mul_f32 v255, v234, v255
    v_cvt_pk_bf16_f32 v172, v248, v249
    v_cvt_pk_bf16_f32 v173, v250, v251
    v_cvt_pk_bf16_f32 v174, v252, v253
    v_cvt_pk_bf16_f32 v175, v254, v255
    s_add_u32 s70, s74, 368640
    buffer_store_dwordx4 v[172:175], v236, s[24:27], s70 offen offset:512 sc1
    s_cmp_eq_u32 s28, 3
    s_cbranch_scc1 L_k1_epi_done
    v_accvgpr_read_b32 v240, a12
    v_accvgpr_read_b32 v241, a13
    v_accvgpr_read_b32 v242, a14
    v_accvgpr_read_b32 v243, a15
    v_accvgpr_read_b32 v244, a28
    v_accvgpr_read_b32 v245, a29
    v_accvgpr_read_b32 v246, a30
    v_accvgpr_read_b32 v247, a31
    v_mul_f32 v240, v235, v240
    v_mul_f32 v241, v235, v241
    v_mul_f32 v242, v235, v242
    v_mul_f32 v243, v235, v243
    v_mul_f32 v244, v235, v244
    v_mul_f32 v245, v235, v245
    v_mul_f32 v246, v235, v246
    v_mul_f32 v247, v235, v247
    v_cvt_pk_bf16_f32 v176, v240, v241
    v_cvt_pk_bf16_f32 v177, v242, v243
    v_cvt_pk_bf16_f32 v178, v244, v245
    v_cvt_pk_bf16_f32 v179, v246, v247
    s_add_u32 s70, s74, 0
    buffer_store_dwordx4 v[176:179], v236, s[24:27], s70 offen offset:768 sc1
    v_accvgpr_read_b32 v248, a44
    v_accvgpr_read_b32 v249, a45
    v_accvgpr_read_b32 v250, a46
    v_accvgpr_read_b32 v251, a47
    v_accvgpr_read_b32 v252, a60
    v_accvgpr_read_b32 v253, a61
    v_accvgpr_read_b32 v254, a62
    v_accvgpr_read_b32 v255, a63
    v_mul_f32 v248, v235, v248
    v_mul_f32 v249, v235, v249
    v_mul_f32 v250, v235, v250
    v_mul_f32 v251, v235, v251
    v_mul_f32 v252, v235, v252
    v_mul_f32 v253, v235, v253
    v_mul_f32 v254, v235, v254
    v_mul_f32 v255, v235, v255
    v_cvt_pk_bf16_f32 v180, v248, v249
    v_cvt_pk_bf16_f32 v181, v250, v251
    v_cvt_pk_bf16_f32 v182, v252, v253
    v_cvt_pk_bf16_f32 v183, v254, v255
    s_add_u32 s70, s74, 122880
    buffer_store_dwordx4 v[180:183], v236, s[24:27], s70 offen offset:768 sc1
    v_accvgpr_read_b32 v240, a76
    v_accvgpr_read_b32 v241, a77
    v_accvgpr_read_b32 v242, a78
    v_accvgpr_read_b32 v243, a79
    v_accvgpr_read_b32 v244, a92
    v_accvgpr_read_b32 v245, a93
    v_accvgpr_read_b32 v246, a94
    v_accvgpr_read_b32 v247, a95
    v_mul_f32 v240, v235, v240
    v_mul_f32 v241, v235, v241
    v_mul_f32 v242, v235, v242
    v_mul_f32 v243, v235, v243
    v_mul_f32 v244, v235, v244
    v_mul_f32 v245, v235, v245
    v_mul_f32 v246, v235, v246
    v_mul_f32 v247, v235, v247
    v_cvt_pk_bf16_f32 v184, v240, v241
    v_cvt_pk_bf16_f32 v185, v242, v243
    v_cvt_pk_bf16_f32 v186, v244, v245
    v_cvt_pk_bf16_f32 v187, v246, v247
    s_add_u32 s70, s74, 245760
    buffer_store_dwordx4 v[184:187], v236, s[24:27], s70 offen offset:768 sc1
    v_accvgpr_read_b32 v248, a108
    v_accvgpr_read_b32 v249, a109
    v_accvgpr_read_b32 v250, a110
    v_accvgpr_read_b32 v251, a111
    v_accvgpr_read_b32 v252, a124
    v_accvgpr_read_b32 v253, a125
    v_accvgpr_read_b32 v254, a126
    v_accvgpr_read_b32 v255, a127
    v_mul_f32 v248, v235, v248
    v_mul_f32 v249, v235, v249
    v_mul_f32 v250, v235, v250
    v_mul_f32 v251, v235, v251
    v_mul_f32 v252, v235, v252
    v_mul_f32 v253, v235, v253
    v_mul_f32 v254, v235, v254
    v_mul_f32 v255, v235, v255
    v_cvt_pk_bf16_f32 v188, v248, v249
    v_cvt_pk_bf16_f32 v189, v250, v251
    v_cvt_pk_bf16_f32 v190, v252, v253
    v_cvt_pk_bf16_f32 v191, v254, v255
    s_add_u32 s70, s74, 368640
    buffer_store_dwordx4 v[188:191], v236, s[24:27], s70 offen offset:768 sc1
L_k1_epi_done:
    s_add_u32 s45, s45, 1
    s_cmp_lt_u32 s45, 2
    s_cbranch_scc0 L_k2
    s_mov_b32 s46, 0
    s_cmp_eq_u32 s28, 3
    s_cselect_b32 s3, 48, 64
    s_add_u32 s33, s33, 4194304
    s_branch L_k1_q
L_k1_redo:
    s_cmp_eq_u32 s45, 1
    s_cbranch_scc0 L_k1_redo2
    v_mbcnt_lo_u32_b32 v237, -1, 0
    v_mbcnt_hi_u32_b32 v237, -1, v237
    s_lshr_b32 s70, s28, 1
    s_lshl_b32 s70, s70, 16
    s_and_b32 s71, s28, 1
    s_lshl_b32 s71, s71, 14
    s_add_u32 s70, s70, s71
    s_lshl_b32 s71, s28, 17
    s_sub_u32 s70, s70, s71
    v_lshrrev_b32 v237, 4, v237
    v_mul_u32_u24 v237, 6144, v237
    v_sub_u32 v237, s70, v237
    v_sub_u32 v212, v212, v237
    v_sub_u32 v213, v213, v237
    v_subrev_u32 v237, 57344, v237
    v_sub_u32 v214, v214, v237
    v_sub_u32 v215, v215, v237
L_k1_redo2:
    s_mov_b32 s46, 1
    s_waitcnt vmcnt(0)
    s_barrier
    s_branch L_k1_cold
L_k1_truemax:
    s_waitcnt vmcnt(0)
    s_barrier
    v_mov_b32 v237, 0xff800000
    v_mov_b32 v238, 0xff800000
    v_mov_b32 v239, 0xff800000
    v_mov_b32 v240, 0xff800000
    s_add_u32 s72, s33, 245760
    s_mov_b32 s44, 16
L_k1_mx:
    s_mov_b32 m0, s29
    s_nop 0
    buffer_load_dwordx4 v208, s[8:11], s72 offen offset:0 lds
    buffer_load_dwordx4 v208, s[8:11], s72 offen offset:1024 lds
    buffer_load_dwordx4 v209, s[8:11], s72 offen offset:2048 lds
    buffer_load_dwordx4 v209, s[8:11], s72 offen offset:3072 lds
    s_waitcnt vmcnt(0)
    s_barrier
    ds_read_b128 a[128:131], v196 offset:0
    ds_read_b128 a[132:135], v197 offset:0
    ds_read_b128 a[136:139], v198 offset:0
    ds_read_b128 a[140:143], v199 offset:0
    ds_read_b128 a[144:147], v196 offset:1024
    ds_read_b128 a[148:151], v197 offset:1024
    ds_read_b128 a[152:155], v198 offset:1024
    ds_read_b128 a[156:159], v199 offset:1024
    s_waitcnt lgkmcnt(0)
    v_mfma_f32_16x16x32_bf16 v[0:3], a[128:131], v[128:131], 0
    v_mfma_f32_16x16x32_bf16 v[4:7], a[128:131], v[144:147], 0
    v_mfma_f32_16x16x32_bf16 v[8:11], a[128:131], v[160:163], 0
    v_mfma_f32_16x16x32_bf16 v[12:15], a[128:131], v[176:179], 0
    v_mfma_f32_16x16x32_bf16 v[0:3], a[132:135], v[132:135], v[0:3]
    v_mfma_f32_16x16x32_bf16 v[4:7], a[132:135], v[148:151], v[4:7]
    v_mfma_f32_16x16x32_bf16 v[8:11], a[132:135], v[164:167], v[8:11]
    v_mfma_f32_16x16x32_bf16 v[12:15], a[132:135], v[180:183], v[12:15]
    v_mfma_f32_16x16x32_bf16 v[0:3], a[136:139], v[136:139], v[0:3]
    v_mfma_f32_16x16x32_bf16 v[4:7], a[136:139], v[152:155], v[4:7]
    v_mfma_f32_16x16x32_bf16 v[8:11], a[136:139], v[168:171], v[8:11]
    v_mfma_f32_16x16x32_bf16 v[12:15], a[136:139], v[184:187], v[12:15]
    v_mfma_f32_16x16x32_bf16 v[0:3], a[140:143], v[140:143], v[0:3]
    v_mfma_f32_16x16x32_bf16 v[4:7], a[140:143], v[156:159], v[4:7]
    v_mfma_f32_16x16x32_bf16 v[8:11], a[140:143], v[172:175], v[8:11]
    v_mfma_f32_16x16x32_bf16 v[12:15], a[140:143], v[188:191], v[12:15]
    v_mfma_f32_16x16x32_bf16 v[16:19], a[144:147], v[128:131], 0
    v_mfma_f32_16x16x32_bf16 v[20:23], a[144:147], v[144:147], 0
    v_mfma_f32_16x16x32_bf16 v[24:27], a[144:147], v[160:163], 0
    v_mfma_f32_16x16x32_bf16 v[28:31], a[144:147], v[176:179], 0
    v_mfma_f32_16x16x32_bf16 v[16:19], a[148:151], v[132:135], v[16:19]
    v_mfma_f32_16x16x32_bf16 v[20:23], a[148:151], v[148:151], v[20:23]
    v_mfma_f32_16x16x32_bf16 v[24:27], a[148:151], v[164:167], v[24:27]
    v_mfma_f32_16x16x32_bf16 v[28:31], a[148:151], v[180:183], v[28:31]
    v_mfma_f32_16x16x32_bf16 v[16:19], a[152:155], v[136:139], v[16:19]
    v_mfma_f32_16x16x32_bf16 v[20:23], a[152:155], v[152:155], v[20:23]
    v_mfma_f32_16x16x32_bf16 v[24:27], a[152:155], v[168:171], v[24:27]
    v_mfma_f32_16x16x32_bf16 v[28:31], a[152:155], v[184:187], v[28:31]
    v_mfma_f32_16x16x32_bf16 v[16:19], a[156:159], v[140:143], v[16:19]
    v_mfma_f32_16x16x32_bf16 v[20:23], a[156:159], v[156:159], v[20:23]
    v_mfma_f32_16x16x32_bf16 v[24:27], a[156:159], v[172:175], v[24:27]
    v_mfma_f32_16x16x32_bf16 v[28:31], a[156:159], v[188:191], v[28:31]
    s_nop 7
    s_nop 1
    v_max3_f32 v237, v237, v0, v1
    v_max3_f32 v237, v237, v2, v3
    v_max3_f32 v237, v237, v16, v17
    v_max3_f32 v237, v237, v18, v19
    v_max3_f32 v238, v238, v4, v5
    v_max3_f32 v238, v238, v6, v7
    v_max3_f32 v238, v238, v20, v21
    v_max3_f32 v238, v238, v22, v23
    v_max3_f32 v239, v239, v8, v9
    v_max3_f32 v239, v239, v10, v11
    v_max3_f32 v239, v239, v24, v25
    v_max3_f32 v239, v239, v26, v27
    v_max3_f32 v240, v240, v12, v13
    v_max3_f32 v240, v240, v14, v15
    v_max3_f32 v240, v240, v28, v29
    v_max3_f32 v240, v240, v30, v31
    s_nop 1
    ds_read_b128 a[128:131], v196 offset:8192
    ds_read_b128 a[132:135], v197 offset:8192
    ds_read_b128 a[136:139], v198 offset:8192
    ds_read_b128 a[140:143], v199 offset:8192
    ds_read_b128 a[144:147], v196 offset:9216
    ds_read_b128 a[148:151], v197 offset:9216
    ds_read_b128 a[152:155], v198 offset:9216
    ds_read_b128 a[156:159], v199 offset:9216
    s_waitcnt lgkmcnt(0)
    v_mfma_f32_16x16x32_bf16 v[0:3], a[128:131], v[128:131], 0
    v_mfma_f32_16x16x32_bf16 v[4:7], a[128:131], v[144:147], 0
    v_mfma_f32_16x16x32_bf16 v[8:11], a[128:131], v[160:163], 0
    v_mfma_f32_16x16x32_bf16 v[12:15], a[128:131], v[176:179], 0
    v_mfma_f32_16x16x32_bf16 v[0:3], a[132:135], v[132:135], v[0:3]
    v_mfma_f32_16x16x32_bf16 v[4:7], a[132:135], v[148:151], v[4:7]
    v_mfma_f32_16x16x32_bf16 v[8:11], a[132:135], v[164:167], v[8:11]
    v_mfma_f32_16x16x32_bf16 v[12:15], a[132:135], v[180:183], v[12:15]
    v_mfma_f32_16x16x32_bf16 v[0:3], a[136:139], v[136:139], v[0:3]
    v_mfma_f32_16x16x32_bf16 v[4:7], a[136:139], v[152:155], v[4:7]
    v_mfma_f32_16x16x32_bf16 v[8:11], a[136:139], v[168:171], v[8:11]
    v_mfma_f32_16x16x32_bf16 v[12:15], a[136:139], v[184:187], v[12:15]
    v_mfma_f32_16x16x32_bf16 v[0:3], a[140:143], v[140:143], v[0:3]
    v_mfma_f32_16x16x32_bf16 v[4:7], a[140:143], v[156:159], v[4:7]
    v_mfma_f32_16x16x32_bf16 v[8:11], a[140:143], v[172:175], v[8:11]
    v_mfma_f32_16x16x32_bf16 v[12:15], a[140:143], v[188:191], v[12:15]
    v_mfma_f32_16x16x32_bf16 v[16:19], a[144:147], v[128:131], 0
    v_mfma_f32_16x16x32_bf16 v[20:23], a[144:147], v[144:147], 0
    v_mfma_f32_16x16x32_bf16 v[24:27], a[144:147], v[160:163], 0
    v_mfma_f32_16x16x32_bf16 v[28:31], a[144:147], v[176:179], 0
    v_mfma_f32_16x16x32_bf16 v[16:19], a[148:151], v[132:135], v[16:19]
    v_mfma_f32_16x16x32_bf16 v[20:23], a[148:151], v[148:151], v[20:23]
    v_mfma_f32_16x16x32_bf16 v[24:27], a[148:151], v[164:167], v[24:27]
    v_mfma_f32_16x16x32_bf16 v[28:31], a[148:151], v[180:183], v[28:31]
    v_mfma_f32_16x16x32_bf16 v[16:19], a[152:155], v[136:139], v[16:19]
    v_mfma_f32_16x16x32_bf16 v[20:23], a[152:155], v[152:155], v[20:23]
    v_mfma_f32_16x16x32_bf16 v[24:27], a[152:155], v[168:171], v[24:27]
    v_mfma_f32_16x16x32_bf16 v[28:31], a[152:155], v[184:187], v[28:31]
    v_mfma_f32_16x16x32_bf16 v[16:19], a[156:159], v[140:143], v[16:19]
    v_mfma_f32_16x16x32_bf16 v[20:23], a[156:159], v[156:159], v[20:23]
    v_mfma_f32_16x16x32_bf16 v[24:27], a[156:159], v[172:175], v[24:27]
    v_mfma_f32_16x16x32_bf16 v[28:31], a[156:159], v[188:191], v[28:31]
    s_nop 7
    s_nop 1
    v_max3_f32 v237, v237, v0, v1
    v_max3_f32 v237, v237, v2, v3
    v_max3_f32 v237, v237, v16, v17
    v_max3_f32 v237, v237, v18, v19
    v_max3_f32 v238, v238, v4, v5
    v_max3_f32 v238, v238, v6, v7
    v_max3_f32 v238, v238, v20, v21
    v_max3_f32 v238, v238, v22, v23
    v_max3_f32 v239, v239, v8, v9
    v_max3_f32 v239, v239, v10, v11
    v_max3_f32 v239, v239, v24, v25
    v_max3_f32 v239, v239, v26, v27
    v_max3_f32 v240, v240, v12, v13
    v_max3_f32 v240, v240, v14, v15
    v_max3_f32 v240, v240, v28, v29
    v_max3_f32 v240, v240, v30, v31
    s_nop 1
    s_barrier
    s_sub_u32 s72, s72, 16384
    s_sub_u32 s44, s44, 1
    s_cmp_lg_u32 s44, 0
    s_cbranch_scc1 L_k1_mx
    v_mov_b32 v241, v237
    s_nop 1
    v_permlane32_swap_b32 v237, v241
    s_nop 1
    v_max_f32 v237, v237, v241
    s_nop 0
    v_mov_b32 v241, v237
    s_nop 1
    v_permlane16_swap_b32 v237, v241
    s_nop 1
    v_max_f32 v237, v237, v241
    s_nop 0
    v_sub_f32 v96, 0, v237
    v_sub_f32 v97, 0, v237
    v_sub_f32 v98, 0, v237
    v_sub_f32 v99, 0, v237
    v_mov_b32 v241, v238
    s_nop 1
    v_permlane32_swap_b32 v238, v241
    s_nop 1
    v_max_f32 v238, v238, v241
    s_nop 0
    v_mov_b32 v241, v238
    s_nop 1
    v_permlane16_swap_b32 v238, v241
    s_nop 1
    v_max_f32 v238, v238, v241
    s_nop 0
    v_sub_f32 v100, 0, v238
    v_sub_f32 v101, 0, v238
    v_sub_f32 v102, 0, v238
    v_sub_f32 v103, 0, v238
    v_mov_b32 v241, v239
    s_nop 1
    v_permlane32_swap_b32 v239, v241
    s_nop 1
    v_max_f32 v239, v239, v241
    s_nop 0
    v_mov_b32 v241, v239
    s_nop 1
    v_permlane16_swap_b32 v239, v241
    s_nop 1
    v_max_f32 v239, v239, v241
    s_nop 0
    v_sub_f32 v104, 0, v239
    v_sub_f32 v105, 0, v239
    v_sub_f32 v106, 0, v239
    v_sub_f32 v107, 0, v239
    v_mov_b32 v241, v240
    s_nop 1
    v_permlane32_swap_b32 v240, v241
    s_nop 1
    v_max_f32 v240, v240, v241
    s_nop 0
    v_mov_b32 v241, v240
    s_nop 1
    v_permlane16_swap_b32 v240, v241
    s_nop 1
    v_max_f32 v240, v240, v241
    s_nop 0
    v_sub_f32 v108, 0, v240
    v_sub_f32 v109, 0, v240
    v_sub_f32 v110, 0, v240
    v_sub_f32 v111, 0, v240
    s_branch L_k1_att
L_k2:
    s_lshr_b32 s70, s2, 3
    s_cmp_ge_u32 s70, 30
    s_cbranch_scc1 L_k2_idle
    s_mov_b32 s16, s60
    s_mov_b32 s17, s61
    s_mov_b32 s18, 7864320
    s_add_u32 s39, s29, 65536
    s_mov_b32 s43, 2
    s_mov_b32 s44, 5
    s_waitcnt vmcnt(32)
    v_mfma_f32_16x16x32_bf16 v[64:67], a[160:163], v[0:3], 0
    ds_read_b64_tr_b16 a[128:129], v200 offset:8192
    v_mfma_f32_16x16x32_bf16 v[68:71], a[160:163], v[4:7], 0
    ds_read_b64_tr_b16 a[130:131], v200 offset:9216
    v_mfma_f32_16x16x32_bf16 v[72:75], a[164:167], v[0:3], 0
    ds_read_b64_tr_b16 a[132:133], v201 offset:8192
    v_mfma_f32_16x16x32_bf16 v[76:79], a[164:167], v[4:7], 0
    s_waitcnt lgkmcnt(11)
    ds_read_b64_tr_b16 a[134:135], v201 offset:9216
    v_mfma_f32_16x16x32_bf16 v[80:83], a[168:171], v[0:3], 0
    ds_read_b64_tr_b16 a[136:137], v202 offset:8192
    v_mfma_f32_16x16x32_bf16 v[84:87], a[168:171], v[4:7], 0
    ds_read_b64_tr_b16 a[138:139], v202 offset:9216
    v_mfma_f32_16x16x32_bf16 v[88:91], a[172:175], v[0:3], 0
    ds_read_b64_tr_b16 a[140:141], v203 offset:8192
    v_mfma_f32_16x16x32_bf16 v[92:95], a[172:175], v[4:7], 0
    s_waitcnt lgkmcnt(11)
    ds_read_b64_tr_b16 a[142:143], v203 offset:9216
    v_mfma_f32_16x16x32_bf16 v[96:99], a[176:179], v[0:3], 0
    ds_read_b64_tr_b16 a[144:145], v204 offset:8192
    v_mfma_f32_16x16x32_bf16 v[100:103], a[176:179], v[4:7], 0
    ds_read_b64_tr_b16 a[146:147], v204 offset:9216
    v_mfma_f32_16x16x32_bf16 v[104:107], a[180:183], v[0:3], 0
    ds_read_b64_tr_b16 a[148:149], v205 offset:8192
    v_mfma_f32_16x16x32_bf16 v[108:111], a[180:183], v[4:7], 0
    s_waitcnt lgkmcnt(11)
    ds_read_b64_tr_b16 a[150:151], v205 offset:9216
    v_mfma_f32_16x16x32_bf16 v[112:115], a[184:187], v[0:3], 0
    ds_read_b64_tr_b16 a[152:153], v206 offset:8192
    v_mfma_f32_16x16x32_bf16 v[116:119], a[184:187], v[4:7], 0
    ds_read_b64_tr_b16 a[154:155], v206 offset:9216
    v_mfma_f32_16x16x32_bf16 v[120:123], a[188:191], v[0:3], 0
    ds_read_b64_tr_b16 a[156:157], v207 offset:8192
    v_mfma_f32_16x16x32_bf16 v[124:127], a[188:191], v[4:7], 0
    s_waitcnt lgkmcnt(11)
    ds_read_b64_tr_b16 a[158:159], v207 offset:9216
    v_mfma_f32_16x16x32_bf16 v[64:67], a[128:131], v[8:11], v[64:67]
    s_waitcnt vmcnt(28)
    s_barrier
    ds_read_b64_tr_b16 a[160:161], v200 offset:16384
    v_mfma_f32_16x16x32_bf16 v[68:71], a[128:131], v[12:15], v[68:71]
    ds_read_b64_tr_b16 a[162:163], v200 offset:17408
    v_mfma_f32_16x16x32_bf16 v[72:75], a[132:135], v[8:11], v[72:75]
    ds_read_b64_tr_b16 a[164:165], v201 offset:16384
    v_mfma_f32_16x16x32_bf16 v[76:79], a[132:135], v[12:15], v[76:79]
    s_waitcnt lgkmcnt(11)
    ds_read_b64_tr_b16 a[166:167], v201 offset:17408
    v_mfma_f32_16x16x32_bf16 v[80:83], a[136:139], v[8:11], v[80:83]
    s_add_u32 s40, s40, 1
    ds_read_b64_tr_b16 a[168:169], v202 offset:16384
    v_mfma_f32_16x16x32_bf16 v[84:87], a[136:139], v[12:15], v[84:87]
    s_add_u32 s41, s40, s68
    ds_read_b64_tr_b16 a[170:171], v202 offset:17408
    v_mfma_f32_16x16x32_bf16 v[88:91], a[140:143], v[8:11], v[88:91]
    ds_read_b64_tr_b16 a[172:173], v203 offset:16384
    v_mfma_f32_16x16x32_bf16 v[92:95], a[140:143], v[12:15], v[92:95]
    s_waitcnt lgkmcnt(11)
    ds_read_b64_tr_b16 a[174:175], v203 offset:17408
    v_mfma_f32_16x16x32_bf16 v[96:99], a[144:147], v[8:11], v[96:99]
    s_and_b32 s41, s41, 3
    ds_read_b64_tr_b16 a[176:177], v204 offset:16384
    v_mfma_f32_16x16x32_bf16 v[100:103], a[144:147], v[12:15], v[100:103]
    s_and_b32 s70, s40, 0xfffffffc
    ds_read_b64_tr_b16 a[178:179], v204 offset:17408
    v_mfma_f32_16x16x32_bf16 v[104:107], a[148:151], v[8:11], v[104:107]
    ds_read_b64_tr_b16 a[180:181], v205 offset:16384
    v_mfma_f32_16x16x32_bf16 v[108:111], a[148:151], v[12:15], v[108:111]
    s_waitcnt lgkmcnt(11)
    ds_read_b64_tr_b16 a[182:183], v205 offset:17408
    v_mfma_f32_16x16x32_bf16 v[112:115], a[152:155], v[8:11], v[112:115]
    s_or_b32 s41, s41, s70
    ds_read_b64_tr_b16 a[184:185], v206 offset:16384
    v_mfma_f32_16x16x32_bf16 v[116:119], a[152:155], v[12:15], v[116:119]
    s_mul_i32 s36, s41, 245760
    ds_read_b64_tr_b16 a[186:187], v206 offset:17408
    v_mfma_f32_16x16x32_bf16 v[120:123], a[156:159], v[8:11], v[120:123]
    ds_read_b64_tr_b16 a[188:189], v207 offset:16384
    v_mfma_f32_16x16x32_bf16 v[124:127], a[156:159], v[12:15], v[124:127]
    s_waitcnt lgkmcnt(11)
    ds_read_b64_tr_b16 a[190:191], v207 offset:17408
    v_mfma_f32_16x16x32_bf16 v[64:67], a[160:163], v[16:19], v[64:67]
    s_add_u32 s37, s36, 122880
    ds_read_b64_tr_b16 a[128:129], v200 offset:24576
    v_mfma_f32_16x16x32_bf16 v[68:71], a[160:163], v[20:23], v[68:71]
    ds_read_b64_tr_b16 a[130:131], v200 offset:25600
    buffer_load_dwordx4 v[0:3], v193, s[24:27], s36 offen offset:0 sc1
    v_mfma_f32_16x16x32_bf16 v[72:75], a[164:167], v[16:19], v[72:75]
    ds_read_b64_tr_b16 a[132:133], v201 offset:24576
    v_mfma_f32_16x16x32_bf16 v[76:79], a[164:167], v[20:23], v[76:79]
    s_waitcnt lgkmcnt(11)
    ds_read_b64_tr_b16 a[134:135], v201 offset:25600
    v_mfma_f32_16x16x32_bf16 v[80:83], a[168:171], v[16:19], v[80:83]
    ds_read_b64_tr_b16 a[136:137], v202 offset:24576
    v_mfma_f32_16x16x32_bf16 v[84:87], a[168:171], v[20:23], v[84:87]
    ds_read_b64_tr_b16 a[138:139], v202 offset:25600
    buffer_load_dwordx4 v[4:7], v193, s[24:27], s36 offen offset:256 sc1
    v_mfma_f32_16x16x32_bf16 v[88:91], a[172:175], v[16:19], v[88:91]
    ds_read_b64_tr_b16 a[140:141], v203 offset:24576
    v_mfma_f32_16x16x32_bf16 v[92:95], a[172:175], v[20:23], v[92:95]
    s_waitcnt lgkmcnt(11)
    ds_read_b64_tr_b16 a[142:143], v203 offset:25600
    v_mfma_f32_16x16x32_bf16 v[96:99], a[176:179], v[16:19], v[96:99]
    ds_read_b64_tr_b16 a[144:145], v204 offset:24576
    v_mfma_f32_16x16x32_bf16 v[100:103], a[176:179], v[20:23], v[100:103]
    ds_read_b64_tr_b16 a[146:147], v204 offset:25600
    buffer_load_dwordx4 v[8:11], v193, s[24:27], s37 offen offset:0 sc1
    v_mfma_f32_16x16x32_bf16 v[104:107], a[180:183], v[16:19], v[104:107]
    ds_read_b64_tr_b16 a[148:149], v205 offset:24576
    v_mfma_f32_16x16x32_bf16 v[108:111], a[180:183], v[20:23], v[108:111]
    s_waitcnt lgkmcnt(11)
    ds_read_b64_tr_b16 a[150:151], v205 offset:25600
    v_mfma_f32_16x16x32_bf16 v[112:115], a[184:187], v[16:19], v[112:115]
    ds_read_b64_tr_b16 a[152:153], v206 offset:24576
    v_mfma_f32_16x16x32_bf16 v[116:119], a[184:187], v[20:23], v[116:119]
    ds_read_b64_tr_b16 a[154:155], v206 offset:25600
    buffer_load_dwordx4 v[12:15], v193, s[24:27], s37 offen offset:256 sc1
    v_mfma_f32_16x16x32_bf16 v[120:123], a[188:191], v[16:19], v[120:123]
    s_lshl_b32 s35, s41, 17
    ds_read_b64_tr_b16 a[156:157], v207 offset:24576
    v_mfma_f32_16x16x32_bf16 v[124:127], a[188:191], v[20:23], v[124:127]
    s_waitcnt lgkmcnt(11)
    s_add_u32 s35, s35, s58
    ds_read_b64_tr_b16 a[158:159], v207 offset:25600
    v_mfma_f32_16x16x32_bf16 v[64:67], a[128:131], v[24:27], v[64:67]
    s_waitcnt vmcnt(24)
    s_barrier
    ds_read_b64_tr_b16 a[160:161], v200 offset:32768
    v_mfma_f32_16x16x32_bf16 v[68:71], a[128:131], v[28:31], v[68:71]
    s_mov_b32 m0, s39
    ds_read_b64_tr_b16 a[162:163], v200 offset:33792
    v_mfma_f32_16x16x32_bf16 v[72:75], a[132:135], v[24:27], v[72:75]
    ds_read_b64_tr_b16 a[164:165], v201 offset:32768
    buffer_load_dwordx4 v212, s[20:23], s35 offen offset:0 lds
    v_mfma_f32_16x16x32_bf16 v[76:79], a[132:135], v[28:31], v[76:79]
    s_waitcnt lgkmcnt(11)
    ds_read_b64_tr_b16 a[166:167], v201 offset:33792
    v_mfma_f32_16x16x32_bf16 v[80:83], a[136:139], v[24:27], v[80:83]
    s_add_u32 s40, s40, 1
    ds_read_b64_tr_b16 a[168:169], v202 offset:32768
    v_mfma_f32_16x16x32_bf16 v[84:87], a[136:139], v[28:31], v[84:87]
    s_add_u32 s41, s40, s68
    ds_read_b64_tr_b16 a[170:171], v202 offset:33792
    v_mfma_f32_16x16x32_bf16 v[88:91], a[140:143], v[24:27], v[88:91]
    ds_read_b64_tr_b16 a[172:173], v203 offset:32768
    buffer_load_dwordx4 v213, s[20:23], s35 offen offset:1024 lds
    v_mfma_f32_16x16x32_bf16 v[92:95], a[140:143], v[28:31], v[92:95]
    s_waitcnt lgkmcnt(11)
    ds_read_b64_tr_b16 a[174:175], v203 offset:33792
    v_mfma_f32_16x16x32_bf16 v[96:99], a[144:147], v[24:27], v[96:99]
    s_and_b32 s41, s41, 3
    ds_read_b64_tr_b16 a[176:177], v204 offset:32768
    v_mfma_f32_16x16x32_bf16 v[100:103], a[144:147], v[28:31], v[100:103]
    s_and_b32 s70, s40, 0xfffffffc
    ds_read_b64_tr_b16 a[178:179], v204 offset:33792
    v_mfma_f32_16x16x32_bf16 v[104:107], a[148:151], v[24:27], v[104:107]
    ds_read_b64_tr_b16 a[180:181], v205 offset:32768
    buffer_load_dwordx4 v214, s[20:23], s35 offen offset:2048 lds
    v_mfma_f32_16x16x32_bf16 v[108:111], a[148:151], v[28:31], v[108:111]
    s_waitcnt lgkmcnt(11)
    ds_read_b64_tr_b16 a[182:183], v205 offset:33792
    v_mfma_f32_16x16x32_bf16 v[112:115], a[152:155], v[24:27], v[112:115]
    s_or_b32 s41, s41, s70
    ds_read_b64_tr_b16 a[184:185], v206 offset:32768
    v_mfma_f32_16x16x32_bf16 v[116:119], a[152:155], v[28:31], v[116:119]
    s_mul_i32 s36, s41, 245760
    ds_read_b64_tr_b16 a[186:187], v206 offset:33792
    v_mfma_f32_16x16x32_bf16 v[120:123], a[156:159], v[24:27], v[120:123]
    ds_read_b64_tr_b16 a[188:189], v207 offset:32768
    buffer_load_dwordx4 v215, s[20:23], s35 offen offset:3072 lds
    v_mfma_f32_16x16x32_bf16 v[124:127], a[156:159], v[28:31], v[124:127]
    s_waitcnt lgkmcnt(11)
    ds_read_b64_tr_b16 a[190:191], v207 offset:33792
    v_mfma_f32_16x16x32_bf16 v[64:67], a[160:163], v[32:35], v[64:67]
    s_add_u32 s37, s36, 122880
    ds_read_b64_tr_b16 a[128:129], v200 offset:40960
    v_mfma_f32_16x16x32_bf16 v[68:71], a[160:163], v[36:39], v[68:71]
    ds_read_b64_tr_b16 a[130:131], v200 offset:41984
    buffer_load_dwordx4 v[16:19], v193, s[24:27], s36 offen offset:0 sc1
    v_mfma_f32_16x16x32_bf16 v[72:75], a[164:167], v[32:35], v[72:75]
    ds_read_b64_tr_b16 a[132:133], v201 offset:40960
    v_mfma_f32_16x16x32_bf16 v[76:79], a[164:167], v[36:39], v[76:79]
    s_waitcnt lgkmcnt(11)
    ds_read_b64_tr_b16 a[134:135], v201 offset:41984
    v_mfma_f32_16x16x32_bf16 v[80:83], a[168:171], v[32:35], v[80:83]
    ds_read_b64_tr_b16 a[136:137], v202 offset:40960
    v_mfma_f32_16x16x32_bf16 v[84:87], a[168:171], v[36:39], v[84:87]
    ds_read_b64_tr_b16 a[138:139], v202 offset:41984
    buffer_load_dwordx4 v[20:23], v193, s[24:27], s36 offen offset:256 sc1
    v_mfma_f32_16x16x32_bf16 v[88:91], a[172:175], v[32:35], v[88:91]
    ds_read_b64_tr_b16 a[140:141], v203 offset:40960
    v_mfma_f32_16x16x32_bf16 v[92:95], a[172:175], v[36:39], v[92:95]
    s_waitcnt lgkmcnt(11)
    ds_read_b64_tr_b16 a[142:143], v203 offset:41984
    v_mfma_f32_16x16x32_bf16 v[96:99], a[176:179], v[32:35], v[96:99]
    ds_read_b64_tr_b16 a[144:145], v204 offset:40960
    v_mfma_f32_16x16x32_bf16 v[100:103], a[176:179], v[36:39], v[100:103]
    ds_read_b64_tr_b16 a[146:147], v204 offset:41984
    buffer_load_dwordx4 v[24:27], v193, s[24:27], s37 offen offset:0 sc1
    v_mfma_f32_16x16x32_bf16 v[104:107], a[180:183], v[32:35], v[104:107]
    ds_read_b64_tr_b16 a[148:149], v205 offset:40960
    v_mfma_f32_16x16x32_bf16 v[108:111], a[180:183], v[36:39], v[108:111]
    s_waitcnt lgkmcnt(11)
    ds_read_b64_tr_b16 a[150:151], v205 offset:41984
    v_mfma_f32_16x16x32_bf16 v[112:115], a[184:187], v[32:35], v[112:115]
    ds_read_b64_tr_b16 a[152:153], v206 offset:40960
    v_mfma_f32_16x16x32_bf16 v[116:119], a[184:187], v[36:39], v[116:119]
    ds_read_b64_tr_b16 a[154:155], v206 offset:41984
    buffer_load_dwordx4 v[28:31], v193, s[24:27], s37 offen offset:256 sc1
    v_mfma_f32_16x16x32_bf16 v[120:123], a[188:191], v[32:35], v[120:123]
    s_lshl_b32 s35, s41, 17
    ds_read_b64_tr_b16 a[156:157], v207 offset:40960
    v_mfma_f32_16x16x32_bf16 v[124:127], a[188:191], v[36:39], v[124:127]
    s_waitcnt lgkmcnt(11)
    s_add_u32 s35, s35, s58
    ds_read_b64_tr_b16 a[158:159], v207 offset:41984
    v_mfma_f32_16x16x32_bf16 v[64:67], a[128:131], v[40:43], v[64:67]
    s_waitcnt vmcnt(24)
    s_barrier
    ds_read_b64_tr_b16 a[160:161], v200 offset:49152
    v_mfma_f32_16x16x32_bf16 v[68:71], a[128:131], v[44:47], v[68:71]
    s_add_u32 m0, s39, 16384
    ds_read_b64_tr_b16 a[162:163], v200 offset:50176
    v_mfma_f32_16x16x32_bf16 v[72:75], a[132:135], v[40:43], v[72:75]
    ds_read_b64_tr_b16 a[164:165], v201 offset:49152
    buffer_load_dwordx4 v212, s[20:23], s35 offen offset:0 lds
    v_mfma_f32_16x16x32_bf16 v[76:79], a[132:135], v[44:47], v[76:79]
    s_waitcnt lgkmcnt(11)
    ds_read_b64_tr_b16 a[166:167], v201 offset:50176
    v_mfma_f32_16x16x32_bf16 v[80:83], a[136:139], v[40:43], v[80:83]
    s_add_u32 s40, s40, 1
    ds_read_b64_tr_b16 a[168:169], v202 offset:49152
    v_mfma_f32_16x16x32_bf16 v[84:87], a[136:139], v[44:47], v[84:87]
    s_add_u32 s41, s40, s68
    ds_read_b64_tr_b16 a[170:171], v202 offset:50176
    v_mfma_f32_16x16x32_bf16 v[88:91], a[140:143], v[40:43], v[88:91]
    ds_read_b64_tr_b16 a[172:173], v203 offset:49152
    buffer_load_dwordx4 v213, s[20:23], s35 offen offset:1024 lds
    v_mfma_f32_16x16x32_bf16 v[92:95], a[140:143], v[44:47], v[92:95]
    s_waitcnt lgkmcnt(11)
    ds_read_b64_tr_b16 a[174:175], v203 offset:50176
    v_mfma_f32_16x16x32_bf16 v[96:99], a[144:147], v[40:43], v[96:99]
    s_and_b32 s41, s41, 3
    ds_read_b64_tr_b16 a[176:177], v204 offset:49152
    v_mfma_f32_16x16x32_bf16 v[100:103], a[144:147], v[44:47], v[100:103]
    s_and_b32 s70, s40, 0xfffffffc
    ds_read_b64_tr_b16 a[178:179], v204 offset:50176
    v_mfma_f32_16x16x32_bf16 v[104:107], a[148:151], v[40:43], v[104:107]
    ds_read_b64_tr_b16 a[180:181], v205 offset:49152
    buffer_load_dwordx4 v214, s[20:23], s35 offen offset:2048 lds
    v_mfma_f32_16x16x32_bf16 v[108:111], a[148:151], v[44:47], v[108:111]
    s_waitcnt lgkmcnt(11)
    ds_read_b64_tr_b16 a[182:183], v205 offset:50176
    v_mfma_f32_16x16x32_bf16 v[112:115], a[152:155], v[40:43], v[112:115]
    s_or_b32 s41, s41, s70
    ds_read_b64_tr_b16 a[184:185], v206 offset:49152
    v_mfma_f32_16x16x32_bf16 v[116:119], a[152:155], v[44:47], v[116:119]
    s_mul_i32 s36, s41, 245760
    ds_read_b64_tr_b16 a[186:187], v206 offset:50176
    v_mfma_f32_16x16x32_bf16 v[120:123], a[156:159], v[40:43], v[120:123]
    ds_read_b64_tr_b16 a[188:189], v207 offset:49152
    buffer_load_dwordx4 v215, s[20:23], s35 offen offset:3072 lds
    v_mfma_f32_16x16x32_bf16 v[124:127], a[156:159], v[44:47], v[124:127]
    s_waitcnt lgkmcnt(11)
    ds_read_b64_tr_b16 a[190:191], v207 offset:50176
    v_mfma_f32_16x16x32_bf16 v[64:67], a[160:163], v[48:51], v[64:67]
    s_add_u32 s37, s36, 122880
    ds_read_b64_tr_b16 a[128:129], v200 offset:57344
    v_mfma_f32_16x16x32_bf16 v[68:71], a[160:163], v[52:55], v[68:71]
    ds_read_b64_tr_b16 a[130:131], v200 offset:58368
    buffer_load_dwordx4 v[32:35], v193, s[24:27], s36 offen offset:0 sc1
    v_mfma_f32_16x16x32_bf16 v[72:75], a[164:167], v[48:51], v[72:75]
    ds_read_b64_tr_b16 a[132:133], v201 offset:57344
    v_mfma_f32_16x16x32_bf16 v[76:79], a[164:167], v[52:55], v[76:79]
    s_waitcnt lgkmcnt(11)
    ds_read_b64_tr_b16 a[134:135], v201 offset:58368
    v_mfma_f32_16x16x32_bf16 v[80:83], a[168:171], v[48:51], v[80:83]
    ds_read_b64_tr_b16 a[136:137], v202 offset:57344
    v_mfma_f32_16x16x32_bf16 v[84:87], a[168:171], v[52:55], v[84:87]
    ds_read_b64_tr_b16 a[138:139], v202 offset:58368
    buffer_load_dwordx4 v[36:39], v193, s[24:27], s36 offen offset:256 sc1
    v_mfma_f32_16x16x32_bf16 v[88:91], a[172:175], v[48:51], v[88:91]
    ds_read_b64_tr_b16 a[140:141], v203 offset:57344
    v_mfma_f32_16x16x32_bf16 v[92:95], a[172:175], v[52:55], v[92:95]
    s_waitcnt lgkmcnt(11)
    ds_read_b64_tr_b16 a[142:143], v203 offset:58368
    v_mfma_f32_16x16x32_bf16 v[96:99], a[176:179], v[48:51], v[96:99]
    ds_read_b64_tr_b16 a[144:145], v204 offset:57344
    v_mfma_f32_16x16x32_bf16 v[100:103], a[176:179], v[52:55], v[100:103]
    ds_read_b64_tr_b16 a[146:147], v204 offset:58368
    buffer_load_dwordx4 v[40:43], v193, s[24:27], s37 offen offset:0 sc1
    v_mfma_f32_16x16x32_bf16 v[104:107], a[180:183], v[48:51], v[104:107]
    ds_read_b64_tr_b16 a[148:149], v205 offset:57344
    v_mfma_f32_16x16x32_bf16 v[108:111], a[180:183], v[52:55], v[108:111]
    s_waitcnt lgkmcnt(11)
    ds_read_b64_tr_b16 a[150:151], v205 offset:58368
    v_mfma_f32_16x16x32_bf16 v[112:115], a[184:187], v[48:51], v[112:115]
    ds_read_b64_tr_b16 a[152:153], v206 offset:57344
    v_mfma_f32_16x16x32_bf16 v[116:119], a[184:187], v[52:55], v[116:119]
    ds_read_b64_tr_b16 a[154:155], v206 offset:58368
    buffer_load_dwordx4 v[44:47], v193, s[24:27], s37 offen offset:256 sc1
    v_mfma_f32_16x16x32_bf16 v[120:123], a[188:191], v[48:51], v[120:123]
    s_lshl_b32 s35, s41, 17
    ds_read_b64_tr_b16 a[156:157], v207 offset:57344
    v_mfma_f32_16x16x32_bf16 v[124:127], a[188:191], v[52:55], v[124:127]
    s_waitcnt lgkmcnt(11)
    s_add_u32 s35, s35, s58
    ds_read_b64_tr_b16 a[158:159], v207 offset:58368
    v_mfma_f32_16x16x32_bf16 v[64:67], a[128:131], v[56:59], v[64:67]
    s_waitcnt vmcnt(12)
    s_barrier
    s_cmp_eq_u32 s28, 0
    s_cbranch_scc0 L_sig_hi
    s_and_b32 s70, s2, 1
    s_lshl_b32 s70, s70, 3
    s_add_u32 s70, s70, s31
    s_lshl_b32 s70, s70, 4
    s_add_u32 s70, s70, 4
    v_mov_b32 v245, s70
    v_mov_b32 v246, 1
    s_mov_b64 exec, 1
    global_atomic_add v245, v246, s[62:63] sc1
    s_mov_b64 exec, -1
L_sig_hi:
    ds_read_b64_tr_b16 a[160:161], v200 offset:0
    v_mfma_f32_16x16x32_bf16 v[68:71], a[128:131], v[60:63], v[68:71]
    s_add_u32 m0, s39, 32768
    ds_read_b64_tr_b16 a[162:163], v200 offset:1024
    v_mfma_f32_16x16x32_bf16 v[72:75], a[132:135], v[56:59], v[72:75]
    ds_read_b64_tr_b16 a[164:165], v201 offset:0
    buffer_load_dwordx4 v212, s[20:23], s35 offen offset:0 lds
    v_mfma_f32_16x16x32_bf16 v[76:79], a[132:135], v[60:63], v[76:79]
    s_waitcnt lgkmcnt(11)
    ds_read_b64_tr_b16 a[166:167], v201 offset:1024
    v_mfma_f32_16x16x32_bf16 v[80:83], a[136:139], v[56:59], v[80:83]
    s_add_u32 s40, s40, 1
    ds_read_b64_tr_b16 a[168:169], v202 offset:0
    v_mfma_f32_16x16x32_bf16 v[84:87], a[136:139], v[60:63], v[84:87]
    s_add_u32 s41, s40, s68
    ds_read_b64_tr_b16 a[170:171], v202 offset:1024
    v_mfma_f32_16x16x32_bf16 v[88:91], a[140:143], v[56:59], v[88:91]
    ds_read_b64_tr_b16 a[172:173], v203 offset:0
    buffer_load_dwordx4 v213, s[20:23], s35 offen offset:1024 lds
    v_mfma_f32_16x16x32_bf16 v[92:95], a[140:143], v[60:63], v[92:95]
    s_waitcnt lgkmcnt(11)
    ds_read_b64_tr_b16 a[174:175], v203 offset:1024
    v_mfma_f32_16x16x32_bf16 v[96:99], a[144:147], v[56:59], v[96:99]
    s_and_b32 s41, s41, 3
    ds_read_b64_tr_b16 a[176:177], v204 offset:0
    v_mfma_f32_16x16x32_bf16 v[100:103], a[144:147], v[60:63], v[100:103]
    s_and_b32 s70, s40, 0xfffffffc
    ds_read_b64_tr_b16 a[178:179], v204 offset:1024
    v_mfma_f32_16x16x32_bf16 v[104:107], a[148:151], v[56:59], v[104:107]
    ds_read_b64_tr_b16 a[180:181], v205 offset:0
    buffer_load_dwordx4 v214, s[20:23], s35 offen offset:2048 lds
    v_mfma_f32_16x16x32_bf16 v[108:111], a[148:151], v[60:63], v[108:111]
    s_waitcnt lgkmcnt(11)
    ds_read_b64_tr_b16 a[182:183], v205 offset:1024
    v_mfma_f32_16x16x32_bf16 v[112:115], a[152:155], v[56:59], v[112:115]
    s_or_b32 s41, s41, s70
    ds_read_b64_tr_b16 a[184:185], v206 offset:0
    v_mfma_f32_16x16x32_bf16 v[116:119], a[152:155], v[60:63], v[116:119]
    s_mul_i32 s36, s41, 245760
    ds_read_b64_tr_b16 a[186:187], v206 offset:1024
    v_mfma_f32_16x16x32_bf16 v[120:123], a[156:159], v[56:59], v[120:123]
    ds_read_b64_tr_b16 a[188:189], v207 offset:0
    buffer_load_dwordx4 v215, s[20:23], s35 offen offset:3072 lds
    v_mfma_f32_16x16x32_bf16 v[124:127], a[156:159], v[60:63], v[124:127]
    s_waitcnt lgkmcnt(11)
    ds_read_b64_tr_b16 a[190:191], v207 offset:1024
L_k2_loop:
    v_mfma_f32_16x16x32_bf16 v[64:67], a[160:163], v[0:3], v[64:67]
    s_add_u32 s37, s36, 122880
    ds_read_b64_tr_b16 a[128:129], v200 offset:8192
    v_mfma_f32_16x16x32_bf16 v[68:71], a[160:163], v[4:7], v[68:71]
    ds_read_b64_tr_b16 a[130:131], v200 offset:9216
    buffer_load_dwordx4 v[48:51], v193, s[24:27], s36 offen offset:0 sc1
    v_mfma_f32_16x16x32_bf16 v[72:75], a[164:167], v[0:3], v[72:75]
    ds_read_b64_tr_b16 a[132:133], v201 offset:8192
    v_mfma_f32_16x16x32_bf16 v[76:79], a[164:167], v[4:7], v[76:79]
    s_waitcnt lgkmcnt(11)
    ds_read_b64_tr_b16 a[134:135], v201 offset:9216
    v_mfma_f32_16x16x32_bf16 v[80:83], a[168:171], v[0:3], v[80:83]
    ds_read_b64_tr_b16 a[136:137], v202 offset:8192
    v_mfma_f32_16x16x32_bf16 v[84:87], a[168:171], v[4:7], v[84:87]
    ds_read_b64_tr_b16 a[138:139], v202 offset:9216
    buffer_load_dwordx4 v[52:55], v193, s[24:27], s36 offen offset:256 sc1
    v_mfma_f32_16x16x32_bf16 v[88:91], a[172:175], v[0:3], v[88:91]
    ds_read_b64_tr_b16 a[140:141], v203 offset:8192
    v_mfma_f32_16x16x32_bf16 v[92:95], a[172:175], v[4:7], v[92:95]
    s_waitcnt lgkmcnt(11)
    ds_read_b64_tr_b16 a[142:143], v203 offset:9216
    v_mfma_f32_16x16x32_bf16 v[96:99], a[176:179], v[0:3], v[96:99]
    ds_read_b64_tr_b16 a[144:145], v204 offset:8192
    v_mfma_f32_16x16x32_bf16 v[100:103], a[176:179], v[4:7], v[100:103]
    ds_read_b64_tr_b16 a[146:147], v204 offset:9216
    buffer_load_dwordx4 v[56:59], v193, s[24:27], s37 offen offset:0 sc1
    v_mfma_f32_16x16x32_bf16 v[104:107], a[180:183], v[0:3], v[104:107]
    ds_read_b64_tr_b16 a[148:149], v205 offset:8192
    v_mfma_f32_16x16x32_bf16 v[108:111], a[180:183], v[4:7], v[108:111]
    s_waitcnt lgkmcnt(11)
    ds_read_b64_tr_b16 a[150:151], v205 offset:9216
    v_mfma_f32_16x16x32_bf16 v[112:115], a[184:187], v[0:3], v[112:115]
    ds_read_b64_tr_b16 a[152:153], v206 offset:8192
    v_mfma_f32_16x16x32_bf16 v[116:119], a[184:187], v[4:7], v[116:119]
    ds_read_b64_tr_b16 a[154:155], v206 offset:9216
    buffer_load_dwordx4 v[60:63], v193, s[24:27], s37 offen offset:256 sc1
    v_mfma_f32_16x16x32_bf16 v[120:123], a[188:191], v[0:3], v[120:123]
    s_lshl_b32 s35, s41, 17
    ds_read_b64_tr_b16 a[156:157], v207 offset:8192
    v_mfma_f32_16x16x32_bf16 v[124:127], a[188:191], v[4:7], v[124:127]
    s_waitcnt lgkmcnt(11)
    s_add_u32 s35, s35, s58
    ds_read_b64_tr_b16 a[158:159], v207 offset:9216
    v_mfma_f32_16x16x32_bf16 v[64:67], a[128:131], v[8:11], v[64:67]
    s_waitcnt vmcnt(12)
    s_barrier
    ds_read_b64_tr_b16 a[160:161], v200 offset:16384
    v_mfma_f32_16x16x32_bf16 v[68:71], a[128:131], v[12:15], v[68:71]
    s_add_u32 m0, s39, 49152
    ds_read_b64_tr_b16 a[162:163], v200 offset:17408
    v_mfma_f32_16x16x32_bf16 v[72:75], a[132:135], v[8:11], v[72:75]
    ds_read_b64_tr_b16 a[164:165], v201 offset:16384
    buffer_load_dwordx4 v212, s[20:23], s35 offen offset:0 lds
    v_mfma_f32_16x16x32_bf16 v[76:79], a[132:135], v[12:15], v[76:79]
    s_waitcnt lgkmcnt(11)
    ds_read_b64_tr_b16 a[166:167], v201 offset:17408
    v_mfma_f32_16x16x32_bf16 v[80:83], a[136:139], v[8:11], v[80:83]
    s_add_u32 s40, s40, 1
    ds_read_b64_tr_b16 a[168:169], v202 offset:16384
    v_mfma_f32_16x16x32_bf16 v[84:87], a[136:139], v[12:15], v[84:87]
    s_add_u32 s41, s40, s68
    ds_read_b64_tr_b16 a[170:171], v202 offset:17408
    v_mfma_f32_16x16x32_bf16 v[88:91], a[140:143], v[8:11], v[88:91]
    ds_read_b64_tr_b16 a[172:173], v203 offset:16384
    buffer_load_dwordx4 v213, s[20:23], s35 offen offset:1024 lds
    v_mfma_f32_16x16x32_bf16 v[92:95], a[140:143], v[12:15], v[92:95]
    s_waitcnt lgkmcnt(11)
    ds_read_b64_tr_b16 a[174:175], v203 offset:17408
    v_mfma_f32_16x16x32_bf16 v[96:99], a[144:147], v[8:11], v[96:99]
    s_and_b32 s41, s41, 3
    ds_read_b64_tr_b16 a[176:177], v204 offset:16384
    v_mfma_f32_16x16x32_bf16 v[100:103], a[144:147], v[12:15], v[100:103]
    s_and_b32 s70, s40, 0xfffffffc
    ds_read_b64_tr_b16 a[178:179], v204 offset:17408
    v_mfma_f32_16x16x32_bf16 v[104:107], a[148:151], v[8:11], v[104:107]
    ds_read_b64_tr_b16 a[180:181], v205 offset:16384
    buffer_load_dwordx4 v214, s[20:23], s35 offen offset:2048 lds
    v_mfma_f32_16x16x32_bf16 v[108:111], a[148:151], v[12:15], v[108:111]
    s_waitcnt lgkmcnt(11)
    ds_read_b64_tr_b16 a[182:183], v205 offset:17408
    v_mfma_f32_16x16x32_bf16 v[112:115], a[152:155], v[8:11], v[112:115]
    s_or_b32 s41, s41, s70
    ds_read_b64_tr_b16 a[184:185], v206 offset:16384
    v_mfma_f32_16x16x32_bf16 v[116:119], a[152:155], v[12:15], v[116:119]
    s_mul_i32 s36, s41, 245760
    ds_read_b64_tr_b16 a[186:187], v206 offset:17408
    v_mfma_f32_16x16x32_bf16 v[120:123], a[156:159], v[8:11], v[120:123]
    ds_read_b64_tr_b16 a[188:189], v207 offset:16384
    buffer_load_dwordx4 v215, s[20:23], s35 offen offset:3072 lds
    v_mfma_f32_16x16x32_bf16 v[124:127], a[156:159], v[12:15], v[124:127]
    s_waitcnt lgkmcnt(11)
    ds_read_b64_tr_b16 a[190:191], v207 offset:17408
    v_mfma_f32_16x16x32_bf16 v[64:67], a[160:163], v[16:19], v[64:67]
    s_add_u32 s37, s36, 122880
    ds_read_b64_tr_b16 a[128:129], v200 offset:24576
    v_mfma_f32_16x16x32_bf16 v[68:71], a[160:163], v[20:23], v[68:71]
    ds_read_b64_tr_b16 a[130:131], v200 offset:25600
    buffer_load_dwordx4 v[0:3], v193, s[24:27], s36 offen offset:0 sc1
    v_mfma_f32_16x16x32_bf16 v[72:75], a[164:167], v[16:19], v[72:75]
    ds_read_b64_tr_b16 a[132:133], v201 offset:24576
    v_mfma_f32_16x16x32_bf16 v[76:79], a[164:167], v[20:23], v[76:79]
    s_waitcnt lgkmcnt(11)
    ds_read_b64_tr_b16 a[134:135], v201 offset:25600
    v_mfma_f32_16x16x32_bf16 v[80:83], a[168:171], v[16:19], v[80:83]
    ds_read_b64_tr_b16 a[136:137], v202 offset:24576
    v_mfma_f32_16x16x32_bf16 v[84:87], a[168:171], v[20:23], v[84:87]
    ds_read_b64_tr_b16 a[138:139], v202 offset:25600
    buffer_load_dwordx4 v[4:7], v193, s[24:27], s36 offen offset:256 sc1
    v_mfma_f32_16x16x32_bf16 v[88:91], a[172:175], v[16:19], v[88:91]
    ds_read_b64_tr_b16 a[140:141], v203 offset:24576
    v_mfma_f32_16x16x32_bf16 v[92:95], a[172:175], v[20:23], v[92:95]
    s_waitcnt lgkmcnt(11)
    ds_read_b64_tr_b16 a[142:143], v203 offset:25600
    v_mfma_f32_16x16x32_bf16 v[96:99], a[176:179], v[16:19], v[96:99]
    ds_read_b64_tr_b16 a[144:145], v204 offset:24576
    v_mfma_f32_16x16x32_bf16 v[100:103], a[176:179], v[20:23], v[100:103]
    ds_read_b64_tr_b16 a[146:147], v204 offset:25600
    buffer_load_dwordx4 v[8:11], v193, s[24:27], s37 offen offset:0 sc1
    v_mfma_f32_16x16x32_bf16 v[104:107], a[180:183], v[16:19], v[104:107]
    ds_read_b64_tr_b16 a[148:149], v205 offset:24576
    v_mfma_f32_16x16x32_bf16 v[108:111], a[180:183], v[20:23], v[108:111]
    s_waitcnt lgkmcnt(11)
    ds_read_b64_tr_b16 a[150:151], v205 offset:25600
    v_mfma_f32_16x16x32_bf16 v[112:115], a[184:187], v[16:19], v[112:115]
    ds_read_b64_tr_b16 a[152:153], v206 offset:24576
    v_mfma_f32_16x16x32_bf16 v[116:119], a[184:187], v[20:23], v[116:119]
    ds_read_b64_tr_b16 a[154:155], v206 offset:25600
    buffer_load_dwordx4 v[12:15], v193, s[24:27], s37 offen offset:256 sc1
    v_mfma_f32_16x16x32_bf16 v[120:123], a[188:191], v[16:19], v[120:123]
    s_lshl_b32 s35, s41, 17
    ds_read_b64_tr_b16 a[156:157], v207 offset:24576
    v_mfma_f32_16x16x32_bf16 v[124:127], a[188:191], v[20:23], v[124:127]
    s_waitcnt lgkmcnt(11)
    s_add_u32 s35, s35, s58
    ds_read_b64_tr_b16 a[158:159], v207 offset:25600
    v_mfma_f32_16x16x32_bf16 v[64:67], a[128:131], v[24:27], v[64:67]
    s_waitcnt vmcnt(12)
    s_barrier
    ds_read_b64_tr_b16 a[160:161], v200 offset:32768
    v_mfma_f32_16x16x32_bf16 v[68:71], a[128:131], v[28:31], v[68:71]
    s_mov_b32 m0, s39
    ds_read_b64_tr_b16 a[162:163], v200 offset:33792
    v_mfma_f32_16x16x32_bf16 v[72:75], a[132:135], v[24:27], v[72:75]
    ds_read_b64_tr_b16 a[164:165], v201 offset:32768
    buffer_load_dwordx4 v212, s[20:23], s35 offen offset:0 lds
    v_mfma_f32_16x16x32_bf16 v[76:79], a[132:135], v[28:31], v[76:79]
    s_waitcnt lgkmcnt(11)
    ds_read_b64_tr_b16 a[166:167], v201 offset:33792
    v_mfma_f32_16x16x32_bf16 v[80:83], a[136:139], v[24:27], v[80:83]
    s_add_u32 s40, s40, 1
    ds_read_b64_tr_b16 a[168:169], v202 offset:32768
    v_mfma_f32_16x16x32_bf16 v[84:87], a[136:139], v[28:31], v[84:87]
    s_add_u32 s41, s40, s68
    ds_read_b64_tr_b16 a[170:171], v202 offset:33792
    v_mfma_f32_16x16x32_bf16 v[88:91], a[140:143], v[24:27], v[88:91]
    ds_read_b64_tr_b16 a[172:173], v203 offset:32768
    buffer_load_dwordx4 v213, s[20:23], s35 offen offset:1024 lds
    v_mfma_f32_16x16x32_bf16 v[92:95], a[140:143], v[28:31], v[92:95]
    s_waitcnt lgkmcnt(11)
    ds_read_b64_tr_b16 a[174:175], v203 offset:33792
    v_mfma_f32_16x16x32_bf16 v[96:99], a[144:147], v[24:27], v[96:99]
    s_and_b32 s41, s41, 3
    ds_read_b64_tr_b16 a[176:177], v204 offset:32768
    v_mfma_f32_16x16x32_bf16 v[100:103], a[144:147], v[28:31], v[100:103]
    s_and_b32 s70, s40, 0xfffffffc
    ds_read_b64_tr_b16 a[178:179], v204 offset:33792
    v_mfma_f32_16x16x32_bf16 v[104:107], a[148:151], v[24:27], v[104:107]
    ds_read_b64_tr_b16 a[180:181], v205 offset:32768
    buffer_load_dwordx4 v214, s[20:23], s35 offen offset:2048 lds
    v_mfma_f32_16x16x32_bf16 v[108:111], a[148:151], v[28:31], v[108:111]
    s_waitcnt lgkmcnt(11)
    ds_read_b64_tr_b16 a[182:183], v205 offset:33792
    v_mfma_f32_16x16x32_bf16 v[112:115], a[152:155], v[24:27], v[112:115]
    s_or_b32 s41, s41, s70
    ds_read_b64_tr_b16 a[184:185], v206 offset:32768
    v_mfma_f32_16x16x32_bf16 v[116:119], a[152:155], v[28:31], v[116:119]
    s_mul_i32 s36, s41, 245760
    ds_read_b64_tr_b16 a[186:187], v206 offset:33792
    v_mfma_f32_16x16x32_bf16 v[120:123], a[156:159], v[24:27], v[120:123]
    ds_read_b64_tr_b16 a[188:189], v207 offset:32768
    buffer_load_dwordx4 v215, s[20:23], s35 offen offset:3072 lds
    v_mfma_f32_16x16x32_bf16 v[124:127], a[156:159], v[28:31], v[124:127]
    s_waitcnt lgkmcnt(11)
    ds_read_b64_tr_b16 a[190:191], v207 offset:33792
    v_mfma_f32_16x16x32_bf16 v[64:67], a[160:163], v[32:35], v[64:67]
    s_add_u32 s37, s36, 122880
    ds_read_b64_tr_b16 a[128:129], v200 offset:40960
    v_mfma_f32_16x16x32_bf16 v[68:71], a[160:163], v[36:39], v[68:71]
    ds_read_b64_tr_b16 a[130:131], v200 offset:41984
    buffer_load_dwordx4 v[16:19], v193, s[24:27], s36 offen offset:0 sc1
    v_mfma_f32_16x16x32_bf16 v[72:75], a[164:167], v[32:35], v[72:75]
    ds_read_b64_tr_b16 a[132:133], v201 offset:40960
    v_mfma_f32_16x16x32_bf16 v[76:79], a[164:167], v[36:39], v[76:79]
    s_waitcnt lgkmcnt(11)
    ds_read_b64_tr_b16 a[134:135], v201 offset:41984
    v_mfma_f32_16x16x32_bf16 v[80:83], a[168:171], v[32:35], v[80:83]
    ds_read_b64_tr_b16 a[136:137], v202 offset:40960
    v_mfma_f32_16x16x32_bf16 v[84:87], a[168:171], v[36:39], v[84:87]
    ds_read_b64_tr_b16 a[138:139], v202 offset:41984
    buffer_load_dwordx4 v[20:23], v193, s[24:27], s36 offen offset:256 sc1
    v_mfma_f32_16x16x32_bf16 v[88:91], a[172:175], v[32:35], v[88:91]
    ds_read_b64_tr_b16 a[140:141], v203 offset:40960
    v_mfma_f32_16x16x32_bf16 v[92:95], a[172:175], v[36:39], v[92:95]
    s_waitcnt lgkmcnt(11)
    ds_read_b64_tr_b16 a[142:143], v203 offset:41984
    v_mfma_f32_16x16x32_bf16 v[96:99], a[176:179], v[32:35], v[96:99]
    ds_read_b64_tr_b16 a[144:145], v204 offset:40960
    v_mfma_f32_16x16x32_bf16 v[100:103], a[176:179], v[36:39], v[100:103]
    ds_read_b64_tr_b16 a[146:147], v204 offset:41984
    buffer_load_dwordx4 v[24:27], v193, s[24:27], s37 offen offset:0 sc1
    v_mfma_f32_16x16x32_bf16 v[104:107], a[180:183], v[32:35], v[104:107]
    ds_read_b64_tr_b16 a[148:149], v205 offset:40960
    v_mfma_f32_16x16x32_bf16 v[108:111], a[180:183], v[36:39], v[108:111]
    s_waitcnt lgkmcnt(11)
    ds_read_b64_tr_b16 a[150:151], v205 offset:41984
    v_mfma_f32_16x16x32_bf16 v[112:115], a[184:187], v[32:35], v[112:115]
    ds_read_b64_tr_b16 a[152:153], v206 offset:40960
    v_mfma_f32_16x16x32_bf16 v[116:119], a[184:187], v[36:39], v[116:119]
    ds_read_b64_tr_b16 a[154:155], v206 offset:41984
    buffer_load_dwordx4 v[28:31], v193, s[24:27], s37 offen offset:256 sc1
    v_mfma_f32_16x16x32_bf16 v[120:123], a[188:191], v[32:35], v[120:123]
    s_lshl_b32 s35, s41, 17
    ds_read_b64_tr_b16 a[156:157], v207 offset:40960
    v_mfma_f32_16x16x32_bf16 v[124:127], a[188:191], v[36:39], v[124:127]
    s_waitcnt lgkmcnt(11)
    s_add_u32 s35, s35, s58
    ds_read_b64_tr_b16 a[158:159], v207 offset:41984
    v_mfma_f32_16x16x32_bf16 v[64:67], a[128:131], v[40:43], v[64:67]
    s_waitcnt vmcnt(12)
    s_barrier
    ds_read_b64_tr_b16 a[160:161], v200 offset:49152
    v_mfma_f32_16x16x32_bf16 v[68:71], a[128:131], v[44:47], v[68:71]
    s_add_u32 m0, s39, 16384
    ds_read_b64_tr_b16 a[162:163], v200 offset:50176
    v_mfma_f32_16x16x32_bf16 v[72:75], a[132:135], v[40:43], v[72:75]
    ds_read_b64_tr_b16 a[164:165], v201 offset:49152
    buffer_load_dwordx4 v212, s[20:23], s35 offen offset:0 lds
    v_mfma_f32_16x16x32_bf16 v[76:79], a[132:135], v[44:47], v[76:79]
    s_waitcnt lgkmcnt(11)
    ds_read_b64_tr_b16 a[166:167], v201 offset:50176
    v_mfma_f32_16x16x32_bf16 v[80:83], a[136:139], v[40:43], v[80:83]
    s_add_u32 s40, s40, 1
    ds_read_b64_tr_b16 a[168:169], v202 offset:49152
    v_mfma_f32_16x16x32_bf16 v[84:87], a[136:139], v[44:47], v[84:87]
    s_add_u32 s41, s40, s68
    ds_read_b64_tr_b16 a[170:171], v202 offset:50176
    v_mfma_f32_16x16x32_bf16 v[88:91], a[140:143], v[40:43], v[88:91]
    ds_read_b64_tr_b16 a[172:173], v203 offset:49152
    buffer_load_dwordx4 v213, s[20:23], s35 offen offset:1024 lds
    v_mfma_f32_16x16x32_bf16 v[92:95], a[140:143], v[44:47], v[92:95]
    s_waitcnt lgkmcnt(11)
    ds_read_b64_tr_b16 a[174:175], v203 offset:50176
    v_mfma_f32_16x16x32_bf16 v[96:99], a[144:147], v[40:43], v[96:99]
    s_and_b32 s41, s41, 3
    ds_read_b64_tr_b16 a[176:177], v204 offset:49152
    v_mfma_f32_16x16x32_bf16 v[100:103], a[144:147], v[44:47], v[100:103]
    s_and_b32 s70, s40, 0xfffffffc
    ds_read_b64_tr_b16 a[178:179], v204 offset:50176
    v_mfma_f32_16x16x32_bf16 v[104:107], a[148:151], v[40:43], v[104:107]
    ds_read_b64_tr_b16 a[180:181], v205 offset:49152
    buffer_load_dwordx4 v214, s[20:23], s35 offen offset:2048 lds
    v_mfma_f32_16x16x32_bf16 v[108:111], a[148:151], v[44:47], v[108:111]
    s_waitcnt lgkmcnt(11)
    ds_read_b64_tr_b16 a[182:183], v205 offset:50176
    v_mfma_f32_16x16x32_bf16 v[112:115], a[152:155], v[40:43], v[112:115]
    s_or_b32 s41, s41, s70
    ds_read_b64_tr_b16 a[184:185], v206 offset:49152
    v_mfma_f32_16x16x32_bf16 v[116:119], a[152:155], v[44:47], v[116:119]
    s_mul_i32 s36, s41, 245760
    ds_read_b64_tr_b16 a[186:187], v206 offset:50176
    v_mfma_f32_16x16x32_bf16 v[120:123], a[156:159], v[40:43], v[120:123]
    ds_read_b64_tr_b16 a[188:189], v207 offset:49152
    buffer_load_dwordx4 v215, s[20:23], s35 offen offset:3072 lds
    v_mfma_f32_16x16x32_bf16 v[124:127], a[156:159], v[44:47], v[124:127]
    s_waitcnt lgkmcnt(11)
    ds_read_b64_tr_b16 a[190:191], v207 offset:50176
    v_mfma_f32_16x16x32_bf16 v[64:67], a[160:163], v[48:51], v[64:67]
    s_add_u32 s37, s36, 122880
    ds_read_b64_tr_b16 a[128:129], v200 offset:57344
    v_mfma_f32_16x16x32_bf16 v[68:71], a[160:163], v[52:55], v[68:71]
    ds_read_b64_tr_b16 a[130:131], v200 offset:58368
    buffer_load_dwordx4 v[32:35], v193, s[24:27], s36 offen offset:0 sc1
    v_mfma_f32_16x16x32_bf16 v[72:75], a[164:167], v[48:51], v[72:75]
    ds_read_b64_tr_b16 a[132:133], v201 offset:57344
    v_mfma_f32_16x16x32_bf16 v[76:79], a[164:167], v[52:55], v[76:79]
    s_waitcnt lgkmcnt(11)
    ds_read_b64_tr_b16 a[134:135], v201 offset:58368
    v_mfma_f32_16x16x32_bf16 v[80:83], a[168:171], v[48:51], v[80:83]
    ds_read_b64_tr_b16 a[136:137], v202 offset:57344
    v_mfma_f32_16x16x32_bf16 v[84:87], a[168:171], v[52:55], v[84:87]
    ds_read_b64_tr_b16 a[138:139], v202 offset:58368
    buffer_load_dwordx4 v[36:39], v193, s[24:27], s36 offen offset:256 sc1
    v_mfma_f32_16x16x32_bf16 v[88:91], a[172:175], v[48:51], v[88:91]
    ds_read_b64_tr_b16 a[140:141], v203 offset:57344
    v_mfma_f32_16x16x32_bf16 v[92:95], a[172:175], v[52:55], v[92:95]
    s_waitcnt lgkmcnt(11)
    ds_read_b64_tr_b16 a[142:143], v203 offset:58368
    v_mfma_f32_16x16x32_bf16 v[96:99], a[176:179], v[48:51], v[96:99]
    ds_read_b64_tr_b16 a[144:145], v204 offset:57344
    v_mfma_f32_16x16x32_bf16 v[100:103], a[176:179], v[52:55], v[100:103]
    ds_read_b64_tr_b16 a[146:147], v204 offset:58368
    buffer_load_dwordx4 v[40:43], v193, s[24:27], s37 offen offset:0 sc1
    v_mfma_f32_16x16x32_bf16 v[104:107], a[180:183], v[48:51], v[104:107]
    ds_read_b64_tr_b16 a[148:149], v205 offset:57344
    v_mfma_f32_16x16x32_bf16 v[108:111], a[180:183], v[52:55], v[108:111]
    s_waitcnt lgkmcnt(11)
    ds_read_b64_tr_b16 a[150:151], v205 offset:58368
    v_mfma_f32_16x16x32_bf16 v[112:115], a[184:187], v[48:51], v[112:115]
    ds_read_b64_tr_b16 a[152:153], v206 offset:57344
    v_mfma_f32_16x16x32_bf16 v[116:119], a[184:187], v[52:55], v[116:119]
    ds_read_b64_tr_b16 a[154:155], v206 offset:58368
    buffer_load_dwordx4 v[44:47], v193, s[24:27], s37 offen offset:256 sc1
    v_mfma_f32_16x16x32_bf16 v[120:123], a[188:191], v[48:51], v[120:123]
    s_lshl_b32 s35, s41, 17
    ds_read_b64_tr_b16 a[156:157], v207 offset:57344
    v_mfma_f32_16x16x32_bf16 v[124:127], a[188:191], v[52:55], v[124:127]
    s_waitcnt lgkmcnt(11)
    s_add_u32 s35, s35, s58
    ds_read_b64_tr_b16 a[158:159], v207 offset:58368
    v_mfma_f32_16x16x32_bf16 v[64:67], a[128:131], v[56:59], v[64:67]
    s_waitcnt vmcnt(12)
    s_barrier
    ds_read_b64_tr_b16 a[160:161], v200 offset:0
    v_mfma_f32_16x16x32_bf16 v[68:71], a[128:131], v[60:63], v[68:71]
    s_add_u32 m0, s39, 32768
    ds_read_b64_tr_b16 a[162:163], v200 offset:1024
    v_mfma_f32_16x16x32_bf16 v[72:75], a[132:135], v[56:59], v[72:75]
    ds_read_b64_tr_b16 a[164:165], v201 offset:0
    buffer_load_dwordx4 v212, s[20:23], s35 offen offset:0 lds
    v_mfma_f32_16x16x32_bf16 v[76:79], a[132:135], v[60:63], v[76:79]
    s_waitcnt lgkmcnt(11)
    ds_read_b64_tr_b16 a[166:167], v201 offset:1024
    v_mfma_f32_16x16x32_bf16 v[80:83], a[136:139], v[56:59], v[80:83]
    s_add_u32 s40, s40, 1
    ds_read_b64_tr_b16 a[168:169], v202 offset:0
    v_mfma_f32_16x16x32_bf16 v[84:87], a[136:139], v[60:63], v[84:87]
    s_add_u32 s41, s40, s68
    ds_read_b64_tr_b16 a[170:171], v202 offset:1024
    v_mfma_f32_16x16x32_bf16 v[88:91], a[140:143], v[56:59], v[88:91]
    ds_read_b64_tr_b16 a[172:173], v203 offset:0
    buffer_load_dwordx4 v213, s[20:23], s35 offen offset:1024 lds
    v_mfma_f32_16x16x32_bf16 v[92:95], a[140:143], v[60:63], v[92:95]
    s_waitcnt lgkmcnt(11)
    ds_read_b64_tr_b16 a[174:175], v203 offset:1024
    v_mfma_f32_16x16x32_bf16 v[96:99], a[144:147], v[56:59], v[96:99]
    s_and_b32 s41, s41, 3
    ds_read_b64_tr_b16 a[176:177], v204 offset:0
    v_mfma_f32_16x16x32_bf16 v[100:103], a[144:147], v[60:63], v[100:103]
    s_and_b32 s70, s40, 0xfffffffc
    ds_read_b64_tr_b16 a[178:179], v204 offset:1024
    v_mfma_f32_16x16x32_bf16 v[104:107], a[148:151], v[56:59], v[104:107]
    ds_read_b64_tr_b16 a[180:181], v205 offset:0
    buffer_load_dwordx4 v214, s[20:23], s35 offen offset:2048 lds
    v_mfma_f32_16x16x32_bf16 v[108:111], a[148:151], v[60:63], v[108:111]
    s_waitcnt lgkmcnt(11)
    ds_read_b64_tr_b16 a[182:183], v205 offset:1024
    v_mfma_f32_16x16x32_bf16 v[112:115], a[152:155], v[56:59], v[112:115]
    s_or_b32 s41, s41, s70
    ds_read_b64_tr_b16 a[184:185], v206 offset:0
    v_mfma_f32_16x16x32_bf16 v[116:119], a[152:155], v[60:63], v[116:119]
    s_mul_i32 s36, s41, 245760
    s_sub_u32 s44, s44, 1
    ds_read_b64_tr_b16 a[186:187], v206 offset:1024
    v_mfma_f32_16x16x32_bf16 v[120:123], a[156:159], v[56:59], v[120:123]
    ds_read_b64_tr_b16 a[188:189], v207 offset:0
    buffer_load_dwordx4 v215, s[20:23], s35 offen offset:3072 lds
    v_mfma_f32_16x16x32_bf16 v[124:127], a[156:159], v[60:63], v[124:127]
    s_waitcnt lgkmcnt(11)
    ds_read_b64_tr_b16 a[190:191], v207 offset:1024
    s_cmp_lg_u32 s44, 0
    s_cbranch_scc1 L_k2_loop
    s_cmp_eq_u32 s43, 0
    s_cbranch_scc1 L_k2_tail
    s_cmp_eq_u32 s43, 2
    s_cbranch_scc0 L_k2_chk
    global_load_dword v244, v195, s[62:63] sc1
    s_mov_b32 s43, 1
    s_mov_b32 s44, 1
    s_branch L_k2_loop
L_k2_chk:
    s_add_u32 s72, s101, 1
    v_readlane_b32 s70, v244, s72
    s_add_u32 s72, s59, 1
    v_readlane_b32 s71, v244, s72
    s_min_u32 s70, s70, s71
    s_cmp_ge_u32 s70, 16
    s_cbranch_scc0 L_k2_spin1
L_k2_go1:
    s_mov_b32 s43, 0
    s_mov_b32 s44, 8
    s_branch L_k2_loop
L_k2_tail:
    v_mfma_f32_16x16x32_bf16 v[64:67], a[160:163], v[0:3], v[64:67]
    s_add_u32 s37, s36, 122880
    ds_read_b64_tr_b16 a[128:129], v200 offset:8192
    v_mfma_f32_16x16x32_bf16 v[68:71], a[160:163], v[4:7], v[68:71]
    ds_read_b64_tr_b16 a[130:131], v200 offset:9216
    buffer_load_dwordx4 v[48:51], v193, s[24:27], s36 offen offset:0 sc1
    v_mfma_f32_16x16x32_bf16 v[72:75], a[164:167], v[0:3], v[72:75]
    ds_read_b64_tr_b16 a[132:133], v201 offset:8192
    v_mfma_f32_16x16x32_bf16 v[76:79], a[164:167], v[4:7], v[76:79]
    s_waitcnt lgkmcnt(11)
    ds_read_b64_tr_b16 a[134:135], v201 offset:9216
    v_mfma_f32_16x16x32_bf16 v[80:83], a[168:171], v[0:3], v[80:83]
    ds_read_b64_tr_b16 a[136:137], v202 offset:8192
    v_mfma_f32_16x16x32_bf16 v[84:87], a[168:171], v[4:7], v[84:87]
    ds_read_b64_tr_b16 a[138:139], v202 offset:9216
    buffer_load_dwordx4 v[52:55], v193, s[24:27], s36 offen offset:256 sc1
    v_mfma_f32_16x16x32_bf16 v[88:91], a[172:175], v[0:3], v[88:91]
    ds_read_b64_tr_b16 a[140:141], v203 offset:8192
    v_mfma_f32_16x16x32_bf16 v[92:95], a[172:175], v[4:7], v[92:95]
    s_waitcnt lgkmcnt(11)
    ds_read_b64_tr_b16 a[142:143], v203 offset:9216
    v_mfma_f32_16x16x32_bf16 v[96:99], a[176:179], v[0:3], v[96:99]
    ds_read_b64_tr_b16 a[144:145], v204 offset:8192
    v_mfma_f32_16x16x32_bf16 v[100:103], a[176:179], v[4:7], v[100:103]
    ds_read_b64_tr_b16 a[146:147], v204 offset:9216
    buffer_load_dwordx4 v[56:59], v193, s[24:27], s37 offen offset:0 sc1
    v_mfma_f32_16x16x32_bf16 v[104:107], a[180:183], v[0:3], v[104:107]
    ds_read_b64_tr_b16 a[148:149], v205 offset:8192
    v_mfma_f32_16x16x32_bf16 v[108:111], a[180:183], v[4:7], v[108:111]
    s_waitcnt lgkmcnt(11)
    ds_read_b64_tr_b16 a[150:151], v205 offset:9216
    v_mfma_f32_16x16x32_bf16 v[112:115], a[184:187], v[0:3], v[112:115]
    ds_read_b64_tr_b16 a[152:153], v206 offset:8192
    v_mfma_f32_16x16x32_bf16 v[116:119], a[184:187], v[4:7], v[116:119]
    ds_read_b64_tr_b16 a[154:155], v206 offset:9216
    buffer_load_dwordx4 v[60:63], v193, s[24:27], s37 offen offset:256 sc1
    v_mfma_f32_16x16x32_bf16 v[120:123], a[188:191], v[0:3], v[120:123]
    s_lshl_b32 s35, s41, 17
    ds_read_b64_tr_b16 a[156:157], v207 offset:8192
    v_mfma_f32_16x16x32_bf16 v[124:127], a[188:191], v[4:7], v[124:127]
    s_waitcnt lgkmcnt(11)
    s_add_u32 s35, s35, s58
    ds_read_b64_tr_b16 a[158:159], v207 offset:9216
    v_mfma_f32_16x16x32_bf16 v[64:67], a[128:131], v[8:11], v[64:67]
    s_waitcnt vmcnt(12)
    s_barrier
    s_add_u32 m0, s39, 49152
    ds_read_b64_tr_b16 a[160:161], v200 offset:16384
    v_mfma_f32_16x16x32_bf16 v[68:71], a[128:131], v[12:15], v[68:71]
    ds_read_b64_tr_b16 a[162:163], v200 offset:17408
    buffer_load_dwordx4 v212, s[20:23], s35 offen offset:0 lds
    v_mfma_f32_16x16x32_bf16 v[72:75], a[132:135], v[8:11], v[72:75]
    ds_read_b64_tr_b16 a[164:165], v201 offset:16384
    buffer_load_dwordx4 v213, s[20:23], s35 offen offset:1024 lds
    v_mfma_f32_16x16x32_bf16 v[76:79], a[132:135], v[12:15], v[76:79]
    s_waitcnt lgkmcnt(11)
    ds_read_b64_tr_b16 a[166:167], v201 offset:17408
    buffer_load_dwordx4 v214, s[20:23], s35 offen offset:2048 lds
    v_mfma_f32_16x16x32_bf16 v[80:83], a[136:139], v[8:11], v[80:83]
    ds_read_b64_tr_b16 a[168:169], v202 offset:16384
    buffer_load_dwordx4 v215, s[20:23], s35 offen offset:3072 lds
    v_mfma_f32_16x16x32_bf16 v[84:87], a[136:139], v[12:15], v[84:87]
    ds_read_b64_tr_b16 a[170:171], v202 offset:17408
    v_mfma_f32_16x16x32_bf16 v[88:91], a[140:143], v[8:11], v[88:91]
    ds_read_b64_tr_b16 a[172:173], v203 offset:16384
    v_mfma_f32_16x16x32_bf16 v[92:95], a[140:143], v[12:15], v[92:95]
    s_waitcnt lgkmcnt(11)
    ds_read_b64_tr_b16 a[174:175], v203 offset:17408
    v_mfma_f32_16x16x32_bf16 v[96:99], a[144:147], v[8:11], v[96:99]
    ds_read_b64_tr_b16 a[176:177], v204 offset:16384
    v_mfma_f32_16x16x32_bf16 v[100:103], a[144:147], v[12:15], v[100:103]
    ds_read_b64_tr_b16 a[178:179], v204 offset:17408
    v_mfma_f32_16x16x32_bf16 v[104:107], a[148:151], v[8:11], v[104:107]
    ds_read_b64_tr_b16 a[180:181], v205 offset:16384
    v_mfma_f32_16x16x32_bf16 v[108:111], a[148:151], v[12:15], v[108:111]
    s_waitcnt lgkmcnt(11)
    ds_read_b64_tr_b16 a[182:183], v205 offset:17408
    v_mfma_f32_16x16x32_bf16 v[112:115], a[152:155], v[8:11], v[112:115]
    ds_read_b64_tr_b16 a[184:185], v206 offset:16384
    v_mfma_f32_16x16x32_bf16 v[116:119], a[152:155], v[12:15], v[116:119]
    ds_read_b64_tr_b16 a[186:187], v206 offset:17408
    v_mfma_f32_16x16x32_bf16 v[120:123], a[156:159], v[8:11], v[120:123]
    ds_read_b64_tr_b16 a[188:189], v207 offset:16384
    v_mfma_f32_16x16x32_bf16 v[124:127], a[156:159], v[12:15], v[124:127]
    s_waitcnt lgkmcnt(11)
    ds_read_b64_tr_b16 a[190:191], v207 offset:17408
    v_mfma_f32_16x16x32_bf16 v[64:67], a[160:163], v[16:19], v[64:67]
    ds_read_b64_tr_b16 a[128:129], v200 offset:24576
    v_mfma_f32_16x16x32_bf16 v[68:71], a[160:163], v[20:23], v[68:71]
    ds_read_b64_tr_b16 a[130:131], v200 offset:25600
    v_mfma_f32_16x16x32_bf16 v[72:75], a[164:167], v[16:19], v[72:75]
    ds_read_b64_tr_b16 a[132:133], v201 offset:24576
    v_mfma_f32_16x16x32_bf16 v[76:79], a[164:167], v[20:23], v[76:79]
    s_waitcnt lgkmcnt(11)
    ds_read_b64_tr_b16 a[134:135], v201 offset:25600
    v_mfma_f32_16x16x32_bf16 v[80:83], a[168:171], v[16:19], v[80:83]
    ds_read_b64_tr_b16 a[136:137], v202 offset:24576
    v_mfma_f32_16x16x32_bf16 v[84:87], a[168:171], v[20:23], v[84:87]
    ds_read_b64_tr_b16 a[138:139], v202 offset:25600
    v_mfma_f32_16x16x32_bf16 v[88:91], a[172:175], v[16:19], v[88:91]
    ds_read_b64_tr_b16 a[140:141], v203 offset:24576
    v_mfma_f32_16x16x32_bf16 v[92:95], a[172:175], v[20:23], v[92:95]
    s_waitcnt lgkmcnt(11)
    ds_read_b64_tr_b16 a[142:143], v203 offset:25600
    v_mfma_f32_16x16x32_bf16 v[96:99], a[176:179], v[16:19], v[96:99]
    ds_read_b64_tr_b16 a[144:145], v204 offset:24576
    v_mfma_f32_16x16x32_bf16 v[100:103], a[176:179], v[20:23], v[100:103]
    ds_read_b64_tr_b16 a[146:147], v204 offset:25600
    v_mfma_f32_16x16x32_bf16 v[104:107], a[180:183], v[16:19], v[104:107]
    ds_read_b64_tr_b16 a[148:149], v205 offset:24576
    v_mfma_f32_16x16x32_bf16 v[108:111], a[180:183], v[20:23], v[108:111]
    s_waitcnt lgkmcnt(11)
    ds_read_b64_tr_b16 a[150:151], v205 offset:25600
    v_mfma_f32_16x16x32_bf16 v[112:115], a[184:187], v[16:19], v[112:115]
    ds_read_b64_tr_b16 a[152:153], v206 offset:24576
    v_mfma_f32_16x16x32_bf16 v[116:119], a[184:187], v[20:23], v[116:119]
    ds_read_b64_tr_b16 a[154:155], v206 offset:25600
    v_mfma_f32_16x16x32_bf16 v[120:123], a[188:191], v[16:19], v[120:123]
    ds_read_b64_tr_b16 a[156:157], v207 offset:24576
    v_mfma_f32_16x16x32_bf16 v[124:127], a[188:191], v[20:23], v[124:127]
    s_waitcnt lgkmcnt(11)
    ds_read_b64_tr_b16 a[158:159], v207 offset:25600
    v_mfma_f32_16x16x32_bf16 v[64:67], a[128:131], v[24:27], v[64:67]
    s_waitcnt vmcnt(8)
    s_barrier
    ds_read_b64_tr_b16 a[160:161], v200 offset:32768
    v_mfma_f32_16x16x32_bf16 v[68:71], a[128:131], v[28:31], v[68:71]
    ds_read_b64_tr_b16 a[162:163], v200 offset:33792
    v_mfma_f32_16x16x32_bf16 v[72:75], a[132:135], v[24:27], v[72:75]
    ds_read_b64_tr_b16 a[164:165], v201 offset:32768
    v_mfma_f32_16x16x32_bf16 v[76:79], a[132:135], v[28:31], v[76:79]
    s_waitcnt lgkmcnt(11)
    ds_read_b64_tr_b16 a[166:167], v201 offset:33792
    v_mfma_f32_16x16x32_bf16 v[80:83], a[136:139], v[24:27], v[80:83]
    ds_read_b64_tr_b16 a[168:169], v200 offset:40960
    v_mfma_f32_16x16x32_bf16 v[84:87], a[136:139], v[28:31], v[84:87]
    ds_read_b64_tr_b16 a[170:171], v200 offset:41984
    v_mfma_f32_16x16x32_bf16 v[88:91], a[140:143], v[24:27], v[88:91]
    ds_read_b64_tr_b16 a[172:173], v201 offset:40960
    v_mfma_f32_16x16x32_bf16 v[92:95], a[140:143], v[28:31], v[92:95]
    s_waitcnt lgkmcnt(11)
    ds_read_b64_tr_b16 a[174:175], v201 offset:41984
    v_mfma_f32_16x16x32_bf16 v[96:99], a[144:147], v[24:27], v[96:99]
    ds_read_b64_tr_b16 a[176:177], v202 offset:32768
    v_mfma_f32_16x16x32_bf16 v[100:103], a[144:147], v[28:31], v[100:103]
    ds_read_b64_tr_b16 a[178:179], v202 offset:33792
    v_mfma_f32_16x16x32_bf16 v[104:107], a[148:151], v[24:27], v[104:107]
    ds_read_b64_tr_b16 a[180:181], v203 offset:32768
    v_mfma_f32_16x16x32_bf16 v[108:111], a[148:151], v[28:31], v[108:111]
    s_waitcnt lgkmcnt(11)
    ds_read_b64_tr_b16 a[182:183], v203 offset:33792
    v_mfma_f32_16x16x32_bf16 v[112:115], a[152:155], v[24:27], v[112:115]
    ds_read_b64_tr_b16 a[184:185], v202 offset:40960
    v_mfma_f32_16x16x32_bf16 v[116:119], a[152:155], v[28:31], v[116:119]
    ds_read_b64_tr_b16 a[186:187], v202 offset:41984
    v_mfma_f32_16x16x32_bf16 v[120:123], a[156:159], v[24:27], v[120:123]
    ds_read_b64_tr_b16 a[188:189], v203 offset:40960
    v_mfma_f32_16x16x32_bf16 v[124:127], a[156:159], v[28:31], v[124:127]
    s_waitcnt lgkmcnt(11)
    ds_read_b64_tr_b16 a[190:191], v203 offset:41984
    s_and_b32 s70, s2, 1
    s_lshl_b32 s70, s70, 11
    s_add_u32 s70, s70, s58
    s_add_u32 s71, s70, 65536
    v_mfma_f32_16x16x32_bf16 v[64:67], a[160:163], v[32:35], v[64:67]
    s_waitcnt vmcnt(0)
    s_barrier
    ds_read_b64_tr_b16 a[128:129], v200 offset:49152
    v_mfma_f32_16x16x32_bf16 v[68:71], a[160:163], v[36:39], v[68:71]
    ds_read_b64_tr_b16 a[130:131], v200 offset:50176
    v_mfma_f32_16x16x32_bf16 v[76:79], a[164:167], v[36:39], v[76:79]
    ds_read_b64_tr_b16 a[132:133], v201 offset:49152
    v_mfma_f32_16x16x32_bf16 v[72:75], a[164:167], v[32:35], v[72:75]
    s_waitcnt lgkmcnt(11)
    ds_read_b64_tr_b16 a[134:135], v201 offset:50176
    v_mfma_f32_16x16x32_bf16 v[64:67], a[168:171], v[40:43], v[64:67]
    ds_read_b64_tr_b16 a[136:137], v200 offset:57344
    v_mfma_f32_16x16x32_bf16 v[68:71], a[168:171], v[44:47], v[68:71]
    ds_read_b64_tr_b16 a[138:139], v200 offset:58368
    v_mfma_f32_16x16x32_bf16 v[76:79], a[172:175], v[44:47], v[76:79]
    ds_read_b64_tr_b16 a[140:141], v201 offset:57344
    v_mfma_f32_16x16x32_bf16 v[72:75], a[172:175], v[40:43], v[72:75]
    s_waitcnt lgkmcnt(11)
    ds_read_b64_tr_b16 a[142:143], v201 offset:58368
    v_mfma_f32_16x16x32_bf16 v[80:83], a[176:179], v[32:35], v[80:83]
    ds_read_b64_tr_b16 a[144:145], v202 offset:49152
    v_mfma_f32_16x16x32_bf16 v[84:87], a[176:179], v[36:39], v[84:87]
    ds_read_b64_tr_b16 a[146:147], v202 offset:50176
    v_mfma_f32_16x16x32_bf16 v[92:95], a[180:183], v[36:39], v[92:95]
    ds_read_b64_tr_b16 a[148:149], v203 offset:49152
    v_mfma_f32_16x16x32_bf16 v[88:91], a[180:183], v[32:35], v[88:91]
    s_waitcnt lgkmcnt(11)
    ds_read_b64_tr_b16 a[150:151], v203 offset:50176
    v_mfma_f32_16x16x32_bf16 v[80:83], a[184:187], v[40:43], v[80:83]
    ds_read_b64_tr_b16 a[152:153], v202 offset:57344
    v_mfma_f32_16x16x32_bf16 v[84:87], a[184:187], v[44:47], v[84:87]
    ds_read_b64_tr_b16 a[154:155], v202 offset:58368
    v_mfma_f32_16x16x32_bf16 v[92:95], a[188:191], v[44:47], v[92:95]
    ds_read_b64_tr_b16 a[156:157], v203 offset:57344
    v_mfma_f32_16x16x32_bf16 v[88:91], a[188:191], v[40:43], v[88:91]
    s_waitcnt lgkmcnt(11)
    ds_read_b64_tr_b16 a[158:159], v203 offset:58368
    v_mfma_f32_16x16x32_bf16 v[64:67], a[128:131], v[48:51], v[64:67]
    ds_read_b64_tr_b16 a[160:161], v204 offset:32768
    v_mfma_f32_16x16x32_bf16 v[68:71], a[128:131], v[52:55], v[68:71]
    ds_read_b64_tr_b16 a[162:163], v204 offset:33792
    v_mfma_f32_16x16x32_bf16 v[76:79], a[132:135], v[52:55], v[76:79]
    ds_read_b64_tr_b16 a[164:165], v205 offset:32768
    v_mfma_f32_16x16x32_bf16 v[72:75], a[132:135], v[48:51], v[72:75]
    s_waitcnt lgkmcnt(11)
    ds_read_b64_tr_b16 a[166:167], v205 offset:33792
    v_mfma_f32_16x16x32_bf16 v[64:67], a[136:139], v[56:59], v[64:67]
    ds_read_b64_tr_b16 a[168:169], v204 offset:40960
    v_mfma_f32_16x16x32_bf16 v[68:71], a[136:139], v[60:63], v[68:71]
    ds_read_b64_tr_b16 a[170:171], v204 offset:41984
    v_mfma_f32_16x16x32_bf16 v[76:79], a[140:143], v[60:63], v[76:79]
    ds_read_b64_tr_b16 a[172:173], v205 offset:40960
    v_mfma_f32_16x16x32_bf16 v[72:75], a[140:143], v[56:59], v[72:75]
    s_waitcnt lgkmcnt(11)
    ds_read_b64_tr_b16 a[174:175], v205 offset:41984
    v_mfma_f32_16x16x32_bf16 v[80:83], a[144:147], v[48:51], v[80:83]
    ds_read_b64_tr_b16 a[176:177], v204 offset:49152
    v_mfma_f32_16x16x32_bf16 v[84:87], a[144:147], v[52:55], v[84:87]
    ds_read_b64_tr_b16 a[178:179], v204 offset:50176
    v_mfma_f32_16x16x32_bf16 v[92:95], a[148:151], v[52:55], v[92:95]
    ds_read_b64_tr_b16 a[180:181], v205 offset:49152
    v_mfma_f32_16x16x32_bf16 v[88:91], a[148:151], v[48:51], v[88:91]
    s_waitcnt lgkmcnt(11)
    ds_read_b64_tr_b16 a[182:183], v205 offset:50176
    v_cvt_pk_bf16_f32 v0, v64, v65
    v_cvt_pk_bf16_f32 v1, v66, v67
    v_mfma_f32_16x16x32_bf16 v[80:83], a[152:155], v[56:59], v[80:83]
    ds_read_b64_tr_b16 a[184:185], v204 offset:57344
    v_cvt_pk_bf16_f32 v2, v72, v73
    v_cvt_pk_bf16_f32 v3, v74, v75
    v_mfma_f32_16x16x32_bf16 v[84:87], a[152:155], v[60:63], v[84:87]
    ds_read_b64_tr_b16 a[186:187], v204 offset:58368
    v_permlane32_swap_b32 v0, v2
    v_mfma_f32_16x16x32_bf16 v[92:95], a[156:159], v[60:63], v[92:95]
    ds_read_b64_tr_b16 a[188:189], v205 offset:57344
    v_permlane32_swap_b32 v1, v3
    v_mfma_f32_16x16x32_bf16 v[88:91], a[156:159], v[56:59], v[88:91]
    s_waitcnt lgkmcnt(11)
    ds_read_b64_tr_b16 a[190:191], v205 offset:58368
    v_permlane16_swap_b32 v0, v2
    v_mfma_f32_16x16x32_bf16 v[96:99], a[160:163], v[32:35], v[96:99]
    ds_read_b64_tr_b16 a[128:129], v206 offset:32768
    v_permlane16_swap_b32 v1, v3
    v_mfma_f32_16x16x32_bf16 v[100:103], a[160:163], v[36:39], v[100:103]
    ds_read_b64_tr_b16 a[130:131], v206 offset:33792
    buffer_store_dwordx4 v[0:3], v194, s[16:19], s70 offen offset:0 nt
    v_cvt_pk_bf16_f32 v4, v68, v69
    v_cvt_pk_bf16_f32 v5, v70, v71
    v_mfma_f32_16x16x32_bf16 v[108:111], a[164:167], v[36:39], v[108:111]
    ds_read_b64_tr_b16 a[132:133], v207 offset:32768
    v_cvt_pk_bf16_f32 v6, v76, v77
    v_cvt_pk_bf16_f32 v7, v78, v79
    v_mfma_f32_16x16x32_bf16 v[104:107], a[164:167], v[32:35], v[104:107]
    s_waitcnt lgkmcnt(11)
    ds_read_b64_tr_b16 a[134:135], v207 offset:33792
    v_permlane32_swap_b32 v4, v6
    v_mfma_f32_16x16x32_bf16 v[96:99], a[168:171], v[40:43], v[96:99]
    ds_read_b64_tr_b16 a[136:137], v206 offset:40960
    v_permlane32_swap_b32 v5, v7
    v_mfma_f32_16x16x32_bf16 v[100:103], a[168:171], v[44:47], v[100:103]
    ds_read_b64_tr_b16 a[138:139], v206 offset:41984
    v_permlane16_swap_b32 v4, v6
    v_mfma_f32_16x16x32_bf16 v[108:111], a[172:175], v[44:47], v[108:111]
    ds_read_b64_tr_b16 a[140:141], v207 offset:40960
    v_permlane16_swap_b32 v5, v7
    v_mfma_f32_16x16x32_bf16 v[104:107], a[172:175], v[40:43], v[104:107]
    s_waitcnt lgkmcnt(11)
    ds_read_b64_tr_b16 a[142:143], v207 offset:41984
    buffer_store_dwordx4 v[4:7], v194, s[16:19], s71 offen offset:0 nt
    v_cvt_pk_bf16_f32 v8, v80, v81
    v_cvt_pk_bf16_f32 v9, v82, v83
    v_mfma_f32_16x16x32_bf16 v[96:99], a[176:179], v[48:51], v[96:99]
    ds_read_b64_tr_b16 a[144:145], v206 offset:49152
    v_cvt_pk_bf16_f32 v10, v88, v89
    v_cvt_pk_bf16_f32 v11, v90, v91
    v_mfma_f32_16x16x32_bf16 v[100:103], a[176:179], v[52:55], v[100:103]
    ds_read_b64_tr_b16 a[146:147], v206 offset:50176
    v_permlane32_swap_b32 v8, v10
    v_mfma_f32_16x16x32_bf16 v[108:111], a[180:183], v[52:55], v[108:111]
    ds_read_b64_tr_b16 a[148:149], v207 offset:49152
    v_permlane32_swap_b32 v9, v11
    v_mfma_f32_16x16x32_bf16 v[104:107], a[180:183], v[48:51], v[104:107]
    s_waitcnt lgkmcnt(11)
    ds_read_b64_tr_b16 a[150:151], v207 offset:50176
    v_permlane16_swap_b32 v8, v10
    v_mfma_f32_16x16x32_bf16 v[96:99], a[184:187], v[56:59], v[96:99]
    ds_read_b64_tr_b16 a[152:153], v206 offset:57344
    v_permlane16_swap_b32 v9, v11
    v_mfma_f32_16x16x32_bf16 v[100:103], a[184:187], v[60:63], v[100:103]
    ds_read_b64_tr_b16 a[154:155], v206 offset:58368
    buffer_store_dwordx4 v[8:11], v194, s[16:19], s70 offen offset:64 nt
    v_cvt_pk_bf16_f32 v12, v84, v85
    v_cvt_pk_bf16_f32 v13, v86, v87
    v_mfma_f32_16x16x32_bf16 v[108:111], a[188:191], v[60:63], v[108:111]
    ds_read_b64_tr_b16 a[156:157], v207 offset:57344
    v_cvt_pk_bf16_f32 v14, v92, v93
    v_cvt_pk_bf16_f32 v15, v94, v95
    v_mfma_f32_16x16x32_bf16 v[104:107], a[188:191], v[56:59], v[104:107]
    s_waitcnt lgkmcnt(11)
    ds_read_b64_tr_b16 a[158:159], v207 offset:58368
    v_permlane32_swap_b32 v12, v14
    v_mfma_f32_16x16x32_bf16 v[112:115], a[128:131], v[32:35], v[112:115]
    v_permlane32_swap_b32 v13, v15
    v_mfma_f32_16x16x32_bf16 v[116:119], a[128:131], v[36:39], v[116:119]
    v_permlane16_swap_b32 v12, v14
    v_mfma_f32_16x16x32_bf16 v[124:127], a[132:135], v[36:39], v[124:127]
    v_permlane16_swap_b32 v13, v15
    v_mfma_f32_16x16x32_bf16 v[120:123], a[132:135], v[32:35], v[120:123]
    s_waitcnt lgkmcnt(8)
    buffer_store_dwordx4 v[12:15], v194, s[16:19], s71 offen offset:64 nt
    v_cvt_pk_bf16_f32 v0, v96, v97
    v_cvt_pk_bf16_f32 v1, v98, v99
    v_mfma_f32_16x16x32_bf16 v[112:115], a[136:139], v[40:43], v[112:115]
    v_cvt_pk_bf16_f32 v2, v104, v105
    v_cvt_pk_bf16_f32 v3, v106, v107
    v_mfma_f32_16x16x32_bf16 v[116:119], a[136:139], v[44:47], v[116:119]
    v_permlane32_swap_b32 v0, v2
    v_mfma_f32_16x16x32_bf16 v[124:127], a[140:143], v[44:47], v[124:127]
    v_permlane32_swap_b32 v1, v3
    v_mfma_f32_16x16x32_bf16 v[120:123], a[140:143], v[40:43], v[120:123]
    s_waitcnt lgkmcnt(4)
    v_permlane16_swap_b32 v0, v2
    v_mfma_f32_16x16x32_bf16 v[112:115], a[144:147], v[48:51], v[112:115]
    v_permlane16_swap_b32 v1, v3
    v_mfma_f32_16x16x32_bf16 v[116:119], a[144:147], v[52:55], v[116:119]
    buffer_store_dwordx4 v[0:3], v194, s[16:19], s70 offen offset:128 nt
    v_cvt_pk_bf16_f32 v4, v100, v101
    v_cvt_pk_bf16_f32 v5, v102, v103
    v_mfma_f32_16x16x32_bf16 v[124:127], a[148:151], v[52:55], v[124:127]
    v_cvt_pk_bf16_f32 v6, v108, v109
    v_cvt_pk_bf16_f32 v7, v110, v111
    v_mfma_f32_16x16x32_bf16 v[120:123], a[148:151], v[48:51], v[120:123]
    s_waitcnt lgkmcnt(0)
    v_permlane32_swap_b32 v4, v6
    v_mfma_f32_16x16x32_bf16 v[112:115], a[152:155], v[56:59], v[112:115]
    v_permlane32_swap_b32 v5, v7
    v_mfma_f32_16x16x32_bf16 v[116:119], a[152:155], v[60:63], v[116:119]
    v_permlane16_swap_b32 v4, v6
    v_mfma_f32_16x16x32_bf16 v[124:127], a[156:159], v[60:63], v[124:127]
    v_permlane16_swap_b32 v5, v7
    v_mfma_f32_16x16x32_bf16 v[120:123], a[156:159], v[56:59], v[120:123]
    buffer_store_dwordx4 v[4:7], v194, s[16:19], s71 offen offset:128 nt
    s_nop 7
    s_nop 1
    v_cvt_pk_bf16_f32 v8, v112, v113
    v_cvt_pk_bf16_f32 v9, v114, v115
    v_cvt_pk_bf16_f32 v10, v120, v121
    v_cvt_pk_bf16_f32 v11, v122, v123
    v_cvt_pk_bf16_f32 v12, v116, v117
    v_cvt_pk_bf16_f32 v13, v118, v119
    v_cvt_pk_bf16_f32 v14, v124, v125
    v_cvt_pk_bf16_f32 v15, v126, v127
    v_permlane32_swap_b32 v8, v10
    v_permlane32_swap_b32 v9, v11
    v_permlane32_swap_b32 v12, v14
    v_permlane32_swap_b32 v13, v15
    s_nop 0
    v_permlane16_swap_b32 v8, v10
    v_permlane16_swap_b32 v9, v11
    v_permlane16_swap_b32 v12, v14
    v_permlane16_swap_b32 v13, v15
    s_nop 0
    buffer_store_dwordx4 v[8:11], v194, s[16:19], s70 offen offset:192 nt
    buffer_store_dwordx4 v[12:15], v194, s[16:19], s71 offen offset:192 nt
    s_endpgm
L_k2_idle:
    s_waitcnt vmcnt(0)
    s_barrier
    s_cmp_eq_u32 s28, 0
    s_cbranch_scc0 L_sig_idle
    s_and_b32 s70, s2, 1
    s_lshl_b32 s70, s70, 3
    s_add_u32 s70, s70, s31
    s_lshl_b32 s70, s70, 4
    s_add_u32 s70, s70, 4
    v_mov_b32 v245, s70
    v_mov_b32 v246, 1
    s_mov_b64 exec, 1
    global_atomic_add v245, v246, s[62:63] sc1
    s_mov_b64 exec, -1
L_sig_idle:
    s_branch L_k1_end
L_k2_spin0:
    s_mov_b32 s73, 0x40000
L_k2_spin0l:
    global_load_dword v244, v195, s[62:63] sc1
    s_waitcnt vmcnt(0)
    v_readlane_b32 s70, v244, s101
    v_readlane_b32 s71, v244, s59
    s_min_u32 s70, s70, s71
    s_cmp_ge_u32 s70, 16
    s_cbranch_scc1 L_k2_go0
    s_sub_u32 s73, s73, 1
    s_cmp_lg_u32 s73, 0
    s_cbranch_scc1 L_k2_spin0l
    s_branch L_k1_end
L_k2_spin1:
    s_mov_b32 s73, 0x40000
L_k2_spin1l:
    global_load_dword v244, v195, s[62:63] sc1
    s_waitcnt vmcnt(0)
    s_add_u32 s72, s101, 1
    v_readlane_b32 s70, v244, s72
    s_add_u32 s72, s59, 1
    v_readlane_b32 s71, v244, s72
    s_min_u32 s70, s70, s71
    s_cmp_ge_u32 s70, 16
    s_cbranch_scc1 L_k2_go1
    s_sub_u32 s73, s73, 1
    s_cmp_lg_u32 s73, 0
    s_cbranch_scc1 L_k2_spin1l
    s_branch L_k1_end
L_k1_end:
    s_waitcnt vmcnt(0)
    s_endpgm
L_w3_Q:
    v_mfma_f32_16x16x32_bf16 v[0:3], a[160:163], a[192:195], 0
    s_add_u32 m0, s29, 98304
    s_add_u32 s43, s43, 16384
    v_mfma_f32_16x16x32_bf16 v[16:19], a[164:167], a[192:195], 0
    s_and_b32 s43, s43, 0xffff
    v_mfma_f32_16x16x32_bf16 v[4:7], a[160:163], a[196:199], 0
    buffer_load_dwordx4 v212, s[20:23], s35 offen offset:0 lds
    v_mfma_f32_16x16x32_bf16 v[20:23], a[164:167], a[196:199], 0
    ds_read_b128 a[208:211], v223 offset:0
    v_mfma_f32_16x16x32_bf16 v[8:11], a[160:163], a[200:203], 0
    buffer_load_dwordx4 v213, s[20:23], s35 offen offset:1024 lds
    v_mfma_f32_16x16x32_bf16 v[24:27], a[164:167], a[200:203], 0
    ds_read_b128 a[212:215], v223 offset:2048
    s_cmp_gt_u32 s3, 0
    ds_read_b64_tr_b16 a[160:161], v224 offset:8192
    s_cselect_b32 s26, 31457280, 0
    ds_read_b64_tr_b16 a[162:163], v224 offset:9216
    s_mov_b32 s71, 0
    ds_read_b64_tr_b16 a[164:165], v225 offset:8192
    v_add_u32 v222, s41, v220
    ds_read_b64_tr_b16 a[166:167], v225 offset:9216
    v_add_u32 v224, s43, v200
    v_mfma_f32_16x16x32_bf16 v[40:43], a[168:171], a[200:203], 0
    buffer_load_dwordx4 v214, s[20:23], s35 offen offset:2048 lds
    v_mfma_f32_16x16x32_bf16 v[56:59], a[172:175], a[200:203], 0
    ds_read_b128 a[216:219], v223 offset:4096
    v_mfma_f32_16x16x32_bf16 v[36:39], a[168:171], a[196:199], 0
    buffer_load_dwordx4 v215, s[20:23], s35 offen offset:3072 lds
    v_mfma_f32_16x16x32_bf16 v[52:55], a[172:175], a[196:199], 0
    s_add_u32 m0, s30, 32768
    ds_read_b128 a[220:223], v223 offset:6144
    v_mfma_f32_16x16x32_bf16 v[32:35], a[168:171], a[192:195], 0
    ds_read_b64_tr_b16 a[168:169], v226 offset:8192
    v_add_u32 v225, s43, v201
    v_mfma_f32_16x16x32_bf16 v[48:51], a[172:175], a[192:195], 0
    ds_read_b64_tr_b16 a[170:171], v226 offset:9216
    s_waitcnt lgkmcnt(10)
    v_mfma_f32_16x16x32_bf16 v[64:67], a[176:179], a[192:195], 0
    ds_read_b64_tr_b16 a[172:173], v227 offset:8192
    v_add_u32 v226, s43, v202
    v_mfma_f32_16x16x32_bf16 v[80:83], a[180:183], a[192:195], 0
    ds_read_b64_tr_b16 a[174:175], v227 offset:9216
    v_add_u32 v223, s41, v221
    v_mfma_f32_16x16x32_bf16 v[68:71], a[176:179], a[196:199], 0
    buffer_load_dwordx4 v216, s[16:19], s36 offen offset:0 lds
    v_mfma_f32_16x16x32_bf16 v[84:87], a[180:183], a[196:199], 0
    buffer_load_dwordx4 v217, s[16:19], s36 offen offset:1024 lds
    v_mfma_f32_16x16x32_bf16 v[72:75], a[176:179], a[200:203], 0
    buffer_load_dwordx4 v218, s[16:19], s36 offen offset:2048 lds
    v_mfma_f32_16x16x32_bf16 v[88:91], a[180:183], a[200:203], 0
    buffer_load_dwordx4 v219, s[16:19], s36 offen offset:3072 lds
    s_mov_b32 s70, s40
    ds_read_b64_tr_b16 a[176:177], v228 offset:8192
    v_add_u32 v227, s43, v203
    s_add_u32 m0, m0, s67
    s_mov_b32 s40, s41
    ds_read_b64_tr_b16 a[178:179], v228 offset:9216
    s_mov_b32 s41, s42
    ds_read_b64_tr_b16 a[180:181], v229 offset:8192
    v_add_u32 v228, s43, v204
    s_mov_b32 s42, s70
    ds_read_b64_tr_b16 a[182:183], v229 offset:9216
    buffer_store_dwordx4 v[128:131], v236, s[24:27], s71 offen offset:0 sc1
    v_mfma_f32_16x16x32_bf16 v[104:107], a[184:187], a[200:203], 0
    buffer_load_dwordx4 v216, s[16:19], s37 offen offset:0 lds
    v_mfma_f32_16x16x32_bf16 v[120:123], a[188:191], a[200:203], 0
    buffer_load_dwordx4 v217, s[16:19], s37 offen offset:1024 lds
    v_mfma_f32_16x16x32_bf16 v[100:103], a[184:187], a[196:199], 0
    buffer_load_dwordx4 v218, s[16:19], s37 offen offset:2048 lds
    v_mfma_f32_16x16x32_bf16 v[116:119], a[188:191], a[196:199], 0
    buffer_load_dwordx4 v219, s[16:19], s37 offen offset:3072 lds
    v_mfma_f32_16x16x32_bf16 v[96:99], a[184:187], a[192:195], 0
    ds_read_b64_tr_b16 a[184:185], v230 offset:8192
    v_add_u32 v229, s43, v205
    v_mfma_f32_16x16x32_bf16 v[112:115], a[188:191], a[192:195], 0
    ds_read_b64_tr_b16 a[186:187], v230 offset:9216
    s_waitcnt lgkmcnt(6)
    v_mfma_f32_16x16x32_bf16 v[0:3], a[160:163], a[208:211], v[0:3]
    ds_read_b64_tr_b16 a[188:189], v231 offset:8192
    s_add_u32 s36, s36, 128
    s_bitset0_b32 s36, 11
    s_add_u32 s37, s37, 128
    s_bitset0_b32 s37, 11
    s_add_u32 s35, s35, 524288
    s_bitset0_b32 s35, 23
    v_mfma_f32_16x16x32_bf16 v[16:19], a[164:167], a[208:211], v[16:19]
    s_waitcnt vmcnt(13)
    ds_read_b64_tr_b16 a[190:191], v231 offset:9216
    s_mov_b32 m0, s39
    s_barrier
    s_mov_b32 s44, 13
L_k1_qloop_w3:
    v_mfma_f32_16x16x32_bf16 v[4:7], a[160:163], a[212:215], v[4:7]
    buffer_load_dwordx4 v212, s[20:23], s35 offen offset:0 lds
    v_mfma_f32_16x16x32_bf16 v[20:23], a[164:167], a[212:215], v[20:23]
    ds_read_b128 a[192:195], v222 offset:0
    v_mfma_f32_16x16x32_bf16 v[8:11], a[160:163], a[216:219], v[8:11]
    buffer_load_dwordx4 v213, s[20:23], s35 offen offset:1024 lds
    v_mfma_f32_16x16x32_bf16 v[24:27], a[164:167], a[216:219], v[24:27]
    ds_read_b128 a[196:199], v222 offset:2048
    ds_read_b64_tr_b16 a[160:161], v224 offset:0
    v_add_u32 v230, s43, v206
    ds_read_b64_tr_b16 a[162:163], v224 offset:1024
    v_add_u32 v231, s43, v207
    ds_read_b64_tr_b16 a[164:165], v225 offset:0
    ds_read_b64_tr_b16 a[166:167], v225 offset:1024
    v_mfma_f32_16x16x32_bf16 v[40:43], a[168:171], a[216:219], v[40:43]
    buffer_load_dwordx4 v214, s[20:23], s35 offen offset:2048 lds
    v_mfma_f32_16x16x32_bf16 v[56:59], a[172:175], a[216:219], v[56:59]
    ds_read_b128 a[200:203], v222 offset:4096
    v_mfma_f32_16x16x32_bf16 v[36:39], a[168:171], a[212:215], v[36:39]
    buffer_load_dwordx4 v215, s[20:23], s35 offen offset:3072 lds
    v_mfma_f32_16x16x32_bf16 v[52:55], a[172:175], a[212:215], v[52:55]
    s_add_u32 m0, s42, s30
    ds_read_b128 a[204:207], v222 offset:6144
    v_mfma_f32_16x16x32_bf16 v[32:35], a[168:171], a[208:211], v[32:35]
    s_add_u32 s35, s35, 524288
    ds_read_b64_tr_b16 a[168:169], v226 offset:0
    v_add_u32 v222, s41, v220
    v_mfma_f32_16x16x32_bf16 v[48:51], a[172:175], a[208:211], v[48:51]
    s_bitset0_b32 s35, 23
    ds_read_b64_tr_b16 a[170:171], v226 offset:1024
    s_waitcnt lgkmcnt(10)
    v_mfma_f32_16x16x32_bf16 v[64:67], a[176:179], a[208:211], v[64:67]
    s_add_u32 s39, s39, 16384
    ds_read_b64_tr_b16 a[172:173], v227 offset:0
    v_mfma_f32_16x16x32_bf16 v[80:83], a[180:183], a[208:211], v[80:83]
    s_and_b32 s39, s39, 0xffff
    ds_read_b64_tr_b16 a[174:175], v227 offset:1024
    v_mfma_f32_16x16x32_bf16 v[68:71], a[176:179], a[212:215], v[68:71]
    buffer_load_dwordx4 v216, s[16:19], s36 offen offset:0 lds
    v_mfma_f32_16x16x32_bf16 v[84:87], a[180:183], a[212:215], v[84:87]
    s_add_u32 s68, s68, 122880
    s_sub_u32 s71, s68, 491264
    s_cselect_b32 s68, s68, s71
    v_mfma_f32_16x16x32_bf16 v[72:75], a[176:179], a[216:219], v[72:75]
    buffer_load_dwordx4 v217, s[16:19], s36 offen offset:1024 lds
    v_mfma_f32_16x16x32_bf16 v[88:91], a[180:183], a[216:219], v[88:91]
    s_add_u32 s47, s47, 4
    s_cmp_lt_u32 s47, s3
    s_cselect_b32 s26, 31457280, 0
    s_or_b32 s39, s39, 0x10000
    ds_read_b64_tr_b16 a[176:177], v228 offset:0
    ds_read_b64_tr_b16 a[178:179], v228 offset:1024
    ds_read_b64_tr_b16 a[180:181], v229 offset:0
    ds_read_b64_tr_b16 a[182:183], v229 offset:1024
    v_mfma_f32_16x16x32_bf16 v[104:107], a[184:187], a[216:219], v[104:107]
    buffer_load_dwordx4 v218, s[16:19], s36 offen offset:2048 lds
    v_mfma_f32_16x16x32_bf16 v[120:123], a[188:191], a[216:219], v[120:123]
    v_mfma_f32_16x16x32_bf16 v[100:103], a[184:187], a[212:215], v[100:103]
    buffer_load_dwordx4 v219, s[16:19], s36 offen offset:3072 lds
    v_mfma_f32_16x16x32_bf16 v[116:119], a[188:191], a[212:215], v[116:119]
    s_add_u32 m0, m0, s67
    v_mfma_f32_16x16x32_bf16 v[96:99], a[184:187], a[208:211], v[96:99]
    ds_read_b64_tr_b16 a[184:185], v230 offset:0
    v_mfma_f32_16x16x32_bf16 v[112:115], a[188:191], a[208:211], v[112:115]
    ds_read_b64_tr_b16 a[186:187], v230 offset:1024
    s_waitcnt lgkmcnt(6)
    v_mfma_f32_16x16x32_bf16 v[0:3], a[160:163], a[192:195], v[0:3]
    s_add_u32 s43, s43, 16384
    ds_read_b64_tr_b16 a[188:189], v231 offset:0
    v_mfma_f32_16x16x32_bf16 v[16:19], a[164:167], a[192:195], v[16:19]
    s_and_b32 s43, s43, 0xffff
    ds_read_b64_tr_b16 a[190:191], v231 offset:1024
    v_mfma_f32_16x16x32_bf16 v[4:7], a[160:163], a[196:199], v[4:7]
    buffer_load_dwordx4 v216, s[16:19], s37 offen offset:0 lds
    v_mfma_f32_16x16x32_bf16 v[20:23], a[164:167], a[196:199], v[20:23]
    ds_read_b128 a[208:211], v223 offset:0
    v_mfma_f32_16x16x32_bf16 v[8:11], a[160:163], a[200:203], v[8:11]
    buffer_load_dwordx4 v217, s[16:19], s37 offen offset:1024 lds
    v_mfma_f32_16x16x32_bf16 v[24:27], a[164:167], a[200:203], v[24:27]
    ds_read_b128 a[212:215], v223 offset:2048
    s_add_u32 s36, s36, 128
    ds_read_b64_tr_b16 a[160:161], v224 offset:8192
    s_bitset0_b32 s36, 11
    ds_read_b64_tr_b16 a[162:163], v224 offset:9216
    ds_read_b64_tr_b16 a[164:165], v225 offset:8192
    ds_read_b64_tr_b16 a[166:167], v225 offset:9216
    v_add_u32 v224, s43, v200
    v_mfma_f32_16x16x32_bf16 v[40:43], a[168:171], a[200:203], v[40:43]
    buffer_load_dwordx4 v218, s[16:19], s37 offen offset:2048 lds
    v_mfma_f32_16x16x32_bf16 v[56:59], a[172:175], a[200:203], v[56:59]
    ds_read_b128 a[216:219], v223 offset:4096
    v_mfma_f32_16x16x32_bf16 v[36:39], a[168:171], a[196:199], v[36:39]
    buffer_load_dwordx4 v219, s[16:19], s37 offen offset:3072 lds
    v_mfma_f32_16x16x32_bf16 v[52:55], a[172:175], a[196:199], v[52:55]
    ds_read_b128 a[220:223], v223 offset:6144
    v_mfma_f32_16x16x32_bf16 v[32:35], a[168:171], a[192:195], v[32:35]
    ds_read_b64_tr_b16 a[168:169], v226 offset:8192
    v_add_u32 v225, s43, v201
    v_mfma_f32_16x16x32_bf16 v[48:51], a[172:175], a[192:195], v[48:51]
    ds_read_b64_tr_b16 a[170:171], v226 offset:9216
    s_waitcnt lgkmcnt(10)
    v_mfma_f32_16x16x32_bf16 v[64:67], a[176:179], a[192:195], v[64:67]
    s_add_u32 s37, s37, 128
    ds_read_b64_tr_b16 a[172:173], v227 offset:8192
    v_add_u32 v226, s43, v202
    v_mfma_f32_16x16x32_bf16 v[80:83], a[180:183], a[192:195], v[80:83]
    s_bitset0_b32 s37, 11
    ds_read_b64_tr_b16 a[174:175], v227 offset:9216
    v_add_u32 v223, s41, v221
    v_mfma_f32_16x16x32_bf16 v[68:71], a[176:179], a[196:199], v[68:71]
    s_set_gpr_idx_on s47, 1
    v_mov_b32 v240, v128
    s_set_gpr_idx_off
    v_mfma_f32_16x16x32_bf16 v[84:87], a[180:183], a[196:199], v[84:87]
    s_set_gpr_idx_on s47, 1
    v_mov_b32 v241, v129
    s_set_gpr_idx_off
    v_mfma_f32_16x16x32_bf16 v[72:75], a[176:179], a[200:203], v[72:75]
    s_set_gpr_idx_on s47, 1
    v_mov_b32 v242, v130
    s_set_gpr_idx_off
    v_mfma_f32_16x16x32_bf16 v[88:91], a[180:183], a[200:203], v[88:91]
    s_set_gpr_idx_on s47, 1
    v_mov_b32 v243, v131
    s_set_gpr_idx_off
    s_mov_b32 s70, s40
    ds_read_b64_tr_b16 a[176:177], v228 offset:8192
    v_add_u32 v227, s43, v203
    s_mov_b32 s40, s41
    ds_read_b64_tr_b16 a[178:179], v228 offset:9216
    s_mov_b32 s41, s42
    ds_read_b64_tr_b16 a[180:181], v229 offset:8192
    v_add_u32 v228, s43, v204
    s_mov_b32 s42, s70
    ds_read_b64_tr_b16 a[182:183], v229 offset:9216
    v_mfma_f32_16x16x32_bf16 v[104:107], a[184:187], a[200:203], v[104:107]
    s_sub_u32 s44, s44, 1
    v_mfma_f32_16x16x32_bf16 v[120:123], a[188:191], a[200:203], v[120:123]
    buffer_store_dwordx4 v[240:243], v236, s[24:27], s68 offen sc1
    v_mfma_f32_16x16x32_bf16 v[100:103], a[184:187], a[196:199], v[100:103]
    v_mfma_f32_16x16x32_bf16 v[116:119], a[188:191], a[196:199], v[116:119]
    s_cmp_lg_u32 s44, 0
    v_mfma_f32_16x16x32_bf16 v[96:99], a[184:187], a[192:195], v[96:99]
    ds_read_b64_tr_b16 a[184:185], v230 offset:8192
    v_add_u32 v229, s43, v205
    v_mfma_f32_16x16x32_bf16 v[112:115], a[188:191], a[192:195], v[112:115]
    ds_read_b64_tr_b16 a[186:187], v230 offset:9216
    s_waitcnt lgkmcnt(6)
    v_mfma_f32_16x16x32_bf16 v[0:3], a[160:163], a[208:211], v[0:3]
    s_mov_b32 m0, s39
    ds_read_b64_tr_b16 a[188:189], v231 offset:8192
    v_mfma_f32_16x16x32_bf16 v[16:19], a[164:167], a[208:211], v[16:19]
    s_waitcnt vmcnt(14)
    ds_read_b64_tr_b16 a[190:191], v231 offset:9216
    s_barrier
    s_cbranch_scc1 L_k1_qloop_w3
    v_mfma_f32_16x16x32_bf16 v[4:7], a[160:163], a[212:215], v[4:7]
    s_mov_b32 m0, s29
    v_mfma_f32_16x16x32_bf16 v[20:23], a[164:167], a[212:215], v[20:23]
    ds_read_b128 a[192:195], v222 offset:0
    v_mfma_f32_16x16x32_bf16 v[8:11], a[160:163], a[216:219], v[8:11]
    buffer_load_dwordx4 v208, s[8:11], s34 offen offset:0 nt lds
    v_mfma_f32_16x16x32_bf16 v[24:27], a[164:167], a[216:219], v[24:27]
    ds_read_b128 a[196:199], v222 offset:2048
    ds_read_b64_tr_b16 a[160:161], v224 offset:0
    v_add_u32 v230, s43, v206
    ds_read_b64_tr_b16 a[162:163], v224 offset:1024
    v_add_u32 v231, s43, v207
    ds_read_b64_tr_b16 a[164:165], v225 offset:0
    ds_read_b64_tr_b16 a[166:167], v225 offset:1024
    v_mfma_f32_16x16x32_bf16 v[40:43], a[168:171], a[216:219], v[40:43]
    v_mfma_f32_16x16x32_bf16 v[56:59], a[172:175], a[216:219], v[56:59]
    ds_read_b128 a[200:203], v222 offset:4096
    v_mfma_f32_16x16x32_bf16 v[36:39], a[168:171], a[212:215], v[36:39]
    buffer_load_dwordx4 v208, s[8:11], s34 offen offset:1024 nt lds
    v_mfma_f32_16x16x32_bf16 v[52:55], a[172:175], a[212:215], v[52:55]
    ds_read_b128 a[204:207], v222 offset:6144
    v_mfma_f32_16x16x32_bf16 v[32:35], a[168:171], a[208:211], v[32:35]
    ds_read_b64_tr_b16 a[168:169], v226 offset:0
    v_add_u32 v222, s41, v220
    v_mfma_f32_16x16x32_bf16 v[48:51], a[172:175], a[208:211], v[48:51]
    ds_read_b64_tr_b16 a[170:171], v226 offset:1024
    s_waitcnt lgkmcnt(10)
    v_mfma_f32_16x16x32_bf16 v[64:67], a[176:179], a[208:211], v[64:67]
    ds_read_b64_tr_b16 a[172:173], v227 offset:0
    v_mfma_f32_16x16x32_bf16 v[80:83], a[180:183], a[208:211], v[80:83]
    ds_read_b64_tr_b16 a[174:175], v227 offset:1024
    v_mfma_f32_16x16x32_bf16 v[68:71], a[176:179], a[212:215], v[68:71]
    v_mfma_f32_16x16x32_bf16 v[84:87], a[180:183], a[212:215], v[84:87]
    v_mfma_f32_16x16x32_bf16 v[72:75], a[176:179], a[216:219], v[72:75]
    buffer_load_dwordx4 v209, s[8:11], s34 offen offset:2048 nt lds
    v_mfma_f32_16x16x32_bf16 v[88:91], a[180:183], a[216:219], v[88:91]
    ds_read_b64_tr_b16 a[176:177], v228 offset:0
    ds_read_b64_tr_b16 a[178:179], v228 offset:1024
    ds_read_b64_tr_b16 a[180:181], v229 offset:0
    ds_read_b64_tr_b16 a[182:183], v229 offset:1024
    v_mfma_f32_16x16x32_bf16 v[104:107], a[184:187], a[216:219], v[104:107]
    v_mfma_f32_16x16x32_bf16 v[120:123], a[188:191], a[216:219], v[120:123]
    v_mfma_f32_16x16x32_bf16 v[100:103], a[184:187], a[212:215], v[100:103]
    buffer_load_dwordx4 v209, s[8:11], s34 offen offset:3072 nt lds
    v_mfma_f32_16x16x32_bf16 v[116:119], a[188:191], a[212:215], v[116:119]
    v_mfma_f32_16x16x32_bf16 v[96:99], a[184:187], a[208:211], v[96:99]
    ds_read_b64_tr_b16 a[184:185], v230 offset:0
    v_mfma_f32_16x16x32_bf16 v[112:115], a[188:191], a[208:211], v[112:115]
    ds_read_b64_tr_b16 a[186:187], v230 offset:1024
    s_waitcnt lgkmcnt(6)
    v_mfma_f32_16x16x32_bf16 v[0:3], a[160:163], a[192:195], v[0:3]
    s_add_u32 s43, s43, 16384
    ds_read_b64_tr_b16 a[188:189], v231 offset:0
    v_mfma_f32_16x16x32_bf16 v[16:19], a[164:167], a[192:195], v[16:19]
    s_and_b32 s43, s43, 0xffff
    ds_read_b64_tr_b16 a[190:191], v231 offset:1024
    v_mfma_f32_16x16x32_bf16 v[4:7], a[160:163], a[196:199], v[4:7]
    v_mfma_f32_16x16x32_bf16 v[20:23], a[164:167], a[196:199], v[20:23]
    ds_read_b128 a[208:211], v223 offset:0
    v_mfma_f32_16x16x32_bf16 v[8:11], a[160:163], a[200:203], v[8:11]
    v_mfma_f32_16x16x32_bf16 v[24:27], a[164:167], a[200:203], v[24:27]
    ds_read_b128 a[212:215], v223 offset:2048
    s_add_u32 s34, s34, 16384
    ds_read_b64_tr_b16 a[160:161], v224 offset:8192
    ds_read_b64_tr_b16 a[162:163], v224 offset:9216
    ds_read_b64_tr_b16 a[164:165], v225 offset:8192
    ds_read_b64_tr_b16 a[166:167], v225 offset:9216
    v_add_u32 v224, s43, v200
    v_mfma_f32_16x16x32_bf16 v[40:43], a[168:171], a[200:203], v[40:43]
    v_mfma_f32_16x16x32_bf16 v[56:59], a[172:175], a[200:203], v[56:59]
    ds_read_b128 a[216:219], v223 offset:4096
    v_mfma_f32_16x16x32_bf16 v[36:39], a[168:171], a[196:199], v[36:39]
    v_mfma_f32_16x16x32_bf16 v[52:55], a[172:175], a[196:199], v[52:55]
    ds_read_b128 a[220:223], v223 offset:6144
    v_mfma_f32_16x16x32_bf16 v[32:35], a[168:171], a[192:195], v[32:35]
    ds_read_b64_tr_b16 a[168:169], v226 offset:8192
    v_add_u32 v225, s43, v201
    v_mfma_f32_16x16x32_bf16 v[48:51], a[172:175], a[192:195], v[48:51]
    ds_read_b64_tr_b16 a[170:171], v226 offset:9216
    s_waitcnt lgkmcnt(10)
    v_mfma_f32_16x16x32_bf16 v[64:67], a[176:179], a[192:195], v[64:67]
    ds_read_b64_tr_b16 a[172:173], v227 offset:8192
    v_add_u32 v226, s43, v202
    v_mfma_f32_16x16x32_bf16 v[80:83], a[180:183], a[192:195], v[80:83]
    ds_read_b64_tr_b16 a[174:175], v227 offset:9216
    v_add_u32 v223, s41, v221
    v_mfma_f32_16x16x32_bf16 v[68:71], a[176:179], a[196:199], v[68:71]
    s_cmp_gt_u32 s3, 56
    s_cselect_b32 s26, 31457280, 0
    s_mov_b32 s71, 245760
    v_mfma_f32_16x16x32_bf16 v[84:87], a[180:183], a[196:199], v[84:87]
    v_mfma_f32_16x16x32_bf16 v[72:75], a[176:179], a[200:203], v[72:75]
    buffer_store_dwordx4 v[184:187], v236, s[24:27], s71 offen offset:768 sc1
    v_mfma_f32_16x16x32_bf16 v[88:91], a[180:183], a[200:203], v[88:91]
    s_mov_b32 s70, s40
    ds_read_b64_tr_b16 a[176:177], v228 offset:8192
    v_add_u32 v227, s43, v203
    s_mov_b32 s40, s41
    ds_read_b64_tr_b16 a[178:179], v228 offset:9216
    s_mov_b32 s41, s42
    ds_read_b64_tr_b16 a[180:181], v229 offset:8192
    v_add_u32 v228, s43, v204
    s_mov_b32 s42, s70
    ds_read_b64_tr_b16 a[182:183], v229 offset:9216
    v_mfma_f32_16x16x32_bf16 v[104:107], a[184:187], a[200:203], v[104:107]
    v_mfma_f32_16x16x32_bf16 v[120:123], a[188:191], a[200:203], v[120:123]
    v_mfma_f32_16x16x32_bf16 v[100:103], a[184:187], a[196:199], v[100:103]
    v_mfma_f32_16x16x32_bf16 v[116:119], a[188:191], a[196:199], v[116:119]
    v_mfma_f32_16x16x32_bf16 v[96:99], a[184:187], a[192:195], v[96:99]
    ds_read_b64_tr_b16 a[184:185], v230 offset:8192
    v_add_u32 v229, s43, v205
    v_mfma_f32_16x16x32_bf16 v[112:115], a[188:191], a[192:195], v[112:115]
    ds_read_b64_tr_b16 a[186:187], v230 offset:9216
    s_waitcnt lgkmcnt(6)
    v_mfma_f32_16x16x32_bf16 v[0:3], a[160:163], a[208:211], v[0:3]
    ds_read_b64_tr_b16 a[188:189], v231 offset:8192
    v_mfma_f32_16x16x32_bf16 v[16:19], a[164:167], a[208:211], v[16:19]
    s_waitcnt vmcnt(6)
    ds_read_b64_tr_b16 a[190:191], v231 offset:9216
    s_barrier
    v_mfma_f32_16x16x32_bf16 v[4:7], a[160:163], a[212:215], v[4:7]
    s_add_u32 m0, s29, 16384
    v_mfma_f32_16x16x32_bf16 v[20:23], a[164:167], a[212:215], v[20:23]
    ds_read_b128 a[192:195], v222 offset:0
    v_mfma_f32_16x16x32_bf16 v[8:11], a[160:163], a[216:219], v[8:11]
    buffer_load_dwordx4 v208, s[8:11], s34 offen offset:0 nt lds
    v_mfma_f32_16x16x32_bf16 v[24:27], a[164:167], a[216:219], v[24:27]
    ds_read_b128 a[196:199], v222 offset:2048
    ds_read_b64_tr_b16 a[160:161], v224 offset:0
    v_add_u32 v230, s43, v206
    ds_read_b64_tr_b16 a[162:163], v224 offset:1024
    v_add_u32 v231, s43, v207
    ds_read_b64_tr_b16 a[164:165], v225 offset:0
    ds_read_b64_tr_b16 a[166:167], v225 offset:1024
    v_mfma_f32_16x16x32_bf16 v[40:43], a[168:171], a[216:219], v[40:43]
    v_mfma_f32_16x16x32_bf16 v[56:59], a[172:175], a[216:219], v[56:59]
    ds_read_b128 a[200:203], v222 offset:4096
    v_mfma_f32_16x16x32_bf16 v[36:39], a[168:171], a[212:215], v[36:39]
    buffer_load_dwordx4 v208, s[8:11], s34 offen offset:1024 nt lds
    v_mfma_f32_16x16x32_bf16 v[52:55], a[172:175], a[212:215], v[52:55]
    ds_read_b128 a[204:207], v222 offset:6144
    v_mfma_f32_16x16x32_bf16 v[32:35], a[168:171], a[208:211], v[32:35]
    ds_read_b64_tr_b16 a[168:169], v226 offset:0
    v_add_u32 v222, s41, v220
    v_mfma_f32_16x16x32_bf16 v[48:51], a[172:175], a[208:211], v[48:51]
    ds_read_b64_tr_b16 a[170:171], v226 offset:1024
    s_waitcnt lgkmcnt(10)
    v_mfma_f32_16x16x32_bf16 v[64:67], a[176:179], a[208:211], v[64:67]
    ds_read_b64_tr_b16 a[172:173], v227 offset:0
    v_mfma_f32_16x16x32_bf16 v[80:83], a[180:183], a[208:211], v[80:83]
    ds_read_b64_tr_b16 a[174:175], v227 offset:1024
    v_mfma_f32_16x16x32_bf16 v[68:71], a[176:179], a[212:215], v[68:71]
    v_mfma_f32_16x16x32_bf16 v[84:87], a[180:183], a[212:215], v[84:87]
    v_mfma_f32_16x16x32_bf16 v[72:75], a[176:179], a[216:219], v[72:75]
    buffer_load_dwordx4 v209, s[8:11], s34 offen offset:2048 nt lds
    v_mfma_f32_16x16x32_bf16 v[88:91], a[180:183], a[216:219], v[88:91]
    ds_read_b64_tr_b16 a[176:177], v228 offset:0
    ds_read_b64_tr_b16 a[178:179], v228 offset:1024
    ds_read_b64_tr_b16 a[180:181], v229 offset:0
    ds_read_b64_tr_b16 a[182:183], v229 offset:1024
    v_mfma_f32_16x16x32_bf16 v[104:107], a[184:187], a[216:219], v[104:107]
    v_mfma_f32_16x16x32_bf16 v[120:123], a[188:191], a[216:219], v[120:123]
    v_mfma_f32_16x16x32_bf16 v[100:103], a[184:187], a[212:215], v[100:103]
    buffer_load_dwordx4 v209, s[8:11], s34 offen offset:3072 nt lds
    v_mfma_f32_16x16x32_bf16 v[116:119], a[188:191], a[212:215], v[116:119]
    v_mfma_f32_16x16x32_bf16 v[96:99], a[184:187], a[208:211], v[96:99]
    ds_read_b64_tr_b16 a[184:185], v230 offset:0
    v_mfma_f32_16x16x32_bf16 v[112:115], a[188:191], a[208:211], v[112:115]
    ds_read_b64_tr_b16 a[186:187], v230 offset:1024
    s_waitcnt lgkmcnt(6)
    v_mfma_f32_16x16x32_bf16 v[0:3], a[160:163], a[192:195], v[0:3]
    s_add_u32 s43, s43, 16384
    ds_read_b64_tr_b16 a[188:189], v231 offset:0
    v_mfma_f32_16x16x32_bf16 v[16:19], a[164:167], a[192:195], v[16:19]
    s_and_b32 s43, s43, 0xffff
    ds_read_b64_tr_b16 a[190:191], v231 offset:1024
    v_mfma_f32_16x16x32_bf16 v[4:7], a[160:163], a[196:199], v[4:7]
    v_mfma_f32_16x16x32_bf16 v[20:23], a[164:167], a[196:199], v[20:23]
    ds_read_b128 a[208:211], v223 offset:0
    v_mfma_f32_16x16x32_bf16 v[8:11], a[160:163], a[200:203], v[8:11]
    v_mfma_f32_16x16x32_bf16 v[24:27], a[164:167], a[200:203], v[24:27]
    ds_read_b128 a[212:215], v223 offset:2048
    s_add_u32 s34, s34, 16384
    ds_read_b64_tr_b16 a[160:161], v224 offset:8192
    ds_read_b64_tr_b16 a[162:163], v224 offset:9216
    ds_read_b64_tr_b16 a[164:165], v225 offset:8192
    ds_read_b64_tr_b16 a[166:167], v225 offset:9216
    v_add_u32 v224, s43, v200
    v_mfma_f32_16x16x32_bf16 v[40:43], a[168:171], a[200:203], v[40:43]
    v_mfma_f32_16x16x32_bf16 v[56:59], a[172:175], a[200:203], v[56:59]
    ds_read_b128 a[216:219], v223 offset:4096
    v_mfma_f32_16x16x32_bf16 v[36:39], a[168:171], a[196:199], v[36:39]
    v_mfma_f32_16x16x32_bf16 v[52:55], a[172:175], a[196:199], v[52:55]
    ds_read_b128 a[220:223], v223 offset:6144
    v_mfma_f32_16x16x32_bf16 v[32:35], a[168:171], a[192:195], v[32:35]
    ds_read_b64_tr_b16 a[168:169], v226 offset:8192
    v_add_u32 v225, s43, v201
    v_mfma_f32_16x16x32_bf16 v[48:51], a[172:175], a[192:195], v[48:51]
    ds_read_b64_tr_b16 a[170:171], v226 offset:9216
    s_waitcnt lgkmcnt(10)
    v_mfma_f32_16x16x32_bf16 v[64:67], a[176:179], a[192:195], v[64:67]
    ds_read_b64_tr_b16 a[172:173], v227 offset:8192
    v_add_u32 v226, s43, v202
    v_mfma_f32_16x16x32_bf16 v[80:83], a[180:183], a[192:195], v[80:83]
    ds_read_b64_tr_b16 a[174:175], v227 offset:9216
    v_add_u32 v223, s41, v221
    v_mfma_f32_16x16x32_bf16 v[68:71], a[176:179], a[196:199], v[68:71]
    s_cmp_gt_u32 s3, 60
    s_cselect_b32 s26, 31457280, 0
    s_mov_b32 s71, 368640
    v_mfma_f32_16x16x32_bf16 v[84:87], a[180:183], a[196:199], v[84:87]
    v_mfma_f32_16x16x32_bf16 v[72:75], a[176:179], a[200:203], v[72:75]
    buffer_store_dwordx4 v[188:191], v236, s[24:27], s71 offen offset:768 sc1
    v_mfma_f32_16x16x32_bf16 v[88:91], a[180:183], a[200:203], v[88:91]
    s_mov_b32 s70, s40
    ds_read_b64_tr_b16 a[176:177], v228 offset:8192
    v_add_u32 v227, s43, v203
    s_mov_b32 s40, s41
    ds_read_b64_tr_b16 a[178:179], v228 offset:9216
    s_mov_b32 s41, s42
    ds_read_b64_tr_b16 a[180:181], v229 offset:8192
    v_add_u32 v228, s43, v204
    s_mov_b32 s42, s70
    ds_read_b64_tr_b16 a[182:183], v229 offset:9216
    v_mfma_f32_16x16x32_bf16 v[104:107], a[184:187], a[200:203], v[104:107]
    v_mfma_f32_16x16x32_bf16 v[120:123], a[188:191], a[200:203], v[120:123]
    v_mfma_f32_16x16x32_bf16 v[100:103], a[184:187], a[196:199], v[100:103]
    v_mfma_f32_16x16x32_bf16 v[116:119], a[188:191], a[196:199], v[116:119]
    v_mfma_f32_16x16x32_bf16 v[96:99], a[184:187], a[192:195], v[96:99]
    ds_read_b64_tr_b16 a[184:185], v230 offset:8192
    v_add_u32 v229, s43, v205
    v_mfma_f32_16x16x32_bf16 v[112:115], a[188:191], a[192:195], v[112:115]
    ds_read_b64_tr_b16 a[186:187], v230 offset:9216
    s_waitcnt lgkmcnt(6)
    v_mfma_f32_16x16x32_bf16 v[0:3], a[160:163], a[208:211], v[0:3]
    ds_read_b64_tr_b16 a[188:189], v231 offset:8192
    v_mfma_f32_16x16x32_bf16 v[16:19], a[164:167], a[208:211], v[16:19]
    ds_read_b64_tr_b16 a[190:191], v231 offset:9216
    v_mfma_f32_16x16x32_bf16 v[4:7], a[160:163], a[212:215], v[4:7]
    s_add_u32 m0, s29, 65536
    v_mfma_f32_16x16x32_bf16 v[20:23], a[164:167], a[212:215], v[20:23]
    v_mfma_f32_16x16x32_bf16 v[8:11], a[160:163], a[216:219], v[8:11]
    buffer_load_dwordx4 v210, s[12:15], s75 offen offset:0 nt lds
    v_mfma_f32_16x16x32_bf16 v[24:27], a[164:167], a[216:219], v[24:27]
    v_mfma_f32_16x16x32_bf16 v[40:43], a[168:171], a[216:219], v[40:43]
    buffer_load_dwordx4 v210, s[12:15], s75 offen offset:1024 nt lds
    v_mfma_f32_16x16x32_bf16 v[56:59], a[172:175], a[216:219], v[56:59]
    v_mfma_f32_16x16x32_bf16 v[36:39], a[168:171], a[212:215], v[36:39]
    v_mfma_f32_16x16x32_bf16 v[52:55], a[172:175], a[212:215], v[52:55]
    v_mfma_f32_16x16x32_bf16 v[32:35], a[168:171], a[208:211], v[32:35]
    v_mfma_f32_16x16x32_bf16 v[48:51], a[172:175], a[208:211], v[48:51]
    s_waitcnt lgkmcnt(0)
    v_mfma_f32_16x16x32_bf16 v[64:67], a[176:179], a[208:211], v[64:67]
    v_mfma_f32_16x16x32_bf16 v[80:83], a[180:183], a[208:211], v[80:83]
    v_mfma_f32_16x16x32_bf16 v[68:71], a[176:179], a[212:215], v[68:71]
    buffer_load_dwordx4 v211, s[12:15], s75 offen offset:2048 nt lds
    v_mfma_f32_16x16x32_bf16 v[84:87], a[180:183], a[212:215], v[84:87]
    v_mfma_f32_16x16x32_bf16 v[72:75], a[176:179], a[216:219], v[72:75]
    v_mfma_f32_16x16x32_bf16 v[88:91], a[180:183], a[216:219], v[88:91]
    buffer_load_dwordx4 v211, s[12:15], s75 offen offset:3072 nt lds
    v_mfma_f32_16x16x32_bf16 v[104:107], a[184:187], a[216:219], v[104:107]
    s_add_u32 s75, s75, 16384
    v_mfma_f32_16x16x32_bf16 v[120:123], a[188:191], a[216:219], v[120:123]
    v_mfma_f32_16x16x32_bf16 v[100:103], a[184:187], a[212:215], v[100:103]
    v_mfma_f32_16x16x32_bf16 v[116:119], a[188:191], a[212:215], v[116:119]
    v_mfma_f32_16x16x32_bf16 v[96:99], a[184:187], a[208:211], v[96:99]
    v_mfma_f32_16x16x32_bf16 v[112:115], a[188:191], a[208:211], v[112:115]
    s_branch L_w3e_Q
L_w3_A:
    ds_read_b128 a[128:131], v196 offset:0
    ds_read_b128 a[132:135], v197 offset:0
    ds_read_b128 a[136:139], v198 offset:0
    ds_read_b128 a[140:143], v199 offset:0
    ds_read_b128 a[144:147], v196 offset:1024
    ds_read_b128 a[148:151], v197 offset:1024
    ds_read_b128 a[152:155], v198 offset:1024
    ds_read_b128 a[156:159], v199 offset:1024
    s_waitcnt lgkmcnt(0)
    v_mfma_f32_16x16x32_bf16 v[0:3], a[128:131], v[128:131], v[96:99]
    v_mfma_f32_16x16x32_bf16 v[4:7], a[128:131], v[144:147], v[100:103]
    v_mfma_f32_16x16x32_bf16 v[8:11], a[128:131], v[160:163], v[104:107]
    ds_read_b128 a[128:131], v196 offset:8192
    v_mfma_f32_16x16x32_bf16 v[0:3], a[132:135], v[132:135], v[0:3]
    v_mfma_f32_16x16x32_bf16 v[4:7], a[132:135], v[148:151], v[4:7]
    v_mfma_f32_16x16x32_bf16 v[8:11], a[132:135], v[164:167], v[8:11]
    ds_read_b128 a[132:135], v197 offset:8192
    v_mfma_f32_16x16x32_bf16 v[0:3], a[136:139], v[136:139], v[0:3]
    v_mfma_f32_16x16x32_bf16 v[4:7], a[136:139], v[152:155], v[4:7]
    v_mfma_f32_16x16x32_bf16 v[8:11], a[136:139], v[168:171], v[8:11]
    ds_read_b128 a[136:139], v198 offset:8192
    v_mfma_f32_16x16x32_bf16 v[0:3], a[140:143], v[140:143], v[0:3]
    v_mfma_f32_16x16x32_bf16 v[4:7], a[140:143], v[156:159], v[4:7]
    v_mfma_f32_16x16x32_bf16 v[8:11], a[140:143], v[172:175], v[8:11]
    ds_read_b128 a[140:143], v199 offset:8192
    v_mfma_f32_16x16x32_bf16 v[16:19], a[144:147], v[128:131], v[96:99]
    v_mfma_f32_16x16x32_bf16 v[20:23], a[144:147], v[144:147], v[100:103]
    v_mfma_f32_16x16x32_bf16 v[24:27], a[144:147], v[160:163], v[104:107]
    ds_read_b128 a[144:147], v196 offset:9216
    v_mfma_f32_16x16x32_bf16 v[16:19], a[148:151], v[132:135], v[16:19]
    v_mfma_f32_16x16x32_bf16 v[20:23], a[148:151], v[148:151], v[20:23]
    v_mfma_f32_16x16x32_bf16 v[24:27], a[148:151], v[164:167], v[24:27]
    ds_read_b128 a[148:151], v197 offset:9216
    v_mfma_f32_16x16x32_bf16 v[16:19], a[152:155], v[136:139], v[16:19]
    v_mfma_f32_16x16x32_bf16 v[20:23], a[152:155], v[152:155], v[20:23]
    v_mfma_f32_16x16x32_bf16 v[24:27], a[152:155], v[168:171], v[24:27]
    ds_read_b128 a[152:155], v198 offset:9216
    v_mfma_f32_16x16x32_bf16 v[16:19], a[156:159], v[140:143], v[16:19]
    v_mfma_f32_16x16x32_bf16 v[20:23], a[156:159], v[156:159], v[20:23]
    v_mfma_f32_16x16x32_bf16 v[24:27], a[156:159], v[172:175], v[24:27]
    ds_read_b128 a[156:159], v199 offset:9216
    s_waitcnt lgkmcnt(0)
    s_nop 4
    v_mfma_f32_16x16x32_bf16 v[32:35], a[128:131], v[128:131], v[96:99]
    v_exp_f32 v0, v0
    v_mfma_f32_16x16x32_bf16 v[48:51], a[144:147], v[128:131], v[96:99]
    v_exp_f32 v1, v1
    v_mfma_f32_16x16x32_bf16 v[36:39], a[128:131], v[144:147], v[100:103]
    s_add_u32 m0, s29, 49152
    v_mfma_f32_16x16x32_bf16 v[52:55], a[144:147], v[144:147], v[100:103]
    v_cvt_pk_bf16_f32 v64, v0, v1
    v_mfma_f32_16x16x32_bf16 v[40:43], a[128:131], v[160:163], v[104:107]
    v_exp_f32 v2, v2
    v_mfma_f32_16x16x32_bf16 v[56:59], a[144:147], v[160:163], v[104:107]
    v_exp_f32 v3, v3
    buffer_load_dwordx4 v208, s[8:11], s34 offen offset:0 nt lds
    v_cvt_pk_bf16_f32 v65, v2, v3
    ds_read_b128 a[128:131], v196 offset:16384
    v_exp_f32 v4, v4
    v_exp_f32 v5, v5
    s_nop 0
    v_cvt_pk_bf16_f32 v68, v4, v5
    ds_read_b128 a[144:147], v196 offset:17408
    v_exp_f32 v6, v6
    v_exp_f32 v7, v7
    buffer_load_dwordx4 v208, s[8:11], s34 offen offset:1024 nt lds
    v_cvt_pk_bf16_f32 v69, v6, v7
    ds_read_b64_tr_b16 a[160:161], v200 offset:0
    v_mfma_f32_16x16x32_bf16 v[32:35], a[132:135], v[132:135], v[32:35]
    v_exp_f32 v8, v8
    v_mfma_f32_16x16x32_bf16 v[48:51], a[148:151], v[132:135], v[48:51]
    v_exp_f32 v9, v9
    v_mfma_f32_16x16x32_bf16 v[36:39], a[132:135], v[148:151], v[36:39]
    ds_read_b64_tr_b16 a[162:163], v200 offset:1024
    v_mfma_f32_16x16x32_bf16 v[52:55], a[148:151], v[148:151], v[52:55]
    v_cvt_pk_bf16_f32 v72, v8, v9
    ds_read_b64_tr_b16 a[164:165], v201 offset:0
    v_mfma_f32_16x16x32_bf16 v[40:43], a[132:135], v[164:167], v[40:43]
    v_exp_f32 v10, v10
    v_mfma_f32_16x16x32_bf16 v[56:59], a[148:151], v[164:167], v[56:59]
    v_exp_f32 v11, v11
    buffer_load_dwordx4 v209, s[8:11], s34 offen offset:2048 nt lds
    v_cvt_pk_bf16_f32 v73, v10, v11
    ds_read_b128 a[132:135], v197 offset:16384
    ds_read_b64_tr_b16 a[166:167], v201 offset:1024
    ds_read_b128 a[148:151], v197 offset:17408
    s_waitcnt lgkmcnt(8)
    buffer_load_dwordx4 v209, s[8:11], s34 offen offset:3072 nt lds
    ds_read_b64_tr_b16 a[168:169], v202 offset:0
    v_mfma_f32_16x16x32_bf16 v[32:35], a[136:139], v[136:139], v[32:35]
    v_exp_f32 v16, v16
    v_mfma_f32_16x16x32_bf16 v[48:51], a[152:155], v[136:139], v[48:51]
    v_exp_f32 v17, v17
    v_mfma_f32_16x16x32_bf16 v[36:39], a[136:139], v[152:155], v[36:39]
    ds_read_b64_tr_b16 a[170:171], v202 offset:1024
    s_add_u32 m0, s29, 98304
    v_mfma_f32_16x16x32_bf16 v[52:55], a[152:155], v[152:155], v[52:55]
    v_cvt_pk_bf16_f32 v66, v16, v17
    ds_read_b64_tr_b16 a[172:173], v203 offset:0
    v_mfma_f32_16x16x32_bf16 v[40:43], a[136:139], v[168:171], v[40:43]
    v_exp_f32 v18, v18
    v_mfma_f32_16x16x32_bf16 v[56:59], a[152:155], v[168:171], v[56:59]
    v_exp_f32 v19, v19
    buffer_load_dwordx4 v210, s[12:15], s75 offen offset:0 nt lds
    v_cvt_pk_bf16_f32 v67, v18, v19
    ds_read_b128 a[136:139], v198 offset:16384
    v_exp_f32 v20, v20
    v_exp_f32 v21, v21
    ds_read_b64_tr_b16 a[174:175], v203 offset:1024
    v_cvt_pk_bf16_f32 v70, v20, v21
    ds_read_b128 a[152:155], v198 offset:17408
    v_exp_f32 v22, v22
    v_exp_f32 v23, v23
    buffer_load_dwordx4 v210, s[12:15], s75 offen offset:1024 nt lds
    v_cvt_pk_bf16_f32 v71, v22, v23
    ds_read_b64_tr_b16 a[176:177], v204 offset:0
    v_mfma_f32_16x16x32_bf16 v[32:35], a[140:143], v[140:143], v[32:35]
    v_exp_f32 v24, v24
    v_mfma_f32_16x16x32_bf16 v[48:51], a[156:159], v[140:143], v[48:51]
    v_exp_f32 v25, v25
    v_mfma_f32_16x16x32_bf16 v[36:39], a[140:143], v[156:159], v[36:39]
    ds_read_b64_tr_b16 a[178:179], v204 offset:1024
    v_mfma_f32_16x16x32_bf16 v[52:55], a[156:159], v[156:159], v[52:55]
    v_cvt_pk_bf16_f32 v74, v24, v25
    ds_read_b64_tr_b16 a[180:181], v205 offset:0
    v_mfma_f32_16x16x32_bf16 v[40:43], a[140:143], v[172:175], v[40:43]
    v_exp_f32 v26, v26
    v_mfma_f32_16x16x32_bf16 v[56:59], a[156:159], v[172:175], v[56:59]
    v_exp_f32 v27, v27
    buffer_load_dwordx4 v211, s[12:15], s75 offen offset:2048 nt lds
    v_cvt_pk_bf16_f32 v75, v26, v27
    ds_read_b128 a[140:143], v199 offset:16384
    ds_read_b64_tr_b16 a[182:183], v205 offset:1024
    ds_read_b128 a[156:159], v199 offset:17408
    s_waitcnt lgkmcnt(7)
    buffer_load_dwordx4 v211, s[12:15], s75 offen offset:3072 nt lds
    ds_read_b64_tr_b16 a[184:185], v206 offset:0
    v_mfma_f32_16x16x32_bf16 v[0:3], a[128:131], v[128:131], v[96:99]
    v_exp_f32 v32, v32
    v_mfma_f32_16x16x32_bf16 v[16:19], a[144:147], v[128:131], v[96:99]
    v_exp_f32 v33, v33
    v_mfma_f32_16x16x32_bf16 v[4:7], a[128:131], v[144:147], v[100:103]
    ds_read_b64_tr_b16 a[186:187], v206 offset:1024
    v_mfma_f32_16x16x32_bf16 v[20:23], a[144:147], v[144:147], v[100:103]
    v_cvt_pk_bf16_f32 v80, v32, v33
    ds_read_b64_tr_b16 a[188:189], v207 offset:0
    v_mfma_f32_16x16x32_bf16 v[8:11], a[128:131], v[160:163], v[104:107]
    v_exp_f32 v34, v34
    v_mfma_f32_16x16x32_bf16 v[24:27], a[144:147], v[160:163], v[104:107]
    v_exp_f32 v35, v35
    s_add_u32 s34, s34, 16384
    v_cvt_pk_bf16_f32 v81, v34, v35
    ds_read_b128 a[128:131], v196 offset:24576
    v_mfma_f32_16x16x32_bf16 a[4:7], a[160:163], v[68:71], 0
    v_exp_f32 v36, v36
    v_mfma_f32_16x16x32_bf16 a[20:23], a[164:167], v[68:71], 0
    v_exp_f32 v37, v37
    v_mfma_f32_16x16x32_bf16 a[8:11], a[160:163], v[72:75], 0
    ds_read_b64_tr_b16 a[190:191], v207 offset:1024
    v_mfma_f32_16x16x32_bf16 a[24:27], a[164:167], v[72:75], 0
    v_cvt_pk_bf16_f32 v84, v36, v37
    ds_read_b128 a[144:147], v196 offset:25600
    v_exp_f32 v38, v38
    v_exp_f32 v39, v39
    v_mfma_f32_16x16x32_bf16 a[0:3], a[160:163], v[64:67], 0
    s_add_u32 s75, s75, 16384
    v_mfma_f32_16x16x32_bf16 a[16:19], a[164:167], v[64:67], 0
    v_cvt_pk_bf16_f32 v85, v38, v39
    v_mfma_f32_16x16x32_bf16 v[112:115], v[252:255], v[64:67], 0
    ds_read_b64_tr_b16 a[160:161], v200 offset:8192
    v_mfma_f32_16x16x32_bf16 v[0:3], a[132:135], v[132:135], v[0:3]
    v_exp_f32 v40, v40
    v_mfma_f32_16x16x32_bf16 v[16:19], a[148:151], v[132:135], v[16:19]
    v_exp_f32 v41, v41
    v_mfma_f32_16x16x32_bf16 v[4:7], a[132:135], v[148:151], v[4:7]
    ds_read_b64_tr_b16 a[162:163], v200 offset:9216
    v_mfma_f32_16x16x32_bf16 v[20:23], a[148:151], v[148:151], v[20:23]
    v_cvt_pk_bf16_f32 v88, v40, v41
    ds_read_b64_tr_b16 a[164:165], v201 offset:8192
    v_mfma_f32_16x16x32_bf16 v[8:11], a[132:135], v[164:167], v[8:11]
    v_exp_f32 v42, v42
    v_mfma_f32_16x16x32_bf16 v[24:27], a[148:151], v[164:167], v[24:27]
    v_exp_f32 v43, v43
    s_nop 0
    v_cvt_pk_bf16_f32 v89, v42, v43
    ds_read_b128 a[132:135], v197 offset:24576
    v_mfma_f32_16x16x32_bf16 a[40:43], a[168:171], v[72:75], 0
    v_mfma_f32_16x16x32_bf16 a[56:59], a[172:175], v[72:75], 0
    ds_read_b64_tr_b16 a[166:167], v201 offset:9216
    ds_read_b128 a[148:151], v197 offset:25600
    v_mfma_f32_16x16x32_bf16 a[32:35], a[168:171], v[64:67], 0
    v_mfma_f32_16x16x32_bf16 a[48:51], a[172:175], v[64:67], 0
    v_mfma_f32_16x16x32_bf16 a[36:39], a[168:171], v[68:71], 0
    s_waitcnt lgkmcnt(7)
    v_mfma_f32_16x16x32_bf16 a[52:55], a[172:175], v[68:71], 0
    v_mfma_f32_16x16x32_bf16 v[116:119], v[252:255], v[68:71], 0
    ds_read_b64_tr_b16 a[168:169], v202 offset:8192
    v_mfma_f32_16x16x32_bf16 v[0:3], a[136:139], v[136:139], v[0:3]
    v_exp_f32 v48, v48
    v_mfma_f32_16x16x32_bf16 v[16:19], a[152:155], v[136:139], v[16:19]
    v_exp_f32 v49, v49
    v_mfma_f32_16x16x32_bf16 v[4:7], a[136:139], v[152:155], v[4:7]
    ds_read_b64_tr_b16 a[170:171], v202 offset:9216
    v_mfma_f32_16x16x32_bf16 v[20:23], a[152:155], v[152:155], v[20:23]
    v_cvt_pk_bf16_f32 v82, v48, v49
    ds_read_b64_tr_b16 a[172:173], v203 offset:8192
    v_mfma_f32_16x16x32_bf16 v[8:11], a[136:139], v[168:171], v[8:11]
    v_exp_f32 v50, v50
    v_mfma_f32_16x16x32_bf16 v[24:27], a[152:155], v[168:171], v[24:27]
    v_exp_f32 v51, v51
    s_nop 0
    v_cvt_pk_bf16_f32 v83, v50, v51
    ds_read_b128 a[136:139], v198 offset:24576
    v_exp_f32 v52, v52
    v_exp_f32 v53, v53
    v_mfma_f32_16x16x32_bf16 a[64:67], a[176:179], v[64:67], 0
    ds_read_b64_tr_b16 a[174:175], v203 offset:9216
    v_mfma_f32_16x16x32_bf16 a[80:83], a[180:183], v[64:67], 0
    v_cvt_pk_bf16_f32 v86, v52, v53
    ds_read_b128 a[152:155], v198 offset:25600
    v_mfma_f32_16x16x32_bf16 a[68:71], a[176:179], v[68:71], 0
    v_exp_f32 v54, v54
    v_mfma_f32_16x16x32_bf16 a[84:87], a[180:183], v[68:71], 0
    v_exp_f32 v55, v55
    v_mfma_f32_16x16x32_bf16 a[72:75], a[176:179], v[72:75], 0
    v_mfma_f32_16x16x32_bf16 a[88:91], a[180:183], v[72:75], 0
    v_cvt_pk_bf16_f32 v87, v54, v55
    v_mfma_f32_16x16x32_bf16 v[120:123], v[252:255], v[72:75], 0
    ds_read_b64_tr_b16 a[176:177], v204 offset:8192
    v_mfma_f32_16x16x32_bf16 v[0:3], a[140:143], v[140:143], v[0:3]
    v_exp_f32 v56, v56
    v_mfma_f32_16x16x32_bf16 v[16:19], a[156:159], v[140:143], v[16:19]
    v_exp_f32 v57, v57
    v_mfma_f32_16x16x32_bf16 v[4:7], a[140:143], v[156:159], v[4:7]
    ds_read_b64_tr_b16 a[178:179], v204 offset:9216
    v_mfma_f32_16x16x32_bf16 v[20:23], a[156:159], v[156:159], v[20:23]
    v_cvt_pk_bf16_f32 v90, v56, v57
    ds_read_b64_tr_b16 a[180:181], v205 offset:8192
    v_mfma_f32_16x16x32_bf16 v[8:11], a[140:143], v[172:175], v[8:11]
    v_exp_f32 v58, v58
    v_mfma_f32_16x16x32_bf16 v[24:27], a[156:159], v[172:175], v[24:27]
    v_exp_f32 v59, v59
    s_nop 0
    v_cvt_pk_bf16_f32 v91, v58, v59
    ds_read_b128 a[140:143], v199 offset:24576
    v_mfma_f32_16x16x32_bf16 a[96:99], a[184:187], v[64:67], 0
    v_mfma_f32_16x16x32_bf16 a[112:115], a[188:191], v[64:67], 0
    v_mfma_f32_16x16x32_bf16 a[100:103], a[184:187], v[68:71], 0
    ds_read_b64_tr_b16 a[182:183], v205 offset:9216
    v_mfma_f32_16x16x32_bf16 a[116:119], a[188:191], v[68:71], 0
    ds_read_b128 a[156:159], v199 offset:25600
    v_mfma_f32_16x16x32_bf16 a[104:107], a[184:187], v[72:75], 0
    v_mfma_f32_16x16x32_bf16 a[120:123], a[188:191], v[72:75], 0
    s_waitcnt lgkmcnt(7)
    ds_read_b64_tr_b16 a[184:185], v206 offset:8192
    s_waitcnt vmcnt(8)
    s_barrier
    s_mov_b32 s44, 3
L_k1_aloop_w3:
    v_mfma_f32_16x16x32_bf16 v[32:35], a[128:131], v[128:131], v[96:99]
    v_exp_f32 v0, v0
    v_mfma_f32_16x16x32_bf16 v[48:51], a[144:147], v[128:131], v[96:99]
    v_exp_f32 v1, v1
    v_mfma_f32_16x16x32_bf16 v[36:39], a[128:131], v[144:147], v[100:103]
    ds_read_b64_tr_b16 a[186:187], v206 offset:9216
    s_mov_b32 m0, s29
    v_mfma_f32_16x16x32_bf16 v[52:55], a[144:147], v[144:147], v[100:103]
    v_cvt_pk_bf16_f32 v64, v0, v1
    ds_read_b64_tr_b16 a[188:189], v207 offset:8192
    v_mfma_f32_16x16x32_bf16 v[40:43], a[128:131], v[160:163], v[104:107]
    v_exp_f32 v2, v2
    v_mfma_f32_16x16x32_bf16 v[56:59], a[144:147], v[160:163], v[104:107]
    v_exp_f32 v3, v3
    buffer_load_dwordx4 v208, s[8:11], s34 offen offset:0 nt lds
    v_cvt_pk_bf16_f32 v65, v2, v3
    ds_read_b128 a[128:131], v196 offset:32768
    v_mfma_f32_16x16x32_bf16 a[4:7], a[160:163], v[84:87], a[4:7]
    v_exp_f32 v4, v4
    v_mfma_f32_16x16x32_bf16 a[20:23], a[164:167], v[84:87], a[20:23]
    v_exp_f32 v5, v5
    v_mfma_f32_16x16x32_bf16 a[8:11], a[160:163], v[88:91], a[8:11]
    ds_read_b64_tr_b16 a[190:191], v207 offset:9216
    v_mfma_f32_16x16x32_bf16 a[24:27], a[164:167], v[88:91], a[24:27]
    v_cvt_pk_bf16_f32 v68, v4, v5
    ds_read_b128 a[144:147], v196 offset:33792
    v_exp_f32 v6, v6
    v_exp_f32 v7, v7
    v_mfma_f32_16x16x32_bf16 a[0:3], a[160:163], v[80:83], a[0:3]
    buffer_load_dwordx4 v208, s[8:11], s34 offen offset:1024 nt lds
    v_mfma_f32_16x16x32_bf16 a[16:19], a[164:167], v[80:83], a[16:19]
    v_cvt_pk_bf16_f32 v69, v6, v7
    v_mfma_f32_16x16x32_bf16 v[112:115], v[252:255], v[80:83], v[112:115]
    ds_read_b64_tr_b16 a[160:161], v200 offset:16384
    v_mfma_f32_16x16x32_bf16 v[32:35], a[132:135], v[132:135], v[32:35]
    v_exp_f32 v8, v8
    v_mfma_f32_16x16x32_bf16 v[48:51], a[148:151], v[132:135], v[48:51]
    v_exp_f32 v9, v9
    v_mfma_f32_16x16x32_bf16 v[36:39], a[132:135], v[148:151], v[36:39]
    ds_read_b64_tr_b16 a[162:163], v200 offset:17408
    v_mfma_f32_16x16x32_bf16 v[52:55], a[148:151], v[148:151], v[52:55]
    v_cvt_pk_bf16_f32 v72, v8, v9
    ds_read_b64_tr_b16 a[164:165], v201 offset:16384
    v_mfma_f32_16x16x32_bf16 v[40:43], a[132:135], v[164:167], v[40:43]
    v_exp_f32 v10, v10
    v_mfma_f32_16x16x32_bf16 v[56:59], a[148:151], v[164:167], v[56:59]
    v_exp_f32 v11, v11
    buffer_load_dwordx4 v209, s[8:11], s34 offen offset:2048 nt lds
    v_cvt_pk_bf16_f32 v73, v10, v11
    ds_read_b128 a[132:135], v197 offset:32768
    v_mfma_f32_16x16x32_bf16 a[40:43], a[168:171], v[88:91], a[40:43]
    v_mfma_f32_16x16x32_bf16 a[56:59], a[172:175], v[88:91], a[56:59]
    ds_read_b64_tr_b16 a[166:167], v201 offset:17408
    ds_read_b128 a[148:151], v197 offset:33792
    v_mfma_f32_16x16x32_bf16 a[32:35], a[168:171], v[80:83], a[32:35]
    v_mfma_f32_16x16x32_bf16 a[48:51], a[172:175], v[80:83], a[48:51]
    v_mfma_f32_16x16x32_bf16 a[36:39], a[168:171], v[84:87], a[36:39]
    s_waitcnt lgkmcnt(7)
    buffer_load_dwordx4 v209, s[8:11], s34 offen offset:3072 nt lds
    v_mfma_f32_16x16x32_bf16 a[52:55], a[172:175], v[84:87], a[52:55]
    v_mfma_f32_16x16x32_bf16 v[116:119], v[252:255], v[84:87], v[116:119]
    ds_read_b64_tr_b16 a[168:169], v202 offset:16384
    v_mfma_f32_16x16x32_bf16 v[32:35], a[136:139], v[136:139], v[32:35]
    v_exp_f32 v16, v16
    v_mfma_f32_16x16x32_bf16 v[48:51], a[152:155], v[136:139], v[48:51]
    v_exp_f32 v17, v17
    v_mfma_f32_16x16x32_bf16 v[36:39], a[136:139], v[152:155], v[36:39]
    ds_read_b64_tr_b16 a[170:171], v202 offset:17408
    s_add_u32 m0, s29, 114688
    v_mfma_f32_16x16x32_bf16 v[52:55], a[152:155], v[152:155], v[52:55]
    v_cvt_pk_bf16_f32 v66, v16, v17
    ds_read_b64_tr_b16 a[172:173], v203 offset:16384
    v_mfma_f32_16x16x32_bf16 v[40:43], a[136:139], v[168:171], v[40:43]
    v_exp_f32 v18, v18
    v_mfma_f32_16x16x32_bf16 v[56:59], a[152:155], v[168:171], v[56:59]
    v_exp_f32 v19, v19
    buffer_load_dwordx4 v210, s[12:15], s75 offen offset:0 nt lds
    v_cvt_pk_bf16_f32 v67, v18, v19
    ds_read_b128 a[136:139], v198 offset:32768
    v_exp_f32 v20, v20
    v_exp_f32 v21, v21
    v_mfma_f32_16x16x32_bf16 a[64:67], a[176:179], v[80:83], a[64:67]
    ds_read_b64_tr_b16 a[174:175], v203 offset:17408
    v_mfma_f32_16x16x32_bf16 a[80:83], a[180:183], v[80:83], a[80:83]
    v_cvt_pk_bf16_f32 v70, v20, v21
    ds_read_b128 a[152:155], v198 offset:33792
    v_mfma_f32_16x16x32_bf16 a[68:71], a[176:179], v[84:87], a[68:71]
    v_exp_f32 v22, v22
    v_mfma_f32_16x16x32_bf16 a[84:87], a[180:183], v[84:87], a[84:87]
    v_exp_f32 v23, v23
    v_mfma_f32_16x16x32_bf16 a[72:75], a[176:179], v[88:91], a[72:75]
    buffer_load_dwordx4 v210, s[12:15], s75 offen offset:1024 nt lds
    v_mfma_f32_16x16x32_bf16 a[88:91], a[180:183], v[88:91], a[88:91]
    v_cvt_pk_bf16_f32 v71, v22, v23
    v_mfma_f32_16x16x32_bf16 v[120:123], v[252:255], v[88:91], v[120:123]
    ds_read_b64_tr_b16 a[176:177], v204 offset:16384
    v_mfma_f32_16x16x32_bf16 v[32:35], a[140:143], v[140:143], v[32:35]
    v_exp_f32 v24, v24
    v_mfma_f32_16x16x32_bf16 v[48:51], a[156:159], v[140:143], v[48:51]
    v_exp_f32 v25, v25
    v_mfma_f32_16x16x32_bf16 v[36:39], a[140:143], v[156:159], v[36:39]
    ds_read_b64_tr_b16 a[178:179], v204 offset:17408
    v_mfma_f32_16x16x32_bf16 v[52:55], a[156:159], v[156:159], v[52:55]
    v_cvt_pk_bf16_f32 v74, v24, v25
    ds_read_b64_tr_b16 a[180:181], v205 offset:16384
    v_mfma_f32_16x16x32_bf16 v[40:43], a[140:143], v[172:175], v[40:43]
    v_exp_f32 v26, v26
    v_mfma_f32_16x16x32_bf16 v[56:59], a[156:159], v[172:175], v[56:59]
    v_exp_f32 v27, v27
    buffer_load_dwordx4 v211, s[12:15], s75 offen offset:2048 nt lds
    v_cvt_pk_bf16_f32 v75, v26, v27
    ds_read_b128 a[140:143], v199 offset:32768
    v_mfma_f32_16x16x32_bf16 a[96:99], a[184:187], v[80:83], a[96:99]
    v_mfma_f32_16x16x32_bf16 a[112:115], a[188:191], v[80:83], a[112:115]
    v_mfma_f32_16x16x32_bf16 a[100:103], a[184:187], v[84:87], a[100:103]
    ds_read_b64_tr_b16 a[182:183], v205 offset:17408
    v_mfma_f32_16x16x32_bf16 a[116:119], a[188:191], v[84:87], a[116:119]
    ds_read_b128 a[156:159], v199 offset:33792
    v_mfma_f32_16x16x32_bf16 a[104:107], a[184:187], v[88:91], a[104:107]
    v_mfma_f32_16x16x32_bf16 a[120:123], a[188:191], v[88:91], a[120:123]
    s_waitcnt lgkmcnt(7)
    buffer_load_dwordx4 v211, s[12:15], s75 offen offset:3072 nt lds
    ds_read_b64_tr_b16 a[184:185], v206 offset:16384
    v_mfma_f32_16x16x32_bf16 v[0:3], a[128:131], v[128:131], v[96:99]
    v_exp_f32 v32, v32
    v_mfma_f32_16x16x32_bf16 v[16:19], a[144:147], v[128:131], v[96:99]
    v_exp_f32 v33, v33
    v_mfma_f32_16x16x32_bf16 v[4:7], a[128:131], v[144:147], v[100:103]
    ds_read_b64_tr_b16 a[186:187], v206 offset:17408
    v_mfma_f32_16x16x32_bf16 v[20:23], a[144:147], v[144:147], v[100:103]
    v_cvt_pk_bf16_f32 v80, v32, v33
    ds_read_b64_tr_b16 a[188:189], v207 offset:16384
    v_mfma_f32_16x16x32_bf16 v[8:11], a[128:131], v[160:163], v[104:107]
    v_exp_f32 v34, v34
    v_mfma_f32_16x16x32_bf16 v[24:27], a[144:147], v[160:163], v[104:107]
    v_exp_f32 v35, v35
    s_add_u32 s34, s34, 16384
    v_cvt_pk_bf16_f32 v81, v34, v35
    ds_read_b128 a[128:131], v196 offset:40960
    v_mfma_f32_16x16x32_bf16 a[4:7], a[160:163], v[68:71], a[4:7]
    v_exp_f32 v36, v36
    v_mfma_f32_16x16x32_bf16 a[20:23], a[164:167], v[68:71], a[20:23]
    v_exp_f32 v37, v37
    v_mfma_f32_16x16x32_bf16 a[8:11], a[160:163], v[72:75], a[8:11]
    ds_read_b64_tr_b16 a[190:191], v207 offset:17408
    v_mfma_f32_16x16x32_bf16 a[24:27], a[164:167], v[72:75], a[24:27]
    v_cvt_pk_bf16_f32 v84, v36, v37
    ds_read_b128 a[144:147], v196 offset:41984
    v_exp_f32 v38, v38
    v_exp_f32 v39, v39
    v_mfma_f32_16x16x32_bf16 a[0:3], a[160:163], v[64:67], a[0:3]
    s_add_u32 s75, s75, 16384
    v_mfma_f32_16x16x32_bf16 a[16:19], a[164:167], v[64:67], a[16:19]
    v_cvt_pk_bf16_f32 v85, v38, v39
    v_mfma_f32_16x16x32_bf16 v[112:115], v[252:255], v[64:67], v[112:115]
    ds_read_b64_tr_b16 a[160:161], v200 offset:24576
    v_mfma_f32_16x16x32_bf16 v[0:3], a[132:135], v[132:135], v[0:3]
    v_exp_f32 v40, v40
    v_mfma_f32_16x16x32_bf16 v[16:19], a[148:151], v[132:135], v[16:19]
    v_exp_f32 v41, v41
    v_mfma_f32_16x16x32_bf16 v[4:7], a[132:135], v[148:151], v[4:7]
    ds_read_b64_tr_b16 a[162:163], v200 offset:25600
    v_mfma_f32_16x16x32_bf16 v[20:23], a[148:151], v[148:151], v[20:23]
    v_cvt_pk_bf16_f32 v88, v40, v41
    ds_read_b64_tr_b16 a[164:165], v201 offset:24576
    v_mfma_f32_16x16x32_bf16 v[8:11], a[132:135], v[164:167], v[8:11]
    v_exp_f32 v42, v42
    v_mfma_f32_16x16x32_bf16 v[24:27], a[148:151], v[164:167], v[24:27]
    v_exp_f32 v43, v43
    s_nop 0
    v_cvt_pk_bf16_f32 v89, v42, v43
    ds_read_b128 a[132:135], v197 offset:40960
    v_mfma_f32_16x16x32_bf16 a[40:43], a[168:171], v[72:75], a[40:43]
    v_mfma_f32_16x16x32_bf16 a[56:59], a[172:175], v[72:75], a[56:59]
    ds_read_b64_tr_b16 a[166:167], v201 offset:25600
    ds_read_b128 a[148:151], v197 offset:41984
    v_mfma_f32_16x16x32_bf16 a[32:35], a[168:171], v[64:67], a[32:35]
    v_mfma_f32_16x16x32_bf16 a[48:51], a[172:175], v[64:67], a[48:51]
    v_mfma_f32_16x16x32_bf16 a[36:39], a[168:171], v[68:71], a[36:39]
    s_waitcnt lgkmcnt(7)
    v_mfma_f32_16x16x32_bf16 a[52:55], a[172:175], v[68:71], a[52:55]
    v_mfma_f32_16x16x32_bf16 v[116:119], v[252:255], v[68:71], v[116:119]
    ds_read_b64_tr_b16 a[168:169], v202 offset:24576
    v_mfma_f32_16x16x32_bf16 v[0:3], a[136:139], v[136:139], v[0:3]
    v_exp_f32 v48, v48
    v_mfma_f32_16x16x32_bf16 v[16:19], a[152:155], v[136:139], v[16:19]
    v_exp_f32 v49, v49
    v_mfma_f32_16x16x32_bf16 v[4:7], a[136:139], v[152:155], v[4:7]
    ds_read_b64_tr_b16 a[170:171], v202 offset:25600
    v_mfma_f32_16x16x32_bf16 v[20:23], a[152:155], v[152:155], v[20:23]
    v_cvt_pk_bf16_f32 v82, v48, v49
    ds_read_b64_tr_b16 a[172:173], v203 offset:24576
    v_mfma_f32_16x16x32_bf16 v[8:11], a[136:139], v[168:171], v[8:11]
    v_exp_f32 v50, v50
    v_mfma_f32_16x16x32_bf16 v[24:27], a[152:155], v[168:171], v[24:27]
    v_exp_f32 v51, v51
    s_nop 0
    v_cvt_pk_bf16_f32 v83, v50, v51
    ds_read_b128 a[136:139], v198 offset:40960
    v_exp_f32 v52, v52
    v_exp_f32 v53, v53
    v_mfma_f32_16x16x32_bf16 a[64:67], a[176:179], v[64:67], a[64:67]
    ds_read_b64_tr_b16 a[174:175], v203 offset:25600
    v_mfma_f32_16x16x32_bf16 a[80:83], a[180:183], v[64:67], a[80:83]
    v_cvt_pk_bf16_f32 v86, v52, v53
    ds_read_b128 a[152:155], v198 offset:41984
    v_mfma_f32_16x16x32_bf16 a[68:71], a[176:179], v[68:71], a[68:71]
    v_exp_f32 v54, v54
    v_mfma_f32_16x16x32_bf16 a[84:87], a[180:183], v[68:71], a[84:87]
    v_exp_f32 v55, v55
    v_mfma_f32_16x16x32_bf16 a[72:75], a[176:179], v[72:75], a[72:75]
    v_mfma_f32_16x16x32_bf16 a[88:91], a[180:183], v[72:75], a[88:91]
    v_cvt_pk_bf16_f32 v87, v54, v55
    v_mfma_f32_16x16x32_bf16 v[120:123], v[252:255], v[72:75], v[120:123]
    ds_read_b64_tr_b16 a[176:177], v204 offset:24576
    v_mfma_f32_16x16x32_bf16 v[0:3], a[140:143], v[140:143], v[0:3]
    v_exp_f32 v56, v56
    v_mfma_f32_16x16x32_bf16 v[16:19], a[156:159], v[140:143], v[16:19]
    v_exp_f32 v57, v57
    v_mfma_f32_16x16x32_bf16 v[4:7], a[140:143], v[156:159], v[4:7]
    ds_read_b64_tr_b16 a[178:179], v204 offset:25600
    v_mfma_f32_16x16x32_bf16 v[20:23], a[156:159], v[156:159], v[20:23]
    v_cvt_pk_bf16_f32 v90, v56, v57
    ds_read_b64_tr_b16 a[180:181], v205 offset:24576
    v_mfma_f32_16x16x32_bf16 v[8:11], a[140:143], v[172:175], v[8:11]
    v_exp_f32 v58, v58
    v_mfma_f32_16x16x32_bf16 v[24:27], a[156:159], v[172:175], v[24:27]
    v_exp_f32 v59, v59
    s_nop 0
    v_cvt_pk_bf16_f32 v91, v58, v59
    ds_read_b128 a[140:143], v199 offset:40960
    v_mfma_f32_16x16x32_bf16 a[96:99], a[184:187], v[64:67], a[96:99]
    v_mfma_f32_16x16x32_bf16 a[112:115], a[188:191], v[64:67], a[112:115]
    v_mfma_f32_16x16x32_bf16 a[100:103], a[184:187], v[68:71], a[100:103]
    ds_read_b64_tr_b16 a[182:183], v205 offset:25600
    v_mfma_f32_16x16x32_bf16 a[116:119], a[188:191], v[68:71], a[116:119]
    ds_read_b128 a[156:159], v199 offset:41984
    v_mfma_f32_16x16x32_bf16 a[104:107], a[184:187], v[72:75], a[104:107]
    v_mfma_f32_16x16x32_bf16 a[120:123], a[188:191], v[72:75], a[120:123]
    s_waitcnt lgkmcnt(7)
    ds_read_b64_tr_b16 a[184:185], v206 offset:24576
    s_waitcnt vmcnt(8)
    s_barrier
    v_mfma_f32_16x16x32_bf16 v[32:35], a[128:131], v[128:131], v[96:99]
    v_exp_f32 v0, v0
    v_mfma_f32_16x16x32_bf16 v[48:51], a[144:147], v[128:131], v[96:99]
    v_exp_f32 v1, v1
    v_mfma_f32_16x16x32_bf16 v[36:39], a[128:131], v[144:147], v[100:103]
    ds_read_b64_tr_b16 a[186:187], v206 offset:25600
    s_add_u32 m0, s29, 16384
    v_mfma_f32_16x16x32_bf16 v[52:55], a[144:147], v[144:147], v[100:103]
    v_cvt_pk_bf16_f32 v64, v0, v1
    ds_read_b64_tr_b16 a[188:189], v207 offset:24576
    v_mfma_f32_16x16x32_bf16 v[40:43], a[128:131], v[160:163], v[104:107]
    v_exp_f32 v2, v2
    v_mfma_f32_16x16x32_bf16 v[56:59], a[144:147], v[160:163], v[104:107]
    v_exp_f32 v3, v3
    buffer_load_dwordx4 v208, s[8:11], s34 offen offset:0 nt lds
    v_cvt_pk_bf16_f32 v65, v2, v3
    ds_read_b128 a[128:131], v196 offset:49152
    v_mfma_f32_16x16x32_bf16 a[4:7], a[160:163], v[84:87], a[4:7]
    v_exp_f32 v4, v4
    v_mfma_f32_16x16x32_bf16 a[20:23], a[164:167], v[84:87], a[20:23]
    v_exp_f32 v5, v5
    v_mfma_f32_16x16x32_bf16 a[8:11], a[160:163], v[88:91], a[8:11]
    ds_read_b64_tr_b16 a[190:191], v207 offset:25600
    v_mfma_f32_16x16x32_bf16 a[24:27], a[164:167], v[88:91], a[24:27]
    v_cvt_pk_bf16_f32 v68, v4, v5
    ds_read_b128 a[144:147], v196 offset:50176
    v_exp_f32 v6, v6
    v_exp_f32 v7, v7
    v_mfma_f32_16x16x32_bf16 a[0:3], a[160:163], v[80:83], a[0:3]
    buffer_load_dwordx4 v208, s[8:11], s34 offen offset:1024 nt lds
    v_mfma_f32_16x16x32_bf16 a[16:19], a[164:167], v[80:83], a[16:19]
    v_cvt_pk_bf16_f32 v69, v6, v7
    v_mfma_f32_16x16x32_bf16 v[112:115], v[252:255], v[80:83], v[112:115]
    ds_read_b64_tr_b16 a[160:161], v200 offset:32768
    v_mfma_f32_16x16x32_bf16 v[32:35], a[132:135], v[132:135], v[32:35]
    v_exp_f32 v8, v8
    v_mfma_f32_16x16x32_bf16 v[48:51], a[148:151], v[132:135], v[48:51]
    v_exp_f32 v9, v9
    v_mfma_f32_16x16x32_bf16 v[36:39], a[132:135], v[148:151], v[36:39]
    ds_read_b64_tr_b16 a[162:163], v200 offset:33792
    v_mfma_f32_16x16x32_bf16 v[52:55], a[148:151], v[148:151], v[52:55]
    v_cvt_pk_bf16_f32 v72, v8, v9
    ds_read_b64_tr_b16 a[164:165], v201 offset:32768
    v_mfma_f32_16x16x32_bf16 v[40:43], a[132:135], v[164:167], v[40:43]
    v_exp_f32 v10, v10
    v_mfma_f32_16x16x32_bf16 v[56:59], a[148:151], v[164:167], v[56:59]
    v_exp_f32 v11, v11
    buffer_load_dwordx4 v209, s[8:11], s34 offen offset:2048 nt lds
    v_cvt_pk_bf16_f32 v73, v10, v11
    ds_read_b128 a[132:135], v197 offset:49152
    v_mfma_f32_16x16x32_bf16 a[40:43], a[168:171], v[88:91], a[40:43]
    v_mfma_f32_16x16x32_bf16 a[56:59], a[172:175], v[88:91], a[56:59]
    ds_read_b64_tr_b16 a[166:167], v201 offset:33792
    ds_read_b128 a[148:151], v197 offset:50176
    v_mfma_f32_16x16x32_bf16 a[32:35], a[168:171], v[80:83], a[32:35]
    v_mfma_f32_16x16x32_bf16 a[48:51], a[172:175], v[80:83], a[48:51]
    v_mfma_f32_16x16x32_bf16 a[36:39], a[168:171], v[84:87], a[36:39]
    s_waitcnt lgkmcnt(7)
    buffer_load_dwordx4 v209, s[8:11], s34 offen offset:3072 nt lds
    v_mfma_f32_16x16x32_bf16 a[52:55], a[172:175], v[84:87], a[52:55]
    v_mfma_f32_16x16x32_bf16 v[116:119], v[252:255], v[84:87], v[116:119]
    ds_read_b64_tr_b16 a[168:169], v202 offset:32768
    v_mfma_f32_16x16x32_bf16 v[32:35], a[136:139], v[136:139], v[32:35]
    v_exp_f32 v16, v16
    v_mfma_f32_16x16x32_bf16 v[48:51], a[152:155], v[136:139], v[48:51]
    v_exp_f32 v17, v17
    v_mfma_f32_16x16x32_bf16 v[36:39], a[136:139], v[152:155], v[36:39]
    ds_read_b64_tr_b16 a[170:171], v202 offset:33792
    s_add_u32 m0, s29, 65536
    v_mfma_f32_16x16x32_bf16 v[52:55], a[152:155], v[152:155], v[52:55]
    v_cvt_pk_bf16_f32 v66, v16, v17
    ds_read_b64_tr_b16 a[172:173], v203 offset:32768
    v_mfma_f32_16x16x32_bf16 v[40:43], a[136:139], v[168:171], v[40:43]
    v_exp_f32 v18, v18
    v_mfma_f32_16x16x32_bf16 v[56:59], a[152:155], v[168:171], v[56:59]
    v_exp_f32 v19, v19
    buffer_load_dwordx4 v210, s[12:15], s75 offen offset:0 nt lds
    v_cvt_pk_bf16_f32 v67, v18, v19
    ds_read_b128 a[136:139], v198 offset:49152
    v_exp_f32 v20, v20
    v_exp_f32 v21, v21
    v_mfma_f32_16x16x32_bf16 a[64:67], a[176:179], v[80:83], a[64:67]
    ds_read_b64_tr_b16 a[174:175], v203 offset:33792
    v_mfma_f32_16x16x32_bf16 a[80:83], a[180:183], v[80:83], a[80:83]
    v_cvt_pk_bf16_f32 v70, v20, v21
    ds_read_b128 a[152:155], v198 offset:50176
    v_mfma_f32_16x16x32_bf16 a[68:71], a[176:179], v[84:87], a[68:71]
    v_exp_f32 v22, v22
    v_mfma_f32_16x16x32_bf16 a[84:87], a[180:183], v[84:87], a[84:87]
    v_exp_f32 v23, v23
    v_mfma_f32_16x16x32_bf16 a[72:75], a[176:179], v[88:91], a[72:75]
    buffer_load_dwordx4 v210, s[12:15], s75 offen offset:1024 nt lds
    v_mfma_f32_16x16x32_bf16 a[88:91], a[180:183], v[88:91], a[88:91]
    v_cvt_pk_bf16_f32 v71, v22, v23
    v_mfma_f32_16x16x32_bf16 v[120:123], v[252:255], v[88:91], v[120:123]
    ds_read_b64_tr_b16 a[176:177], v204 offset:32768
    v_mfma_f32_16x16x32_bf16 v[32:35], a[140:143], v[140:143], v[32:35]
    v_exp_f32 v24, v24
    v_mfma_f32_16x16x32_bf16 v[48:51], a[156:159], v[140:143], v[48:51]
    v_exp_f32 v25, v25
    v_mfma_f32_16x16x32_bf16 v[36:39], a[140:143], v[156:159], v[36:39]
    ds_read_b64_tr_b16 a[178:179], v204 offset:33792
    v_mfma_f32_16x16x32_bf16 v[52:55], a[156:159], v[156:159], v[52:55]
    v_cvt_pk_bf16_f32 v74, v24, v25
    ds_read_b64_tr_b16 a[180:181], v205 offset:32768
    v_mfma_f32_16x16x32_bf16 v[40:43], a[140:143], v[172:175], v[40:43]
    v_exp_f32 v26, v26
    v_mfma_f32_16x16x32_bf16 v[56:59], a[156:159], v[172:175], v[56:59]
    v_exp_f32 v27, v27
    buffer_load_dwordx4 v211, s[12:15], s75 offen offset:2048 nt lds
    v_cvt_pk_bf16_f32 v75, v26, v27
    ds_read_b128 a[140:143], v199 offset:49152
    v_mfma_f32_16x16x32_bf16 a[96:99], a[184:187], v[80:83], a[96:99]
    v_mfma_f32_16x16x32_bf16 a[112:115], a[188:191], v[80:83], a[112:115]
    v_mfma_f32_16x16x32_bf16 a[100:103], a[184:187], v[84:87], a[100:103]
    ds_read_b64_tr_b16 a[182:183], v205 offset:33792
    v_mfma_f32_16x16x32_bf16 a[116:119], a[188:191], v[84:87], a[116:119]
    ds_read_b128 a[156:159], v199 offset:50176
    v_mfma_f32_16x16x32_bf16 a[104:107], a[184:187], v[88:91], a[104:107]
    v_mfma_f32_16x16x32_bf16 a[120:123], a[188:191], v[88:91], a[120:123]
    s_waitcnt lgkmcnt(7)
    buffer_load_dwordx4 v211, s[12:15], s75 offen offset:3072 nt lds
    ds_read_b64_tr_b16 a[184:185], v206 offset:32768
    v_mfma_f32_16x16x32_bf16 v[0:3], a[128:131], v[128:131], v[96:99]
    v_exp_f32 v32, v32
    v_mfma_f32_16x16x32_bf16 v[16:19], a[144:147], v[128:131], v[96:99]
    v_exp_f32 v33, v33
    v_mfma_f32_16x16x32_bf16 v[4:7], a[128:131], v[144:147], v[100:103]
    ds_read_b64_tr_b16 a[186:187], v206 offset:33792
    v_mfma_f32_16x16x32_bf16 v[20:23], a[144:147], v[144:147], v[100:103]
    v_cvt_pk_bf16_f32 v80, v32, v33
    ds_read_b64_tr_b16 a[188:189], v207 offset:32768
    v_mfma_f32_16x16x32_bf16 v[8:11], a[128:131], v[160:163], v[104:107]
    v_exp_f32 v34, v34
    v_mfma_f32_16x16x32_bf16 v[24:27], a[144:147], v[160:163], v[104:107]
    v_exp_f32 v35, v35
    s_add_u32 s34, s34, 16384
    v_cvt_pk_bf16_f32 v81, v34, v35
    ds_read_b128 a[128:131], v196 offset:57344
    v_mfma_f32_16x16x32_bf16 a[4:7], a[160:163], v[68:71], a[4:7]
    v_exp_f32 v36, v36
    v_mfma_f32_16x16x32_bf16 a[20:23], a[164:167], v[68:71], a[20:23]
    v_exp_f32 v37, v37
    v_mfma_f32_16x16x32_bf16 a[8:11], a[160:163], v[72:75], a[8:11]
    ds_read_b64_tr_b16 a[190:191], v207 offset:33792
    v_mfma_f32_16x16x32_bf16 a[24:27], a[164:167], v[72:75], a[24:27]
    v_cvt_pk_bf16_f32 v84, v36, v37
    ds_read_b128 a[144:147], v196 offset:58368
    v_exp_f32 v38, v38
    v_exp_f32 v39, v39
    v_mfma_f32_16x16x32_bf16 a[0:3], a[160:163], v[64:67], a[0:3]
    s_add_u32 s75, s75, 16384
    v_mfma_f32_16x16x32_bf16 a[16:19], a[164:167], v[64:67], a[16:19]
    v_cvt_pk_bf16_f32 v85, v38, v39
    v_mfma_f32_16x16x32_bf16 v[112:115], v[252:255], v[64:67], v[112:115]
    ds_read_b64_tr_b16 a[160:161], v200 offset:40960
    v_mfma_f32_16x16x32_bf16 v[0:3], a[132:135], v[132:135], v[0:3]
    v_exp_f32 v40, v40
    v_mfma_f32_16x16x32_bf16 v[16:19], a[148:151], v[132:135], v[16:19]
    v_exp_f32 v41, v41
    v_mfma_f32_16x16x32_bf16 v[4:7], a[132:135], v[148:151], v[4:7]
    ds_read_b64_tr_b16 a[162:163], v200 offset:41984
    v_mfma_f32_16x16x32_bf16 v[20:23], a[148:151], v[148:151], v[20:23]
    v_cvt_pk_bf16_f32 v88, v40, v41
    ds_read_b64_tr_b16 a[164:165], v201 offset:40960
    v_mfma_f32_16x16x32_bf16 v[8:11], a[132:135], v[164:167], v[8:11]
    v_exp_f32 v42, v42
    v_mfma_f32_16x16x32_bf16 v[24:27], a[148:151], v[164:167], v[24:27]
    v_exp_f32 v43, v43
    s_nop 0
    v_cvt_pk_bf16_f32 v89, v42, v43
    ds_read_b128 a[132:135], v197 offset:57344
    v_mfma_f32_16x16x32_bf16 a[40:43], a[168:171], v[72:75], a[40:43]
    v_mfma_f32_16x16x32_bf16 a[56:59], a[172:175], v[72:75], a[56:59]
    ds_read_b64_tr_b16 a[166:167], v201 offset:41984
    ds_read_b128 a[148:151], v197 offset:58368
    v_mfma_f32_16x16x32_bf16 a[32:35], a[168:171], v[64:67], a[32:35]
    v_mfma_f32_16x16x32_bf16 a[48:51], a[172:175], v[64:67], a[48:51]
    v_mfma_f32_16x16x32_bf16 a[36:39], a[168:171], v[68:71], a[36:39]
    s_waitcnt lgkmcnt(7)
    v_mfma_f32_16x16x32_bf16 a[52:55], a[172:175], v[68:71], a[52:55]
    v_mfma_f32_16x16x32_bf16 v[116:119], v[252:255], v[68:71], v[116:119]
    ds_read_b64_tr_b16 a[168:169], v202 offset:40960
    v_mfma_f32_16x16x32_bf16 v[0:3], a[136:139], v[136:139], v[0:3]
    v_exp_f32 v48, v48
    v_mfma_f32_16x16x32_bf16 v[16:19], a[152:155], v[136:139], v[16:19]
    v_exp_f32 v49, v49
    v_mfma_f32_16x16x32_bf16 v[4:7], a[136:139], v[152:155], v[4:7]
    ds_read_b64_tr_b16 a[170:171], v202 offset:41984
    v_mfma_f32_16x16x32_bf16 v[20:23], a[152:155], v[152:155], v[20:23]
    v_cvt_pk_bf16_f32 v82, v48, v49
    ds_read_b64_tr_b16 a[172:173], v203 offset:40960
    v_mfma_f32_16x16x32_bf16 v[8:11], a[136:139], v[168:171], v[8:11]
    v_exp_f32 v50, v50
    v_mfma_f32_16x16x32_bf16 v[24:27], a[152:155], v[168:171], v[24:27]
    v_exp_f32 v51, v51
    s_nop 0
    v_cvt_pk_bf16_f32 v83, v50, v51
    ds_read_b128 a[136:139], v198 offset:57344
    v_exp_f32 v52, v52
    v_exp_f32 v53, v53
    v_mfma_f32_16x16x32_bf16 a[64:67], a[176:179], v[64:67], a[64:67]
    ds_read_b64_tr_b16 a[174:175], v203 offset:41984
    v_mfma_f32_16x16x32_bf16 a[80:83], a[180:183], v[64:67], a[80:83]
    v_cvt_pk_bf16_f32 v86, v52, v53
    ds_read_b128 a[152:155], v198 offset:58368
    v_mfma_f32_16x16x32_bf16 a[68:71], a[176:179], v[68:71], a[68:71]
    v_exp_f32 v54, v54
    v_mfma_f32_16x16x32_bf16 a[84:87], a[180:183], v[68:71], a[84:87]
    v_exp_f32 v55, v55
    v_mfma_f32_16x16x32_bf16 a[72:75], a[176:179], v[72:75], a[72:75]
    v_mfma_f32_16x16x32_bf16 a[88:91], a[180:183], v[72:75], a[88:91]
    v_cvt_pk_bf16_f32 v87, v54, v55
    v_mfma_f32_16x16x32_bf16 v[120:123], v[252:255], v[72:75], v[120:123]
    ds_read_b64_tr_b16 a[176:177], v204 offset:40960
    v_mfma_f32_16x16x32_bf16 v[0:3], a[140:143], v[140:143], v[0:3]
    v_exp_f32 v56, v56
    v_mfma_f32_16x16x32_bf16 v[16:19], a[156:159], v[140:143], v[16:19]
    v_exp_f32 v57, v57
    v_mfma_f32_16x16x32_bf16 v[4:7], a[140:143], v[156:159], v[4:7]
    ds_read_b64_tr_b16 a[178:179], v204 offset:41984
    v_mfma_f32_16x16x32_bf16 v[20:23], a[156:159], v[156:159], v[20:23]
    v_cvt_pk_bf16_f32 v90, v56, v57
    ds_read_b64_tr_b16 a[180:181], v205 offset:40960
    v_mfma_f32_16x16x32_bf16 v[8:11], a[140:143], v[172:175], v[8:11]
    v_exp_f32 v58, v58
    v_mfma_f32_16x16x32_bf16 v[24:27], a[156:159], v[172:175], v[24:27]
    v_exp_f32 v59, v59
    s_nop 0
    v_cvt_pk_bf16_f32 v91, v58, v59
    ds_read_b128 a[140:143], v199 offset:57344
    v_mfma_f32_16x16x32_bf16 a[96:99], a[184:187], v[64:67], a[96:99]
    v_mfma_f32_16x16x32_bf16 a[112:115], a[188:191], v[64:67], a[112:115]
    v_mfma_f32_16x16x32_bf16 a[100:103], a[184:187], v[68:71], a[100:103]
    ds_read_b64_tr_b16 a[182:183], v205 offset:41984
    v_mfma_f32_16x16x32_bf16 a[116:119], a[188:191], v[68:71], a[116:119]
    ds_read_b128 a[156:159], v199 offset:58368
    v_mfma_f32_16x16x32_bf16 a[104:107], a[184:187], v[72:75], a[104:107]
    v_mfma_f32_16x16x32_bf16 a[120:123], a[188:191], v[72:75], a[120:123]
    s_waitcnt lgkmcnt(7)
    ds_read_b64_tr_b16 a[184:185], v206 offset:40960
    s_waitcnt vmcnt(8)
    s_barrier
    v_mfma_f32_16x16x32_bf16 v[32:35], a[128:131], v[128:131], v[96:99]
    v_exp_f32 v0, v0
    v_mfma_f32_16x16x32_bf16 v[48:51], a[144:147], v[128:131], v[96:99]
    v_exp_f32 v1, v1
    v_mfma_f32_16x16x32_bf16 v[36:39], a[128:131], v[144:147], v[100:103]
    ds_read_b64_tr_b16 a[186:187], v206 offset:41984
    s_add_u32 m0, s29, 32768
    v_mfma_f32_16x16x32_bf16 v[52:55], a[144:147], v[144:147], v[100:103]
    v_cvt_pk_bf16_f32 v64, v0, v1
    ds_read_b64_tr_b16 a[188:189], v207 offset:40960
    v_mfma_f32_16x16x32_bf16 v[40:43], a[128:131], v[160:163], v[104:107]
    v_exp_f32 v2, v2
    v_mfma_f32_16x16x32_bf16 v[56:59], a[144:147], v[160:163], v[104:107]
    v_exp_f32 v3, v3
    buffer_load_dwordx4 v208, s[8:11], s34 offen offset:0 nt lds
    v_cvt_pk_bf16_f32 v65, v2, v3
    ds_read_b128 a[128:131], v196 offset:0
    v_mfma_f32_16x16x32_bf16 a[4:7], a[160:163], v[84:87], a[4:7]
    v_exp_f32 v4, v4
    v_mfma_f32_16x16x32_bf16 a[20:23], a[164:167], v[84:87], a[20:23]
    v_exp_f32 v5, v5
    v_mfma_f32_16x16x32_bf16 a[8:11], a[160:163], v[88:91], a[8:11]
    ds_read_b64_tr_b16 a[190:191], v207 offset:41984
    v_mfma_f32_16x16x32_bf16 a[24:27], a[164:167], v[88:91], a[24:27]
    v_cvt_pk_bf16_f32 v68, v4, v5
    ds_read_b128 a[144:147], v196 offset:1024
    v_exp_f32 v6, v6
    v_exp_f32 v7, v7
    v_mfma_f32_16x16x32_bf16 a[0:3], a[160:163], v[80:83], a[0:3]
    buffer_load_dwordx4 v208, s[8:11], s34 offen offset:1024 nt lds
    v_mfma_f32_16x16x32_bf16 a[16:19], a[164:167], v[80:83], a[16:19]
    v_cvt_pk_bf16_f32 v69, v6, v7
    v_mfma_f32_16x16x32_bf16 v[112:115], v[252:255], v[80:83], v[112:115]
    ds_read_b64_tr_b16 a[160:161], v200 offset:49152
    v_mfma_f32_16x16x32_bf16 v[32:35], a[132:135], v[132:135], v[32:35]
    v_exp_f32 v8, v8
    v_mfma_f32_16x16x32_bf16 v[48:51], a[148:151], v[132:135], v[48:51]
    v_exp_f32 v9, v9
    v_mfma_f32_16x16x32_bf16 v[36:39], a[132:135], v[148:151], v[36:39]
    ds_read_b64_tr_b16 a[162:163], v200 offset:50176
    v_mfma_f32_16x16x32_bf16 v[52:55], a[148:151], v[148:151], v[52:55]
    v_cvt_pk_bf16_f32 v72, v8, v9
    ds_read_b64_tr_b16 a[164:165], v201 offset:49152
    v_mfma_f32_16x16x32_bf16 v[40:43], a[132:135], v[164:167], v[40:43]
    v_exp_f32 v10, v10
    v_mfma_f32_16x16x32_bf16 v[56:59], a[148:151], v[164:167], v[56:59]
    v_exp_f32 v11, v11
    buffer_load_dwordx4 v209, s[8:11], s34 offen offset:2048 nt lds
    v_cvt_pk_bf16_f32 v73, v10, v11
    ds_read_b128 a[132:135], v197 offset:0
    v_mfma_f32_16x16x32_bf16 a[40:43], a[168:171], v[88:91], a[40:43]
    v_mfma_f32_16x16x32_bf16 a[56:59], a[172:175], v[88:91], a[56:59]
    ds_read_b64_tr_b16 a[166:167], v201 offset:50176
    ds_read_b128 a[148:151], v197 offset:1024
    v_mfma_f32_16x16x32_bf16 a[32:35], a[168:171], v[80:83], a[32:35]
    v_mfma_f32_16x16x32_bf16 a[48:51], a[172:175], v[80:83], a[48:51]
    v_mfma_f32_16x16x32_bf16 a[36:39], a[168:171], v[84:87], a[36:39]
    s_waitcnt lgkmcnt(7)
    buffer_load_dwordx4 v209, s[8:11], s34 offen offset:3072 nt lds
    v_mfma_f32_16x16x32_bf16 a[52:55], a[172:175], v[84:87], a[52:55]
    v_mfma_f32_16x16x32_bf16 v[116:119], v[252:255], v[84:87], v[116:119]
    ds_read_b64_tr_b16 a[168:169], v202 offset:49152
    v_mfma_f32_16x16x32_bf16 v[32:35], a[136:139], v[136:139], v[32:35]
    v_exp_f32 v16, v16
    v_mfma_f32_16x16x32_bf16 v[48:51], a[152:155], v[136:139], v[48:51]
    v_exp_f32 v17, v17
    v_mfma_f32_16x16x32_bf16 v[36:39], a[136:139], v[152:155], v[36:39]
    ds_read_b64_tr_b16 a[170:171], v202 offset:50176
    s_add_u32 m0, s29, 81920
    v_mfma_f32_16x16x32_bf16 v[52:55], a[152:155], v[152:155], v[52:55]
    v_cvt_pk_bf16_f32 v66, v16, v17
    ds_read_b64_tr_b16 a[172:173], v203 offset:49152
    v_mfma_f32_16x16x32_bf16 v[40:43], a[136:139], v[168:171], v[40:43]
    v_exp_f32 v18, v18
    v_mfma_f32_16x16x32_bf16 v[56:59], a[152:155], v[168:171], v[56:59]
    v_exp_f32 v19, v19
    buffer_load_dwordx4 v210, s[12:15], s75 offen offset:0 nt lds
    v_cvt_pk_bf16_f32 v67, v18, v19
    ds_read_b128 a[136:139], v198 offset:0
    v_exp_f32 v20, v20
    v_exp_f32 v21, v21
    v_mfma_f32_16x16x32_bf16 a[64:67], a[176:179], v[80:83], a[64:67]
    ds_read_b64_tr_b16 a[174:175], v203 offset:50176
    v_mfma_f32_16x16x32_bf16 a[80:83], a[180:183], v[80:83], a[80:83]
    v_cvt_pk_bf16_f32 v70, v20, v21
    ds_read_b128 a[152:155], v198 offset:1024
    v_mfma_f32_16x16x32_bf16 a[68:71], a[176:179], v[84:87], a[68:71]
    v_exp_f32 v22, v22
    v_mfma_f32_16x16x32_bf16 a[84:87], a[180:183], v[84:87], a[84:87]
    v_exp_f32 v23, v23
    v_mfma_f32_16x16x32_bf16 a[72:75], a[176:179], v[88:91], a[72:75]
    buffer_load_dwordx4 v210, s[12:15], s75 offen offset:1024 nt lds
    v_mfma_f32_16x16x32_bf16 a[88:91], a[180:183], v[88:91], a[88:91]
    v_cvt_pk_bf16_f32 v71, v22, v23
    v_mfma_f32_16x16x32_bf16 v[120:123], v[252:255], v[88:91], v[120:123]
    ds_read_b64_tr_b16 a[176:177], v204 offset:49152
    v_mfma_f32_16x16x32_bf16 v[32:35], a[140:143], v[140:143], v[32:35]
    v_exp_f32 v24, v24
    v_mfma_f32_16x16x32_bf16 v[48:51], a[156:159], v[140:143], v[48:51]
    v_exp_f32 v25, v25
    v_mfma_f32_16x16x32_bf16 v[36:39], a[140:143], v[156:159], v[36:39]
    ds_read_b64_tr_b16 a[178:179], v204 offset:50176
    v_mfma_f32_16x16x32_bf16 v[52:55], a[156:159], v[156:159], v[52:55]
    v_cvt_pk_bf16_f32 v74, v24, v25
    ds_read_b64_tr_b16 a[180:181], v205 offset:49152
    v_mfma_f32_16x16x32_bf16 v[40:43], a[140:143], v[172:175], v[40:43]
    v_exp_f32 v26, v26
    v_mfma_f32_16x16x32_bf16 v[56:59], a[156:159], v[172:175], v[56:59]
    v_exp_f32 v27, v27
    buffer_load_dwordx4 v211, s[12:15], s75 offen offset:2048 nt lds
    v_cvt_pk_bf16_f32 v75, v26, v27
    ds_read_b128 a[140:143], v199 offset:0
    v_mfma_f32_16x16x32_bf16 a[96:99], a[184:187], v[80:83], a[96:99]
    v_mfma_f32_16x16x32_bf16 a[112:115], a[188:191], v[80:83], a[112:115]
    v_mfma_f32_16x16x32_bf16 a[100:103], a[184:187], v[84:87], a[100:103]
    ds_read_b64_tr_b16 a[182:183], v205 offset:50176
    v_mfma_f32_16x16x32_bf16 a[116:119], a[188:191], v[84:87], a[116:119]
    ds_read_b128 a[156:159], v199 offset:1024
    v_mfma_f32_16x16x32_bf16 a[104:107], a[184:187], v[88:91], a[104:107]
    v_mfma_f32_16x16x32_bf16 a[120:123], a[188:191], v[88:91], a[120:123]
    s_waitcnt lgkmcnt(7)
    buffer_load_dwordx4 v211, s[12:15], s75 offen offset:3072 nt lds
    ds_read_b64_tr_b16 a[184:185], v206 offset:49152
    v_mfma_f32_16x16x32_bf16 v[0:3], a[128:131], v[128:131], v[96:99]
    v_exp_f32 v32, v32
    v_mfma_f32_16x16x32_bf16 v[16:19], a[144:147], v[128:131], v[96:99]
    v_exp_f32 v33, v33
    v_mfma_f32_16x16x32_bf16 v[4:7], a[128:131], v[144:147], v[100:103]
    ds_read_b64_tr_b16 a[186:187], v206 offset:50176
    v_mfma_f32_16x16x32_bf16 v[20:23], a[144:147], v[144:147], v[100:103]
    v_cvt_pk_bf16_f32 v80, v32, v33
    ds_read_b64_tr_b16 a[188:189], v207 offset:49152
    v_mfma_f32_16x16x32_bf16 v[8:11], a[128:131], v[160:163], v[104:107]
    v_exp_f32 v34, v34
    v_mfma_f32_16x16x32_bf16 v[24:27], a[144:147], v[160:163], v[104:107]
    v_exp_f32 v35, v35
    s_add_u32 s34, s34, 16384
    v_cvt_pk_bf16_f32 v81, v34, v35
    ds_read_b128 a[128:131], v196 offset:8192
    v_mfma_f32_16x16x32_bf16 a[4:7], a[160:163], v[68:71], a[4:7]
    v_exp_f32 v36, v36
    v_mfma_f32_16x16x32_bf16 a[20:23], a[164:167], v[68:71], a[20:23]
    v_exp_f32 v37, v37
    v_mfma_f32_16x16x32_bf16 a[8:11], a[160:163], v[72:75], a[8:11]
    ds_read_b64_tr_b16 a[190:191], v207 offset:50176
    v_mfma_f32_16x16x32_bf16 a[24:27], a[164:167], v[72:75], a[24:27]
    v_cvt_pk_bf16_f32 v84, v36, v37
    ds_read_b128 a[144:147], v196 offset:9216
    v_exp_f32 v38, v38
    v_exp_f32 v39, v39
    v_mfma_f32_16x16x32_bf16 a[0:3], a[160:163], v[64:67], a[0:3]
    s_add_u32 s75, s75, 16384
    v_mfma_f32_16x16x32_bf16 a[16:19], a[164:167], v[64:67], a[16:19]
    v_cvt_pk_bf16_f32 v85, v38, v39
    v_mfma_f32_16x16x32_bf16 v[112:115], v[252:255], v[64:67], v[112:115]
    ds_read_b64_tr_b16 a[160:161], v200 offset:57344
    v_mfma_f32_16x16x32_bf16 v[0:3], a[132:135], v[132:135], v[0:3]
    v_exp_f32 v40, v40
    v_mfma_f32_16x16x32_bf16 v[16:19], a[148:151], v[132:135], v[16:19]
    v_exp_f32 v41, v41
    v_mfma_f32_16x16x32_bf16 v[4:7], a[132:135], v[148:151], v[4:7]
    ds_read_b64_tr_b16 a[162:163], v200 offset:58368
    v_mfma_f32_16x16x32_bf16 v[20:23], a[148:151], v[148:151], v[20:23]
    v_cvt_pk_bf16_f32 v88, v40, v41
    ds_read_b64_tr_b16 a[164:165], v201 offset:57344
    v_mfma_f32_16x16x32_bf16 v[8:11], a[132:135], v[164:167], v[8:11]
    v_exp_f32 v42, v42
    v_mfma_f32_16x16x32_bf16 v[24:27], a[148:151], v[164:167], v[24:27]
    v_exp_f32 v43, v43
    s_nop 0
    v_cvt_pk_bf16_f32 v89, v42, v43
    ds_read_b128 a[132:135], v197 offset:8192
    v_mfma_f32_16x16x32_bf16 a[40:43], a[168:171], v[72:75], a[40:43]
    v_mfma_f32_16x16x32_bf16 a[56:59], a[172:175], v[72:75], a[56:59]
    ds_read_b64_tr_b16 a[166:167], v201 offset:58368
    ds_read_b128 a[148:151], v197 offset:9216
    v_mfma_f32_16x16x32_bf16 a[32:35], a[168:171], v[64:67], a[32:35]
    v_mfma_f32_16x16x32_bf16 a[48:51], a[172:175], v[64:67], a[48:51]
    v_mfma_f32_16x16x32_bf16 a[36:39], a[168:171], v[68:71], a[36:39]
    s_waitcnt lgkmcnt(7)
    v_mfma_f32_16x16x32_bf16 a[52:55], a[172:175], v[68:71], a[52:55]
    v_mfma_f32_16x16x32_bf16 v[116:119], v[252:255], v[68:71], v[116:119]
    ds_read_b64_tr_b16 a[168:169], v202 offset:57344
    v_mfma_f32_16x16x32_bf16 v[0:3], a[136:139], v[136:139], v[0:3]
    v_exp_f32 v48, v48
    v_mfma_f32_16x16x32_bf16 v[16:19], a[152:155], v[136:139], v[16:19]
    v_exp_f32 v49, v49
    v_mfma_f32_16x16x32_bf16 v[4:7], a[136:139], v[152:155], v[4:7]
    ds_read_b64_tr_b16 a[170:171], v202 offset:58368
    v_mfma_f32_16x16x32_bf16 v[20:23], a[152:155], v[152:155], v[20:23]
    v_cvt_pk_bf16_f32 v82, v48, v49
    ds_read_b64_tr_b16 a[172:173], v203 offset:57344
    v_mfma_f32_16x16x32_bf16 v[8:11], a[136:139], v[168:171], v[8:11]
    v_exp_f32 v50, v50
    v_mfma_f32_16x16x32_bf16 v[24:27], a[152:155], v[168:171], v[24:27]
    v_exp_f32 v51, v51
    s_nop 0
    v_cvt_pk_bf16_f32 v83, v50, v51
    ds_read_b128 a[136:139], v198 offset:8192
    v_exp_f32 v52, v52
    v_exp_f32 v53, v53
    v_mfma_f32_16x16x32_bf16 a[64:67], a[176:179], v[64:67], a[64:67]
    ds_read_b64_tr_b16 a[174:175], v203 offset:58368
    v_mfma_f32_16x16x32_bf16 a[80:83], a[180:183], v[64:67], a[80:83]
    v_cvt_pk_bf16_f32 v86, v52, v53
    ds_read_b128 a[152:155], v198 offset:9216
    v_mfma_f32_16x16x32_bf16 a[68:71], a[176:179], v[68:71], a[68:71]
    v_exp_f32 v54, v54
    v_mfma_f32_16x16x32_bf16 a[84:87], a[180:183], v[68:71], a[84:87]
    v_exp_f32 v55, v55
    v_mfma_f32_16x16x32_bf16 a[72:75], a[176:179], v[72:75], a[72:75]
    v_mfma_f32_16x16x32_bf16 a[88:91], a[180:183], v[72:75], a[88:91]
    v_cvt_pk_bf16_f32 v87, v54, v55
    v_mfma_f32_16x16x32_bf16 v[120:123], v[252:255], v[72:75], v[120:123]
    ds_read_b64_tr_b16 a[176:177], v204 offset:57344
    v_mfma_f32_16x16x32_bf16 v[0:3], a[140:143], v[140:143], v[0:3]
    v_exp_f32 v56, v56
    v_mfma_f32_16x16x32_bf16 v[16:19], a[156:159], v[140:143], v[16:19]
    v_exp_f32 v57, v57
    v_mfma_f32_16x16x32_bf16 v[4:7], a[140:143], v[156:159], v[4:7]
    ds_read_b64_tr_b16 a[178:179], v204 offset:58368
    v_mfma_f32_16x16x32_bf16 v[20:23], a[156:159], v[156:159], v[20:23]
    v_cvt_pk_bf16_f32 v90, v56, v57
    ds_read_b64_tr_b16 a[180:181], v205 offset:57344
    v_mfma_f32_16x16x32_bf16 v[8:11], a[140:143], v[172:175], v[8:11]
    v_exp_f32 v58, v58
    v_mfma_f32_16x16x32_bf16 v[24:27], a[156:159], v[172:175], v[24:27]
    v_exp_f32 v59, v59
    s_nop 0
    v_cvt_pk_bf16_f32 v91, v58, v59
    ds_read_b128 a[140:143], v199 offset:8192
    v_mfma_f32_16x16x32_bf16 a[96:99], a[184:187], v[64:67], a[96:99]
    v_mfma_f32_16x16x32_bf16 a[112:115], a[188:191], v[64:67], a[112:115]
    v_mfma_f32_16x16x32_bf16 a[100:103], a[184:187], v[68:71], a[100:103]
    ds_read_b64_tr_b16 a[182:183], v205 offset:58368
    v_mfma_f32_16x16x32_bf16 a[116:119], a[188:191], v[68:71], a[116:119]
    ds_read_b128 a[156:159], v199 offset:9216
    v_mfma_f32_16x16x32_bf16 a[104:107], a[184:187], v[72:75], a[104:107]
    v_mfma_f32_16x16x32_bf16 a[120:123], a[188:191], v[72:75], a[120:123]
    s_waitcnt lgkmcnt(7)
    ds_read_b64_tr_b16 a[184:185], v206 offset:57344
    s_waitcnt vmcnt(8)
    s_barrier
    v_mfma_f32_16x16x32_bf16 v[32:35], a[128:131], v[128:131], v[96:99]
    v_exp_f32 v0, v0
    v_mfma_f32_16x16x32_bf16 v[48:51], a[144:147], v[128:131], v[96:99]
    v_exp_f32 v1, v1
    v_mfma_f32_16x16x32_bf16 v[36:39], a[128:131], v[144:147], v[100:103]
    ds_read_b64_tr_b16 a[186:187], v206 offset:58368
    s_add_u32 m0, s29, 49152
    v_mfma_f32_16x16x32_bf16 v[52:55], a[144:147], v[144:147], v[100:103]
    v_cvt_pk_bf16_f32 v64, v0, v1
    ds_read_b64_tr_b16 a[188:189], v207 offset:57344
    v_mfma_f32_16x16x32_bf16 v[40:43], a[128:131], v[160:163], v[104:107]
    v_exp_f32 v2, v2
    v_mfma_f32_16x16x32_bf16 v[56:59], a[144:147], v[160:163], v[104:107]
    v_exp_f32 v3, v3
    buffer_load_dwordx4 v208, s[8:11], s34 offen offset:0 nt lds
    v_cvt_pk_bf16_f32 v65, v2, v3
    ds_read_b128 a[128:131], v196 offset:16384
    v_mfma_f32_16x16x32_bf16 a[4:7], a[160:163], v[84:87], a[4:7]
    v_exp_f32 v4, v4
    v_mfma_f32_16x16x32_bf16 a[20:23], a[164:167], v[84:87], a[20:23]
    v_exp_f32 v5, v5
    v_mfma_f32_16x16x32_bf16 a[8:11], a[160:163], v[88:91], a[8:11]
    ds_read_b64_tr_b16 a[190:191], v207 offset:58368
    v_mfma_f32_16x16x32_bf16 a[24:27], a[164:167], v[88:91], a[24:27]
    v_cvt_pk_bf16_f32 v68, v4, v5
    ds_read_b128 a[144:147], v196 offset:17408
    v_exp_f32 v6, v6
    v_exp_f32 v7, v7
    v_mfma_f32_16x16x32_bf16 a[0:3], a[160:163], v[80:83], a[0:3]
    buffer_load_dwordx4 v208, s[8:11], s34 offen offset:1024 nt lds
    v_mfma_f32_16x16x32_bf16 a[16:19], a[164:167], v[80:83], a[16:19]
    v_cvt_pk_bf16_f32 v69, v6, v7
    v_mfma_f32_16x16x32_bf16 v[112:115], v[252:255], v[80:83], v[112:115]
    ds_read_b64_tr_b16 a[160:161], v200 offset:0
    v_mfma_f32_16x16x32_bf16 v[32:35], a[132:135], v[132:135], v[32:35]
    v_exp_f32 v8, v8
    v_mfma_f32_16x16x32_bf16 v[48:51], a[148:151], v[132:135], v[48:51]
    v_exp_f32 v9, v9
    v_mfma_f32_16x16x32_bf16 v[36:39], a[132:135], v[148:151], v[36:39]
    ds_read_b64_tr_b16 a[162:163], v200 offset:1024
    v_mfma_f32_16x16x32_bf16 v[52:55], a[148:151], v[148:151], v[52:55]
    v_cvt_pk_bf16_f32 v72, v8, v9
    ds_read_b64_tr_b16 a[164:165], v201 offset:0
    v_mfma_f32_16x16x32_bf16 v[40:43], a[132:135], v[164:167], v[40:43]
    v_exp_f32 v10, v10
    v_mfma_f32_16x16x32_bf16 v[56:59], a[148:151], v[164:167], v[56:59]
    v_exp_f32 v11, v11
    buffer_load_dwordx4 v209, s[8:11], s34 offen offset:2048 nt lds
    v_cvt_pk_bf16_f32 v73, v10, v11
    ds_read_b128 a[132:135], v197 offset:16384
    v_mfma_f32_16x16x32_bf16 a[40:43], a[168:171], v[88:91], a[40:43]
    v_mfma_f32_16x16x32_bf16 a[56:59], a[172:175], v[88:91], a[56:59]
    ds_read_b64_tr_b16 a[166:167], v201 offset:1024
    ds_read_b128 a[148:151], v197 offset:17408
    v_mfma_f32_16x16x32_bf16 a[32:35], a[168:171], v[80:83], a[32:35]
    v_mfma_f32_16x16x32_bf16 a[48:51], a[172:175], v[80:83], a[48:51]
    v_mfma_f32_16x16x32_bf16 a[36:39], a[168:171], v[84:87], a[36:39]
    s_waitcnt lgkmcnt(7)
    buffer_load_dwordx4 v209, s[8:11], s34 offen offset:3072 nt lds
    v_mfma_f32_16x16x32_bf16 a[52:55], a[172:175], v[84:87], a[52:55]
    v_mfma_f32_16x16x32_bf16 v[116:119], v[252:255], v[84:87], v[116:119]
    ds_read_b64_tr_b16 a[168:169], v202 offset:0
    v_mfma_f32_16x16x32_bf16 v[32:35], a[136:139], v[136:139], v[32:35]
    v_exp_f32 v16, v16
    v_mfma_f32_16x16x32_bf16 v[48:51], a[152:155], v[136:139], v[48:51]
    v_exp_f32 v17, v17
    v_mfma_f32_16x16x32_bf16 v[36:39], a[136:139], v[152:155], v[36:39]
    ds_read_b64_tr_b16 a[170:171], v202 offset:1024
    s_add_u32 m0, s29, 98304
    v_mfma_f32_16x16x32_bf16 v[52:55], a[152:155], v[152:155], v[52:55]
    v_cvt_pk_bf16_f32 v66, v16, v17
    ds_read_b64_tr_b16 a[172:173], v203 offset:0
    v_mfma_f32_16x16x32_bf16 v[40:43], a[136:139], v[168:171], v[40:43]
    v_exp_f32 v18, v18
    v_mfma_f32_16x16x32_bf16 v[56:59], a[152:155], v[168:171], v[56:59]
    v_exp_f32 v19, v19
    buffer_load_dwordx4 v210, s[12:15], s75 offen offset:0 nt lds
    v_cvt_pk_bf16_f32 v67, v18, v19
    ds_read_b128 a[136:139], v198 offset:16384
    v_exp_f32 v20, v20
    v_exp_f32 v21, v21
    v_mfma_f32_16x16x32_bf16 a[64:67], a[176:179], v[80:83], a[64:67]
    ds_read_b64_tr_b16 a[174:175], v203 offset:1024
    v_mfma_f32_16x16x32_bf16 a[80:83], a[180:183], v[80:83], a[80:83]
    v_cvt_pk_bf16_f32 v70, v20, v21
    ds_read_b128 a[152:155], v198 offset:17408
    v_mfma_f32_16x16x32_bf16 a[68:71], a[176:179], v[84:87], a[68:71]
    v_exp_f32 v22, v22
    v_mfma_f32_16x16x32_bf16 a[84:87], a[180:183], v[84:87], a[84:87]
    v_exp_f32 v23, v23
    v_mfma_f32_16x16x32_bf16 a[72:75], a[176:179], v[88:91], a[72:75]
    buffer_load_dwordx4 v210, s[12:15], s75 offen offset:1024 nt lds
    v_mfma_f32_16x16x32_bf16 a[88:91], a[180:183], v[88:91], a[88:91]
    v_cvt_pk_bf16_f32 v71, v22, v23
    v_mfma_f32_16x16x32_bf16 v[120:123], v[252:255], v[88:91], v[120:123]
    ds_read_b64_tr_b16 a[176:177], v204 offset:0
    v_mfma_f32_16x16x32_bf16 v[32:35], a[140:143], v[140:143], v[32:35]
    v_exp_f32 v24, v24
    v_mfma_f32_16x16x32_bf16 v[48:51], a[156:159], v[140:143], v[48:51]
    v_exp_f32 v25, v25
    v_mfma_f32_16x16x32_bf16 v[36:39], a[140:143], v[156:159], v[36:39]
    ds_read_b64_tr_b16 a[178:179], v204 offset:1024
    v_mfma_f32_16x16x32_bf16 v[52:55], a[156:159], v[156:159], v[52:55]
    v_cvt_pk_bf16_f32 v74, v24, v25
    ds_read_b64_tr_b16 a[180:181], v205 offset:0
    v_mfma_f32_16x16x32_bf16 v[40:43], a[140:143], v[172:175], v[40:43]
    v_exp_f32 v26, v26
    v_mfma_f32_16x16x32_bf16 v[56:59], a[156:159], v[172:175], v[56:59]
    v_exp_f32 v27, v27
    buffer_load_dwordx4 v211, s[12:15], s75 offen offset:2048 nt lds
    v_cvt_pk_bf16_f32 v75, v26, v27
    ds_read_b128 a[140:143], v199 offset:16384
    v_mfma_f32_16x16x32_bf16 a[96:99], a[184:187], v[80:83], a[96:99]
    v_mfma_f32_16x16x32_bf16 a[112:115], a[188:191], v[80:83], a[112:115]
    v_mfma_f32_16x16x32_bf16 a[100:103], a[184:187], v[84:87], a[100:103]
    ds_read_b64_tr_b16 a[182:183], v205 offset:1024
    v_mfma_f32_16x16x32_bf16 a[116:119], a[188:191], v[84:87], a[116:119]
    ds_read_b128 a[156:159], v199 offset:17408
    v_mfma_f32_16x16x32_bf16 a[104:107], a[184:187], v[88:91], a[104:107]
    v_mfma_f32_16x16x32_bf16 a[120:123], a[188:191], v[88:91], a[120:123]
    s_waitcnt lgkmcnt(7)
    buffer_load_dwordx4 v211, s[12:15], s75 offen offset:3072 nt lds
    ds_read_b64_tr_b16 a[184:185], v206 offset:0
    v_mfma_f32_16x16x32_bf16 v[0:3], a[128:131], v[128:131], v[96:99]
    v_exp_f32 v32, v32
    v_mfma_f32_16x16x32_bf16 v[16:19], a[144:147], v[128:131], v[96:99]
    v_exp_f32 v33, v33
    v_mfma_f32_16x16x32_bf16 v[4:7], a[128:131], v[144:147], v[100:103]
    ds_read_b64_tr_b16 a[186:187], v206 offset:1024
    v_mfma_f32_16x16x32_bf16 v[20:23], a[144:147], v[144:147], v[100:103]
    v_cvt_pk_bf16_f32 v80, v32, v33
    ds_read_b64_tr_b16 a[188:189], v207 offset:0
    v_mfma_f32_16x16x32_bf16 v[8:11], a[128:131], v[160:163], v[104:107]
    v_exp_f32 v34, v34
    v_mfma_f32_16x16x32_bf16 v[24:27], a[144:147], v[160:163], v[104:107]
    v_exp_f32 v35, v35
    s_add_u32 s34, s34, 16384
    v_cvt_pk_bf16_f32 v81, v34, v35
    ds_read_b128 a[128:131], v196 offset:24576
    v_mfma_f32_16x16x32_bf16 a[4:7], a[160:163], v[68:71], a[4:7]
    v_exp_f32 v36, v36
    v_mfma_f32_16x16x32_bf16 a[20:23], a[164:167], v[68:71], a[20:23]
    v_exp_f32 v37, v37
    v_mfma_f32_16x16x32_bf16 a[8:11], a[160:163], v[72:75], a[8:11]
    ds_read_b64_tr_b16 a[190:191], v207 offset:1024
    v_mfma_f32_16x16x32_bf16 a[24:27], a[164:167], v[72:75], a[24:27]
    v_cvt_pk_bf16_f32 v84, v36, v37
    ds_read_b128 a[144:147], v196 offset:25600
    v_exp_f32 v38, v38
    v_exp_f32 v39, v39
    v_mfma_f32_16x16x32_bf16 a[0:3], a[160:163], v[64:67], a[0:3]
    s_add_u32 s75, s75, 16384
    v_mfma_f32_16x16x32_bf16 a[16:19], a[164:167], v[64:67], a[16:19]
    v_cvt_pk_bf16_f32 v85, v38, v39
    v_mfma_f32_16x16x32_bf16 v[112:115], v[252:255], v[64:67], v[112:115]
    ds_read_b64_tr_b16 a[160:161], v200 offset:8192
    v_mfma_f32_16x16x32_bf16 v[0:3], a[132:135], v[132:135], v[0:3]
    v_exp_f32 v40, v40
    v_mfma_f32_16x16x32_bf16 v[16:19], a[148:151], v[132:135], v[16:19]
    v_exp_f32 v41, v41
    v_mfma_f32_16x16x32_bf16 v[4:7], a[132:135], v[148:151], v[4:7]
    ds_read_b64_tr_b16 a[162:163], v200 offset:9216
    v_mfma_f32_16x16x32_bf16 v[20:23], a[148:151], v[148:151], v[20:23]
    v_cvt_pk_bf16_f32 v88, v40, v41
    ds_read_b64_tr_b16 a[164:165], v201 offset:8192
    v_mfma_f32_16x16x32_bf16 v[8:11], a[132:135], v[164:167], v[8:11]
    v_exp_f32 v42, v42
    v_mfma_f32_16x16x32_bf16 v[24:27], a[148:151], v[164:167], v[24:27]
    v_exp_f32 v43, v43
    s_nop 0
    v_cvt_pk_bf16_f32 v89, v42, v43
    ds_read_b128 a[132:135], v197 offset:24576
    v_mfma_f32_16x16x32_bf16 a[40:43], a[168:171], v[72:75], a[40:43]
    v_mfma_f32_16x16x32_bf16 a[56:59], a[172:175], v[72:75], a[56:59]
    ds_read_b64_tr_b16 a[166:167], v201 offset:9216
    ds_read_b128 a[148:151], v197 offset:25600
    v_mfma_f32_16x16x32_bf16 a[32:35], a[168:171], v[64:67], a[32:35]
    v_mfma_f32_16x16x32_bf16 a[48:51], a[172:175], v[64:67], a[48:51]
    v_mfma_f32_16x16x32_bf16 a[36:39], a[168:171], v[68:71], a[36:39]
    s_waitcnt lgkmcnt(7)
    v_mfma_f32_16x16x32_bf16 a[52:55], a[172:175], v[68:71], a[52:55]
    v_mfma_f32_16x16x32_bf16 v[116:119], v[252:255], v[68:71], v[116:119]
    ds_read_b64_tr_b16 a[168:169], v202 offset:8192
    v_mfma_f32_16x16x32_bf16 v[0:3], a[136:139], v[136:139], v[0:3]
    v_exp_f32 v48, v48
    v_mfma_f32_16x16x32_bf16 v[16:19], a[152:155], v[136:139], v[16:19]
    v_exp_f32 v49, v49
    v_mfma_f32_16x16x32_bf16 v[4:7], a[136:139], v[152:155], v[4:7]
    ds_read_b64_tr_b16 a[170:171], v202 offset:9216
    v_mfma_f32_16x16x32_bf16 v[20:23], a[152:155], v[152:155], v[20:23]
    v_cvt_pk_bf16_f32 v82, v48, v49
    ds_read_b64_tr_b16 a[172:173], v203 offset:8192
    v_mfma_f32_16x16x32_bf16 v[8:11], a[136:139], v[168:171], v[8:11]
    v_exp_f32 v50, v50
    v_mfma_f32_16x16x32_bf16 v[24:27], a[152:155], v[168:171], v[24:27]
    v_exp_f32 v51, v51
    s_nop 0
    v_cvt_pk_bf16_f32 v83, v50, v51
    ds_read_b128 a[136:139], v198 offset:24576
    v_exp_f32 v52, v52
    v_exp_f32 v53, v53
    v_mfma_f32_16x16x32_bf16 a[64:67], a[176:179], v[64:67], a[64:67]
    ds_read_b64_tr_b16 a[174:175], v203 offset:9216
    v_mfma_f32_16x16x32_bf16 a[80:83], a[180:183], v[64:67], a[80:83]
    v_cvt_pk_bf16_f32 v86, v52, v53
    ds_read_b128 a[152:155], v198 offset:25600
    v_mfma_f32_16x16x32_bf16 a[68:71], a[176:179], v[68:71], a[68:71]
    v_exp_f32 v54, v54
    v_mfma_f32_16x16x32_bf16 a[84:87], a[180:183], v[68:71], a[84:87]
    v_exp_f32 v55, v55
    v_mfma_f32_16x16x32_bf16 a[72:75], a[176:179], v[72:75], a[72:75]
    v_mfma_f32_16x16x32_bf16 a[88:91], a[180:183], v[72:75], a[88:91]
    v_cvt_pk_bf16_f32 v87, v54, v55
    v_mfma_f32_16x16x32_bf16 v[120:123], v[252:255], v[72:75], v[120:123]
    ds_read_b64_tr_b16 a[176:177], v204 offset:8192
    v_mfma_f32_16x16x32_bf16 v[0:3], a[140:143], v[140:143], v[0:3]
    v_exp_f32 v56, v56
    v_mfma_f32_16x16x32_bf16 v[16:19], a[156:159], v[140:143], v[16:19]
    v_exp_f32 v57, v57
    v_mfma_f32_16x16x32_bf16 v[4:7], a[140:143], v[156:159], v[4:7]
    ds_read_b64_tr_b16 a[178:179], v204 offset:9216
    v_mfma_f32_16x16x32_bf16 v[20:23], a[156:159], v[156:159], v[20:23]
    v_cvt_pk_bf16_f32 v90, v56, v57
    ds_read_b64_tr_b16 a[180:181], v205 offset:8192
    v_mfma_f32_16x16x32_bf16 v[8:11], a[140:143], v[172:175], v[8:11]
    v_exp_f32 v58, v58
    v_mfma_f32_16x16x32_bf16 v[24:27], a[156:159], v[172:175], v[24:27]
    v_exp_f32 v59, v59
    s_nop 0
    v_cvt_pk_bf16_f32 v91, v58, v59
    ds_read_b128 a[140:143], v199 offset:24576
    v_mfma_f32_16x16x32_bf16 a[96:99], a[184:187], v[64:67], a[96:99]
    v_mfma_f32_16x16x32_bf16 a[112:115], a[188:191], v[64:67], a[112:115]
    v_mfma_f32_16x16x32_bf16 a[100:103], a[184:187], v[68:71], a[100:103]
    ds_read_b64_tr_b16 a[182:183], v205 offset:9216
    v_mfma_f32_16x16x32_bf16 a[116:119], a[188:191], v[68:71], a[116:119]
    ds_read_b128 a[156:159], v199 offset:25600
    v_mfma_f32_16x16x32_bf16 a[104:107], a[184:187], v[72:75], a[104:107]
    v_mfma_f32_16x16x32_bf16 a[120:123], a[188:191], v[72:75], a[120:123]
    s_waitcnt lgkmcnt(7)
    ds_read_b64_tr_b16 a[184:185], v206 offset:8192
    s_sub_u32 s44, s44, 1
    s_cmp_lg_u32 s44, 0
    s_waitcnt vmcnt(8)
    s_barrier
    s_cbranch_scc1 L_k1_aloop_w3
    v_mfma_f32_16x16x32_bf16 v[32:35], a[128:131], v[128:131], v[96:99]
    v_exp_f32 v0, v0
    v_mfma_f32_16x16x32_bf16 v[48:51], a[144:147], v[128:131], v[96:99]
    v_exp_f32 v1, v1
    v_mfma_f32_16x16x32_bf16 v[36:39], a[128:131], v[144:147], v[100:103]
    ds_read_b64_tr_b16 a[186:187], v206 offset:9216
    s_add_u32 m0, s29, 114688
    v_mfma_f32_16x16x32_bf16 v[52:55], a[144:147], v[144:147], v[100:103]
    v_cvt_pk_bf16_f32 v64, v0, v1
    ds_read_b64_tr_b16 a[188:189], v207 offset:8192
    v_mfma_f32_16x16x32_bf16 v[40:43], a[128:131], v[160:163], v[104:107]
    v_exp_f32 v2, v2
    v_mfma_f32_16x16x32_bf16 v[56:59], a[144:147], v[160:163], v[104:107]
    v_exp_f32 v3, v3
    buffer_load_dwordx4 v210, s[12:15], s75 offen offset:0 nt lds
    v_cvt_pk_bf16_f32 v65, v2, v3
    ds_read_b128 a[128:131], v196 offset:32768
    v_mfma_f32_16x16x32_bf16 a[4:7], a[160:163], v[84:87], a[4:7]
    v_exp_f32 v4, v4
    v_mfma_f32_16x16x32_bf16 a[20:23], a[164:167], v[84:87], a[20:23]
    v_exp_f32 v5, v5
    v_mfma_f32_16x16x32_bf16 a[8:11], a[160:163], v[88:91], a[8:11]
    ds_read_b64_tr_b16 a[190:191], v207 offset:9216
    v_mfma_f32_16x16x32_bf16 a[24:27], a[164:167], v[88:91], a[24:27]
    v_cvt_pk_bf16_f32 v68, v4, v5
    ds_read_b128 a[144:147], v196 offset:33792
    v_exp_f32 v6, v6
    v_exp_f32 v7, v7
    v_mfma_f32_16x16x32_bf16 a[0:3], a[160:163], v[80:83], a[0:3]
    buffer_load_dwordx4 v210, s[12:15], s75 offen offset:1024 nt lds
    v_mfma_f32_16x16x32_bf16 a[16:19], a[164:167], v[80:83], a[16:19]
    v_cvt_pk_bf16_f32 v69, v6, v7
    v_mfma_f32_16x16x32_bf16 v[112:115], v[252:255], v[80:83], v[112:115]
    ds_read_b64_tr_b16 a[160:161], v200 offset:16384
    v_mfma_f32_16x16x32_bf16 v[32:35], a[132:135], v[132:135], v[32:35]
    v_exp_f32 v8, v8
    v_mfma_f32_16x16x32_bf16 v[48:51], a[148:151], v[132:135], v[48:51]
    v_exp_f32 v9, v9
    v_mfma_f32_16x16x32_bf16 v[36:39], a[132:135], v[148:151], v[36:39]
    ds_read_b64_tr_b16 a[162:163], v200 offset:17408
    v_mfma_f32_16x16x32_bf16 v[52:55], a[148:151], v[148:151], v[52:55]
    v_cvt_pk_bf16_f32 v72, v8, v9
    ds_read_b64_tr_b16 a[164:165], v201 offset:16384
    v_mfma_f32_16x16x32_bf16 v[40:43], a[132:135], v[164:167], v[40:43]
    v_exp_f32 v10, v10
    v_mfma_f32_16x16x32_bf16 v[56:59], a[148:151], v[164:167], v[56:59]
    v_exp_f32 v11, v11
    buffer_load_dwordx4 v211, s[12:15], s75 offen offset:2048 nt lds
    v_cvt_pk_bf16_f32 v73, v10, v11
    ds_read_b128 a[132:135], v197 offset:32768
    v_mfma_f32_16x16x32_bf16 a[40:43], a[168:171], v[88:91], a[40:43]
    v_mfma_f32_16x16x32_bf16 a[56:59], a[172:175], v[88:91], a[56:59]
    ds_read_b64_tr_b16 a[166:167], v201 offset:17408
    ds_read_b128 a[148:151], v197 offset:33792
    v_mfma_f32_16x16x32_bf16 a[32:35], a[168:171], v[80:83], a[32:35]
    v_mfma_f32_16x16x32_bf16 a[48:51], a[172:175], v[80:83], a[48:51]
    v_mfma_f32_16x16x32_bf16 a[36:39], a[168:171], v[84:87], a[36:39]
    s_waitcnt lgkmcnt(7)
    buffer_load_dwordx4 v211, s[12:15], s75 offen offset:3072 nt lds
    v_mfma_f32_16x16x32_bf16 a[52:55], a[172:175], v[84:87], a[52:55]
    v_mfma_f32_16x16x32_bf16 v[116:119], v[252:255], v[84:87], v[116:119]
    ds_read_b64_tr_b16 a[168:169], v202 offset:16384
    v_mfma_f32_16x16x32_bf16 v[32:35], a[136:139], v[136:139], v[32:35]
    v_exp_f32 v16, v16
    v_mfma_f32_16x16x32_bf16 v[48:51], a[152:155], v[136:139], v[48:51]
    v_exp_f32 v17, v17
    v_mfma_f32_16x16x32_bf16 v[36:39], a[136:139], v[152:155], v[36:39]
    ds_read_b64_tr_b16 a[170:171], v202 offset:17408
    s_add_u32 m0, s30, 131072
    v_mfma_f32_16x16x32_bf16 v[52:55], a[152:155], v[152:155], v[52:55]
    v_cvt_pk_bf16_f32 v66, v16, v17
    ds_read_b64_tr_b16 a[172:173], v203 offset:16384
    v_mfma_f32_16x16x32_bf16 v[40:43], a[136:139], v[168:171], v[40:43]
    v_exp_f32 v18, v18
    v_mfma_f32_16x16x32_bf16 v[56:59], a[152:155], v[168:171], v[56:59]
    v_exp_f32 v19, v19
    buffer_load_dwordx4 v216, s[16:19], s36 offen offset:0 lds
    v_cvt_pk_bf16_f32 v67, v18, v19
    ds_read_b128 a[136:139], v198 offset:32768
    v_exp_f32 v20, v20
    v_exp_f32 v21, v21
    v_mfma_f32_16x16x32_bf16 a[64:67], a[176:179], v[80:83], a[64:67]
    ds_read_b64_tr_b16 a[174:175], v203 offset:17408
    v_mfma_f32_16x16x32_bf16 a[80:83], a[180:183], v[80:83], a[80:83]
    v_cvt_pk_bf16_f32 v70, v20, v21
    ds_read_b128 a[152:155], v198 offset:33792
    v_mfma_f32_16x16x32_bf16 a[68:71], a[176:179], v[84:87], a[68:71]
    v_exp_f32 v22, v22
    v_mfma_f32_16x16x32_bf16 a[84:87], a[180:183], v[84:87], a[84:87]
    v_exp_f32 v23, v23
    v_mfma_f32_16x16x32_bf16 a[72:75], a[176:179], v[88:91], a[72:75]
    buffer_load_dwordx4 v217, s[16:19], s36 offen offset:1024 lds
    v_mfma_f32_16x16x32_bf16 a[88:91], a[180:183], v[88:91], a[88:91]
    v_cvt_pk_bf16_f32 v71, v22, v23
    v_mfma_f32_16x16x32_bf16 v[120:123], v[252:255], v[88:91], v[120:123]
    ds_read_b64_tr_b16 a[176:177], v204 offset:16384
    v_mfma_f32_16x16x32_bf16 v[32:35], a[140:143], v[140:143], v[32:35]
    v_exp_f32 v24, v24
    v_mfma_f32_16x16x32_bf16 v[48:51], a[156:159], v[140:143], v[48:51]
    v_exp_f32 v25, v25
    v_mfma_f32_16x16x32_bf16 v[36:39], a[140:143], v[156:159], v[36:39]
    ds_read_b64_tr_b16 a[178:179], v204 offset:17408
    v_mfma_f32_16x16x32_bf16 v[52:55], a[156:159], v[156:159], v[52:55]
    v_cvt_pk_bf16_f32 v74, v24, v25
    ds_read_b64_tr_b16 a[180:181], v205 offset:16384
    v_mfma_f32_16x16x32_bf16 v[40:43], a[140:143], v[172:175], v[40:43]
    v_exp_f32 v26, v26
    v_mfma_f32_16x16x32_bf16 v[56:59], a[156:159], v[172:175], v[56:59]
    v_exp_f32 v27, v27
    buffer_load_dwordx4 v218, s[16:19], s36 offen offset:2048 lds
    v_cvt_pk_bf16_f32 v75, v26, v27
    ds_read_b128 a[140:143], v199 offset:32768
    v_mfma_f32_16x16x32_bf16 a[96:99], a[184:187], v[80:83], a[96:99]
    v_mfma_f32_16x16x32_bf16 a[112:115], a[188:191], v[80:83], a[112:115]
    v_mfma_f32_16x16x32_bf16 a[100:103], a[184:187], v[84:87], a[100:103]
    ds_read_b64_tr_b16 a[182:183], v205 offset:17408
    v_mfma_f32_16x16x32_bf16 a[116:119], a[188:191], v[84:87], a[116:119]
    ds_read_b128 a[156:159], v199 offset:33792
    v_mfma_f32_16x16x32_bf16 a[104:107], a[184:187], v[88:91], a[104:107]
    v_mfma_f32_16x16x32_bf16 a[120:123], a[188:191], v[88:91], a[120:123]
    s_waitcnt lgkmcnt(7)
    buffer_load_dwordx4 v219, s[16:19], s36 offen offset:3072 lds
    ds_read_b64_tr_b16 a[184:185], v206 offset:16384
    v_mfma_f32_16x16x32_bf16 v[0:3], a[128:131], v[128:131], v[96:99]
    v_exp_f32 v32, v32
    v_mfma_f32_16x16x32_bf16 v[16:19], a[144:147], v[128:131], v[96:99]
    v_exp_f32 v33, v33
    v_mfma_f32_16x16x32_bf16 v[4:7], a[128:131], v[144:147], v[100:103]
    ds_read_b64_tr_b16 a[186:187], v206 offset:17408
    s_add_u32 m0, m0, s67
    v_mfma_f32_16x16x32_bf16 v[20:23], a[144:147], v[144:147], v[100:103]
    v_cvt_pk_bf16_f32 v80, v32, v33
    ds_read_b64_tr_b16 a[188:189], v207 offset:16384
    v_mfma_f32_16x16x32_bf16 v[8:11], a[128:131], v[160:163], v[104:107]
    v_exp_f32 v34, v34
    v_mfma_f32_16x16x32_bf16 v[24:27], a[144:147], v[160:163], v[104:107]
    v_exp_f32 v35, v35
    buffer_load_dwordx4 v216, s[16:19], s37 offen offset:0 lds
    v_cvt_pk_bf16_f32 v81, v34, v35
    ds_read_b128 a[128:131], v196 offset:40960
    v_mfma_f32_16x16x32_bf16 a[4:7], a[160:163], v[68:71], a[4:7]
    v_exp_f32 v36, v36
    v_mfma_f32_16x16x32_bf16 a[20:23], a[164:167], v[68:71], a[20:23]
    v_exp_f32 v37, v37
    v_mfma_f32_16x16x32_bf16 a[8:11], a[160:163], v[72:75], a[8:11]
    ds_read_b64_tr_b16 a[190:191], v207 offset:17408
    v_mfma_f32_16x16x32_bf16 a[24:27], a[164:167], v[72:75], a[24:27]
    v_cvt_pk_bf16_f32 v84, v36, v37
    ds_read_b128 a[144:147], v196 offset:41984
    v_exp_f32 v38, v38
    v_exp_f32 v39, v39
    v_mfma_f32_16x16x32_bf16 a[0:3], a[160:163], v[64:67], a[0:3]
    buffer_load_dwordx4 v217, s[16:19], s37 offen offset:1024 lds
    v_mfma_f32_16x16x32_bf16 a[16:19], a[164:167], v[64:67], a[16:19]
    v_cvt_pk_bf16_f32 v85, v38, v39
    v_mfma_f32_16x16x32_bf16 v[112:115], v[252:255], v[64:67], v[112:115]
    ds_read_b64_tr_b16 a[160:161], v200 offset:24576
    v_mfma_f32_16x16x32_bf16 v[0:3], a[132:135], v[132:135], v[0:3]
    v_exp_f32 v40, v40
    v_mfma_f32_16x16x32_bf16 v[16:19], a[148:151], v[132:135], v[16:19]
    v_exp_f32 v41, v41
    v_mfma_f32_16x16x32_bf16 v[4:7], a[132:135], v[148:151], v[4:7]
    ds_read_b64_tr_b16 a[162:163], v200 offset:25600
    v_mfma_f32_16x16x32_bf16 v[20:23], a[148:151], v[148:151], v[20:23]
    v_cvt_pk_bf16_f32 v88, v40, v41
    ds_read_b64_tr_b16 a[164:165], v201 offset:24576
    v_mfma_f32_16x16x32_bf16 v[8:11], a[132:135], v[164:167], v[8:11]
    v_exp_f32 v42, v42
    v_mfma_f32_16x16x32_bf16 v[24:27], a[148:151], v[164:167], v[24:27]
    v_exp_f32 v43, v43
    buffer_load_dwordx4 v218, s[16:19], s37 offen offset:2048 lds
    v_cvt_pk_bf16_f32 v89, v42, v43
    ds_read_b128 a[132:135], v197 offset:40960
    v_mfma_f32_16x16x32_bf16 a[40:43], a[168:171], v[72:75], a[40:43]
    v_mfma_f32_16x16x32_bf16 a[56:59], a[172:175], v[72:75], a[56:59]
    ds_read_b64_tr_b16 a[166:167], v201 offset:25600
    ds_read_b128 a[148:151], v197 offset:41984
    v_mfma_f32_16x16x32_bf16 a[32:35], a[168:171], v[64:67], a[32:35]
    v_mfma_f32_16x16x32_bf16 a[48:51], a[172:175], v[64:67], a[48:51]
    v_mfma_f32_16x16x32_bf16 a[36:39], a[168:171], v[68:71], a[36:39]
    s_waitcnt lgkmcnt(7)
    buffer_load_dwordx4 v219, s[16:19], s37 offen offset:3072 lds
    v_mfma_f32_16x16x32_bf16 a[52:55], a[172:175], v[68:71], a[52:55]
    v_mfma_f32_16x16x32_bf16 v[116:119], v[252:255], v[68:71], v[116:119]
    ds_read_b64_tr_b16 a[168:169], v202 offset:24576
    v_mfma_f32_16x16x32_bf16 v[0:3], a[136:139], v[136:139], v[0:3]
    v_exp_f32 v48, v48
    v_mfma_f32_16x16x32_bf16 v[16:19], a[152:155], v[136:139], v[16:19]
    v_exp_f32 v49, v49
    v_mfma_f32_16x16x32_bf16 v[4:7], a[136:139], v[152:155], v[4:7]
    ds_read_b64_tr_b16 a[170:171], v202 offset:25600
    v_mfma_f32_16x16x32_bf16 v[20:23], a[152:155], v[152:155], v[20:23]
    v_cvt_pk_bf16_f32 v82, v48, v49
    ds_read_b64_tr_b16 a[172:173], v203 offset:24576
    v_mfma_f32_16x16x32_bf16 v[8:11], a[136:139], v[168:171], v[8:11]
    v_exp_f32 v50, v50
    v_mfma_f32_16x16x32_bf16 v[24:27], a[152:155], v[168:171], v[24:27]
    v_exp_f32 v51, v51
    s_add_u32 s36, s36, 128
    s_bitset0_b32 s36, 11
    v_cvt_pk_bf16_f32 v83, v50, v51
    ds_read_b128 a[136:139], v198 offset:40960
    v_exp_f32 v52, v52
    v_exp_f32 v53, v53
    v_mfma_f32_16x16x32_bf16 a[64:67], a[176:179], v[64:67], a[64:67]
    ds_read_b64_tr_b16 a[174:175], v203 offset:25600
    v_mfma_f32_16x16x32_bf16 a[80:83], a[180:183], v[64:67], a[80:83]
    v_cvt_pk_bf16_f32 v86, v52, v53
    ds_read_b128 a[152:155], v198 offset:41984
    v_mfma_f32_16x16x32_bf16 a[68:71], a[176:179], v[68:71], a[68:71]
    v_exp_f32 v54, v54
    v_mfma_f32_16x16x32_bf16 a[84:87], a[180:183], v[68:71], a[84:87]
    v_exp_f32 v55, v55
    v_mfma_f32_16x16x32_bf16 a[72:75], a[176:179], v[72:75], a[72:75]
    s_add_u32 s37, s37, 128
    s_bitset0_b32 s37, 11
    v_mfma_f32_16x16x32_bf16 a[88:91], a[180:183], v[72:75], a[88:91]
    v_cvt_pk_bf16_f32 v87, v54, v55
    v_mfma_f32_16x16x32_bf16 v[120:123], v[252:255], v[72:75], v[120:123]
    ds_read_b64_tr_b16 a[176:177], v204 offset:24576
    v_mfma_f32_16x16x32_bf16 v[0:3], a[140:143], v[140:143], v[0:3]
    v_exp_f32 v56, v56
    v_mfma_f32_16x16x32_bf16 v[16:19], a[156:159], v[140:143], v[16:19]
    v_exp_f32 v57, v57
    v_mfma_f32_16x16x32_bf16 v[4:7], a[140:143], v[156:159], v[4:7]
    ds_read_b64_tr_b16 a[178:179], v204 offset:25600
    v_mfma_f32_16x16x32_bf16 v[20:23], a[156:159], v[156:159], v[20:23]
    v_cvt_pk_bf16_f32 v90, v56, v57
    ds_read_b64_tr_b16 a[180:181], v205 offset:24576
    v_mfma_f32_16x16x32_bf16 v[8:11], a[140:143], v[172:175], v[8:11]
    v_exp_f32 v58, v58
    v_mfma_f32_16x16x32_bf16 v[24:27], a[156:159], v[172:175], v[24:27]
    v_exp_f32 v59, v59
    s_nop 0
    v_cvt_pk_bf16_f32 v91, v58, v59
    ds_read_b128 a[140:143], v199 offset:40960
    v_mfma_f32_16x16x32_bf16 a[96:99], a[184:187], v[64:67], a[96:99]
    v_mfma_f32_16x16x32_bf16 a[112:115], a[188:191], v[64:67], a[112:115]
    v_mfma_f32_16x16x32_bf16 a[100:103], a[184:187], v[68:71], a[100:103]
    ds_read_b64_tr_b16 a[182:183], v205 offset:25600
    v_mfma_f32_16x16x32_bf16 a[116:119], a[188:191], v[68:71], a[116:119]
    ds_read_b128 a[156:159], v199 offset:41984
    v_mfma_f32_16x16x32_bf16 a[104:107], a[184:187], v[72:75], a[104:107]
    v_mfma_f32_16x16x32_bf16 a[120:123], a[188:191], v[72:75], a[120:123]
    s_waitcnt lgkmcnt(7)
    ds_read_b64_tr_b16 a[184:185], v206 offset:24576
    s_waitcnt vmcnt(12)
    s_barrier
    v_mfma_f32_16x16x32_bf16 v[32:35], a[128:131], v[128:131], v[96:99]
    v_exp_f32 v0, v0
    v_mfma_f32_16x16x32_bf16 v[48:51], a[144:147], v[128:131], v[96:99]
    v_exp_f32 v1, v1
    buffer_load_dword v192, v233, s[4:7], s69 offen
    v_mfma_f32_16x16x32_bf16 v[36:39], a[128:131], v[144:147], v[100:103]
    ds_read_b64_tr_b16 a[186:187], v206 offset:25600
    s_add_u32 m0, s29, 65536
    v_mfma_f32_16x16x32_bf16 v[52:55], a[144:147], v[144:147], v[100:103]
    v_cvt_pk_bf16_f32 v64, v0, v1
    ds_read_b64_tr_b16 a[188:189], v207 offset:24576
    v_mov_b32 v246, 0
    v_mfma_f32_16x16x32_bf16 v[40:43], a[128:131], v[160:163], v[104:107]
    v_exp_f32 v2, v2
    global_load_dword v244, v195, s[62:63] sc1
    v_mbcnt_lo_u32_b32 v250, -1, 0
    v_mfma_f32_16x16x32_bf16 v[56:59], a[144:147], v[160:163], v[104:107]
    v_exp_f32 v3, v3
    buffer_load_dwordx4 v212, s[20:23], s35 offen offset:0 lds
    v_cvt_pk_bf16_f32 v65, v2, v3
    ds_read_b128 a[128:131], v196 offset:49152
    v_mfma_f32_16x16x32_bf16 a[4:7], a[160:163], v[84:87], a[4:7]
    v_exp_f32 v4, v4
    v_mfma_f32_16x16x32_bf16 a[20:23], a[164:167], v[84:87], a[20:23]
    v_exp_f32 v5, v5
    v_mfma_f32_16x16x32_bf16 a[8:11], a[160:163], v[88:91], a[8:11]
    ds_read_b64_tr_b16 a[190:191], v207 offset:25600
    v_mfma_f32_16x16x32_bf16 a[24:27], a[164:167], v[88:91], a[24:27]
    v_cvt_pk_bf16_f32 v68, v4, v5
    ds_read_b128 a[144:147], v196 offset:50176
    v_mov_b32 v247, 0
    v_exp_f32 v6, v6
    v_mbcnt_hi_u32_b32 v250, -1, v250
    v_exp_f32 v7, v7
    v_mfma_f32_16x16x32_bf16 a[0:3], a[160:163], v[80:83], a[0:3]
    buffer_load_dwordx4 v213, s[20:23], s35 offen offset:1024 lds
    v_mfma_f32_16x16x32_bf16 a[16:19], a[164:167], v[80:83], a[16:19]
    v_cvt_pk_bf16_f32 v69, v6, v7
    v_mfma_f32_16x16x32_bf16 v[112:115], v[252:255], v[80:83], v[112:115]
    ds_read_b64_tr_b16 a[160:161], v200 offset:32768
    v_mfma_f32_16x16x32_bf16 v[32:35], a[132:135], v[132:135], v[32:35]
    v_exp_f32 v8, v8
    v_mfma_f32_16x16x32_bf16 v[48:51], a[148:151], v[132:135], v[48:51]
    v_exp_f32 v9, v9
    v_mfma_f32_16x16x32_bf16 v[36:39], a[132:135], v[148:151], v[36:39]
    ds_read_b64_tr_b16 a[162:163], v200 offset:33792
    v_mfma_f32_16x16x32_bf16 v[52:55], a[148:151], v[148:151], v[52:55]
    v_cvt_pk_bf16_f32 v72, v8, v9
    ds_read_b64_tr_b16 a[164:165], v201 offset:32768
    v_mov_b32 v248, 0
    v_mfma_f32_16x16x32_bf16 v[40:43], a[132:135], v[164:167], v[40:43]
    v_exp_f32 v10, v10
    v_lshlrev_b32 v250, 4, v250
    v_mfma_f32_16x16x32_bf16 v[56:59], a[148:151], v[164:167], v[56:59]
    v_exp_f32 v11, v11
    buffer_load_dwordx4 v214, s[20:23], s35 offen offset:2048 lds
    v_cvt_pk_bf16_f32 v73, v10, v11
    ds_read_b128 a[132:135], v197 offset:49152
    v_mfma_f32_16x16x32_bf16 a[40:43], a[168:171], v[88:91], a[40:43]
    v_mfma_f32_16x16x32_bf16 a[56:59], a[172:175], v[88:91], a[56:59]
    ds_read_b64_tr_b16 a[166:167], v201 offset:33792
    ds_read_b128 a[148:151], v197 offset:50176
    v_mov_b32 v249, 0
    v_mfma_f32_16x16x32_bf16 a[32:35], a[168:171], v[80:83], a[32:35]
    v_mfma_f32_16x16x32_bf16 a[48:51], a[172:175], v[80:83], a[48:51]
    v_mfma_f32_16x16x32_bf16 a[36:39], a[168:171], v[84:87], a[36:39]
    s_waitcnt lgkmcnt(7)
    buffer_load_dwordx4 v215, s[20:23], s35 offen offset:3072 lds
    v_mfma_f32_16x16x32_bf16 a[52:55], a[172:175], v[84:87], a[52:55]
    v_mfma_f32_16x16x32_bf16 v[116:119], v[252:255], v[84:87], v[116:119]
    ds_read_b64_tr_b16 a[168:169], v202 offset:32768
    v_mfma_f32_16x16x32_bf16 v[32:35], a[136:139], v[136:139], v[32:35]
    v_exp_f32 v16, v16
    v_mfma_f32_16x16x32_bf16 v[48:51], a[152:155], v[136:139], v[48:51]
    v_exp_f32 v17, v17
    v_mfma_f32_16x16x32_bf16 v[36:39], a[136:139], v[152:155], v[36:39]
    ds_read_b64_tr_b16 a[170:171], v202 offset:33792
    s_mov_b32 m0, s30
    v_mfma_f32_16x16x32_bf16 v[52:55], a[152:155], v[152:155], v[52:55]
    v_cvt_pk_bf16_f32 v66, v16, v17
    ds_read_b64_tr_b16 a[172:173], v203 offset:32768
    v_mfma_f32_16x16x32_bf16 v[40:43], a[136:139], v[168:171], v[40:43]
    v_exp_f32 v18, v18
    ds_write_b128 v250, v[246:249] offset:30720
    v_mfma_f32_16x16x32_bf16 v[56:59], a[152:155], v[168:171], v[56:59]
    v_exp_f32 v19, v19
    buffer_load_dwordx4 v216, s[16:19], s36 offen offset:0 lds
    v_cvt_pk_bf16_f32 v67, v18, v19
    ds_read_b128 a[136:139], v198 offset:49152
    v_exp_f32 v20, v20
    v_exp_f32 v21, v21
    v_mfma_f32_16x16x32_bf16 a[64:67], a[176:179], v[80:83], a[64:67]
    ds_read_b64_tr_b16 a[174:175], v203 offset:33792
    v_mfma_f32_16x16x32_bf16 a[80:83], a[180:183], v[80:83], a[80:83]
    v_cvt_pk_bf16_f32 v70, v20, v21
    ds_read_b128 a[152:155], v198 offset:50176
    v_mfma_f32_16x16x32_bf16 a[68:71], a[176:179], v[84:87], a[68:71]
    v_exp_f32 v22, v22
    ds_write_b128 v250, v[246:249] offset:31744
    v_mfma_f32_16x16x32_bf16 a[84:87], a[180:183], v[84:87], a[84:87]
    v_exp_f32 v23, v23
    v_mfma_f32_16x16x32_bf16 a[72:75], a[176:179], v[88:91], a[72:75]
    buffer_load_dwordx4 v217, s[16:19], s36 offen offset:1024 lds
    v_mfma_f32_16x16x32_bf16 a[88:91], a[180:183], v[88:91], a[88:91]
    v_cvt_pk_bf16_f32 v71, v22, v23
    v_mfma_f32_16x16x32_bf16 v[120:123], v[252:255], v[88:91], v[120:123]
    ds_read_b64_tr_b16 a[176:177], v204 offset:32768
    v_mfma_f32_16x16x32_bf16 v[32:35], a[140:143], v[140:143], v[32:35]
    v_exp_f32 v24, v24
    v_mfma_f32_16x16x32_bf16 v[48:51], a[156:159], v[140:143], v[48:51]
    v_exp_f32 v25, v25
    v_mfma_f32_16x16x32_bf16 v[36:39], a[140:143], v[156:159], v[36:39]
    ds_read_b64_tr_b16 a[178:179], v204 offset:33792
    v_mfma_f32_16x16x32_bf16 v[52:55], a[156:159], v[156:159], v[52:55]
    v_cvt_pk_bf16_f32 v74, v24, v25
    ds_read_b64_tr_b16 a[180:181], v205 offset:32768
    v_mfma_f32_16x16x32_bf16 v[40:43], a[140:143], v[172:175], v[40:43]
    v_exp_f32 v26, v26
    v_mfma_f32_16x16x32_bf16 v[56:59], a[156:159], v[172:175], v[56:59]
    v_exp_f32 v27, v27
    buffer_load_dwordx4 v218, s[16:19], s36 offen offset:2048 lds
    v_cvt_pk_bf16_f32 v75, v26, v27
    ds_read_b128 a[140:143], v199 offset:49152
    v_mfma_f32_16x16x32_bf16 a[96:99], a[184:187], v[80:83], a[96:99]
    v_mfma_f32_16x16x32_bf16 a[112:115], a[188:191], v[80:83], a[112:115]
    v_mfma_f32_16x16x32_bf16 a[100:103], a[184:187], v[84:87], a[100:103]
    ds_read_b64_tr_b16 a[182:183], v205 offset:33792
    v_mfma_f32_16x16x32_bf16 a[116:119], a[188:191], v[84:87], a[116:119]
    ds_read_b128 a[156:159], v199 offset:50176
    v_mfma_f32_16x16x32_bf16 a[104:107], a[184:187], v[88:91], a[104:107]
    v_mfma_f32_16x16x32_bf16 a[120:123], a[188:191], v[88:91], a[120:123]
    s_waitcnt lgkmcnt(8)
    buffer_load_dwordx4 v219, s[16:19], s36 offen offset:3072 lds
    ds_read_b64_tr_b16 a[184:185], v206 offset:32768
    v_mfma_f32_16x16x32_bf16 v[0:3], a[128:131], v[128:131], v[96:99]
    v_exp_f32 v32, v32
    v_mfma_f32_16x16x32_bf16 v[16:19], a[144:147], v[128:131], v[96:99]
    v_exp_f32 v33, v33
    v_mfma_f32_16x16x32_bf16 v[4:7], a[128:131], v[144:147], v[100:103]
    ds_read_b64_tr_b16 a[186:187], v206 offset:33792
    s_add_u32 m0, m0, s67
    v_mfma_f32_16x16x32_bf16 v[20:23], a[144:147], v[144:147], v[100:103]
    v_cvt_pk_bf16_f32 v80, v32, v33
    ds_read_b64_tr_b16 a[188:189], v207 offset:32768
    v_mfma_f32_16x16x32_bf16 v[8:11], a[128:131], v[160:163], v[104:107]
    v_exp_f32 v34, v34
    v_mfma_f32_16x16x32_bf16 v[24:27], a[144:147], v[160:163], v[104:107]
    v_exp_f32 v35, v35
    buffer_load_dwordx4 v216, s[16:19], s37 offen offset:0 lds
    v_cvt_pk_bf16_f32 v81, v34, v35
    ds_read_b128 a[128:131], v196 offset:57344
    v_mfma_f32_16x16x32_bf16 a[4:7], a[160:163], v[68:71], a[4:7]
    v_exp_f32 v36, v36
    v_mfma_f32_16x16x32_bf16 a[20:23], a[164:167], v[68:71], a[20:23]
    v_exp_f32 v37, v37
    v_mfma_f32_16x16x32_bf16 a[8:11], a[160:163], v[72:75], a[8:11]
    ds_read_b64_tr_b16 a[190:191], v207 offset:33792
    v_mfma_f32_16x16x32_bf16 a[24:27], a[164:167], v[72:75], a[24:27]
    v_cvt_pk_bf16_f32 v84, v36, v37
    ds_read_b128 a[144:147], v196 offset:58368
    v_exp_f32 v38, v38
    v_exp_f32 v39, v39
    v_mfma_f32_16x16x32_bf16 a[0:3], a[160:163], v[64:67], a[0:3]
    buffer_load_dwordx4 v217, s[16:19], s37 offen offset:1024 lds
    v_mfma_f32_16x16x32_bf16 a[16:19], a[164:167], v[64:67], a[16:19]
    v_cvt_pk_bf16_f32 v85, v38, v39
    v_mfma_f32_16x16x32_bf16 v[112:115], v[252:255], v[64:67], v[112:115]
    ds_read_b64_tr_b16 a[160:161], v200 offset:40960
    v_mfma_f32_16x16x32_bf16 v[0:3], a[132:135], v[132:135], v[0:3]
    v_exp_f32 v40, v40
    v_mfma_f32_16x16x32_bf16 v[16:19], a[148:151], v[132:135], v[16:19]
    v_exp_f32 v41, v41
    v_mfma_f32_16x16x32_bf16 v[4:7], a[132:135], v[148:151], v[4:7]
    ds_read_b64_tr_b16 a[162:163], v200 offset:41984
    v_mfma_f32_16x16x32_bf16 v[20:23], a[148:151], v[148:151], v[20:23]
    v_cvt_pk_bf16_f32 v88, v40, v41
    ds_read_b64_tr_b16 a[164:165], v201 offset:40960
    v_mfma_f32_16x16x32_bf16 v[8:11], a[132:135], v[164:167], v[8:11]
    v_exp_f32 v42, v42
    v_mfma_f32_16x16x32_bf16 v[24:27], a[148:151], v[164:167], v[24:27]
    v_exp_f32 v43, v43
    buffer_load_dwordx4 v218, s[16:19], s37 offen offset:2048 lds
    v_cvt_pk_bf16_f32 v89, v42, v43
    ds_read_b128 a[132:135], v197 offset:57344
    v_mfma_f32_16x16x32_bf16 a[40:43], a[168:171], v[72:75], a[40:43]
    v_mfma_f32_16x16x32_bf16 a[56:59], a[172:175], v[72:75], a[56:59]
    ds_read_b64_tr_b16 a[166:167], v201 offset:41984
    ds_read_b128 a[148:151], v197 offset:58368
    v_mfma_f32_16x16x32_bf16 a[32:35], a[168:171], v[64:67], a[32:35]
    v_mfma_f32_16x16x32_bf16 a[48:51], a[172:175], v[64:67], a[48:51]
    v_mfma_f32_16x16x32_bf16 a[36:39], a[168:171], v[68:71], a[36:39]
    s_waitcnt lgkmcnt(7)
    buffer_load_dwordx4 v219, s[16:19], s37 offen offset:3072 lds
    v_mfma_f32_16x16x32_bf16 a[52:55], a[172:175], v[68:71], a[52:55]
    v_mfma_f32_16x16x32_bf16 v[116:119], v[252:255], v[68:71], v[116:119]
    ds_read_b64_tr_b16 a[168:169], v202 offset:40960
    v_mfma_f32_16x16x32_bf16 v[0:3], a[136:139], v[136:139], v[0:3]
    v_exp_f32 v48, v48
    v_mfma_f32_16x16x32_bf16 v[16:19], a[152:155], v[136:139], v[16:19]
    v_exp_f32 v49, v49
    v_mfma_f32_16x16x32_bf16 v[4:7], a[136:139], v[152:155], v[4:7]
    ds_read_b64_tr_b16 a[170:171], v202 offset:41984
    v_mfma_f32_16x16x32_bf16 v[20:23], a[152:155], v[152:155], v[20:23]
    v_cvt_pk_bf16_f32 v82, v48, v49
    ds_read_b64_tr_b16 a[172:173], v203 offset:40960
    v_mfma_f32_16x16x32_bf16 v[8:11], a[136:139], v[168:171], v[8:11]
    v_exp_f32 v50, v50
    v_mfma_f32_16x16x32_bf16 v[24:27], a[152:155], v[168:171], v[24:27]
    v_exp_f32 v51, v51
    s_add_u32 s36, s36, 128
    s_bitset0_b32 s36, 11
    v_cvt_pk_bf16_f32 v83, v50, v51
    ds_read_b128 a[136:139], v198 offset:57344
    v_exp_f32 v52, v52
    v_exp_f32 v53, v53
    v_mfma_f32_16x16x32_bf16 a[64:67], a[176:179], v[64:67], a[64:67]
    ds_read_b64_tr_b16 a[174:175], v203 offset:41984
    buffer_load_dword v192, v233, s[96:99], s69 offen
    v_mfma_f32_16x16x32_bf16 a[80:83], a[180:183], v[64:67], a[80:83]
    v_cvt_pk_bf16_f32 v86, v52, v53
    ds_read_b128 a[152:155], v198 offset:58368
    v_mfma_f32_16x16x32_bf16 a[68:71], a[176:179], v[68:71], a[68:71]
    v_exp_f32 v54, v54
    v_mfma_f32_16x16x32_bf16 a[84:87], a[180:183], v[68:71], a[84:87]
    v_exp_f32 v55, v55
    v_mfma_f32_16x16x32_bf16 a[72:75], a[176:179], v[72:75], a[72:75]
    s_add_u32 s37, s37, 128
    s_bitset0_b32 s37, 11
    v_mfma_f32_16x16x32_bf16 a[88:91], a[180:183], v[72:75], a[88:91]
    v_cvt_pk_bf16_f32 v87, v54, v55
    v_mfma_f32_16x16x32_bf16 v[120:123], v[252:255], v[72:75], v[120:123]
    ds_read_b64_tr_b16 a[176:177], v204 offset:40960
    v_mfma_f32_16x16x32_bf16 v[0:3], a[140:143], v[140:143], v[0:3]
    v_exp_f32 v56, v56
    v_mfma_f32_16x16x32_bf16 v[16:19], a[156:159], v[140:143], v[16:19]
    v_exp_f32 v57, v57
    v_mfma_f32_16x16x32_bf16 v[4:7], a[140:143], v[156:159], v[4:7]
    ds_read_b64_tr_b16 a[178:179], v204 offset:41984
    v_mfma_f32_16x16x32_bf16 v[20:23], a[156:159], v[156:159], v[20:23]
    v_cvt_pk_bf16_f32 v90, v56, v57
    ds_read_b64_tr_b16 a[180:181], v205 offset:40960
    v_mfma_f32_16x16x32_bf16 v[8:11], a[140:143], v[172:175], v[8:11]
    v_exp_f32 v58, v58
    v_mfma_f32_16x16x32_bf16 v[24:27], a[156:159], v[172:175], v[24:27]
    v_exp_f32 v59, v59
    s_add_u32 s35, s35, s100
    s_bitset0_b32 s35, s42
    v_cvt_pk_bf16_f32 v91, v58, v59
    ds_read_b128 a[140:143], v199 offset:57344
    v_mfma_f32_16x16x32_bf16 a[96:99], a[184:187], v[64:67], a[96:99]
    v_mfma_f32_16x16x32_bf16 a[112:115], a[188:191], v[64:67], a[112:115]
    v_mfma_f32_16x16x32_bf16 a[100:103], a[184:187], v[68:71], a[100:103]
    ds_read_b64_tr_b16 a[182:183], v205 offset:41984
    v_mfma_f32_16x16x32_bf16 a[116:119], a[188:191], v[68:71], a[116:119]
    ds_read_b128 a[156:159], v199 offset:58368
    v_mfma_f32_16x16x32_bf16 a[104:107], a[184:187], v[72:75], a[104:107]
    v_mfma_f32_16x16x32_bf16 a[120:123], a[188:191], v[72:75], a[120:123]
    s_waitcnt lgkmcnt(7)
    ds_read_b64_tr_b16 a[184:185], v206 offset:40960
    s_waitcnt vmcnt(23)
    s_barrier
    v_mfma_f32_16x16x32_bf16 v[32:35], a[128:131], v[128:131], v[96:99]
    v_exp_f32 v0, v0
    v_mfma_f32_16x16x32_bf16 v[48:51], a[144:147], v[128:131], v[96:99]
    v_exp_f32 v1, v1
    v_mfma_f32_16x16x32_bf16 v[36:39], a[128:131], v[144:147], v[100:103]
    ds_read_b64_tr_b16 a[186:187], v206 offset:41984
    s_add_u32 m0, s29, 81920
    v_mfma_f32_16x16x32_bf16 v[52:55], a[144:147], v[144:147], v[100:103]
    v_cvt_pk_bf16_f32 v64, v0, v1
    ds_read_b64_tr_b16 a[188:189], v207 offset:40960
    v_mfma_f32_16x16x32_bf16 v[40:43], a[128:131], v[160:163], v[104:107]
    v_exp_f32 v2, v2
    v_mfma_f32_16x16x32_bf16 v[56:59], a[144:147], v[160:163], v[104:107]
    v_exp_f32 v3, v3
    buffer_load_dwordx4 v212, s[20:23], s35 offen offset:0 lds
    v_cvt_pk_bf16_f32 v65, v2, v3
    v_mfma_f32_16x16x32_bf16 a[4:7], a[160:163], v[84:87], a[4:7]
    v_exp_f32 v4, v4
    v_mfma_f32_16x16x32_bf16 a[20:23], a[164:167], v[84:87], a[20:23]
    v_exp_f32 v5, v5
    v_mfma_f32_16x16x32_bf16 a[8:11], a[160:163], v[88:91], a[8:11]
    ds_read_b64_tr_b16 a[190:191], v207 offset:41984
    v_mfma_f32_16x16x32_bf16 a[24:27], a[164:167], v[88:91], a[24:27]
    v_cvt_pk_bf16_f32 v68, v4, v5
    v_exp_f32 v6, v6
    v_exp_f32 v7, v7
    v_mfma_f32_16x16x32_bf16 a[0:3], a[160:163], v[80:83], a[0:3]
    buffer_load_dwordx4 v213, s[20:23], s35 offen offset:1024 lds
    v_mfma_f32_16x16x32_bf16 a[16:19], a[164:167], v[80:83], a[16:19]
    v_cvt_pk_bf16_f32 v69, v6, v7
    v_mfma_f32_16x16x32_bf16 v[112:115], v[252:255], v[80:83], v[112:115]
    ds_read_b64_tr_b16 a[160:161], v200 offset:49152
    v_mfma_f32_16x16x32_bf16 v[32:35], a[132:135], v[132:135], v[32:35]
    v_exp_f32 v8, v8
    v_mfma_f32_16x16x32_bf16 v[48:51], a[148:151], v[132:135], v[48:51]
    v_exp_f32 v9, v9
    v_mfma_f32_16x16x32_bf16 v[36:39], a[132:135], v[148:151], v[36:39]
    ds_read_b64_tr_b16 a[162:163], v200 offset:50176
    v_mfma_f32_16x16x32_bf16 v[52:55], a[148:151], v[148:151], v[52:55]
    v_cvt_pk_bf16_f32 v72, v8, v9
    ds_read_b64_tr_b16 a[164:165], v201 offset:49152
    v_mfma_f32_16x16x32_bf16 v[40:43], a[132:135], v[164:167], v[40:43]
    v_exp_f32 v10, v10
    v_mfma_f32_16x16x32_bf16 v[56:59], a[148:151], v[164:167], v[56:59]
    v_exp_f32 v11, v11
    buffer_load_dwordx4 v214, s[20:23], s35 offen offset:2048 lds
    v_cvt_pk_bf16_f32 v73, v10, v11
    v_mfma_f32_16x16x32_bf16 a[40:43], a[168:171], v[88:91], a[40:43]
    v_mfma_f32_16x16x32_bf16 a[56:59], a[172:175], v[88:91], a[56:59]
    ds_read_b64_tr_b16 a[166:167], v201 offset:50176
    v_mfma_f32_16x16x32_bf16 a[32:35], a[168:171], v[80:83], a[32:35]
    v_mfma_f32_16x16x32_bf16 a[48:51], a[172:175], v[80:83], a[48:51]
    v_mfma_f32_16x16x32_bf16 a[36:39], a[168:171], v[84:87], a[36:39]
    s_waitcnt lgkmcnt(4)
    buffer_load_dwordx4 v215, s[20:23], s35 offen offset:3072 lds
    v_mfma_f32_16x16x32_bf16 a[52:55], a[172:175], v[84:87], a[52:55]
    v_mfma_f32_16x16x32_bf16 v[116:119], v[252:255], v[84:87], v[116:119]
    ds_read_b64_tr_b16 a[168:169], v202 offset:49152
    v_mfma_f32_16x16x32_bf16 v[32:35], a[136:139], v[136:139], v[32:35]
    v_exp_f32 v16, v16
    v_mfma_f32_16x16x32_bf16 v[48:51], a[152:155], v[136:139], v[48:51]
    v_exp_f32 v17, v17
    v_mfma_f32_16x16x32_bf16 v[36:39], a[136:139], v[152:155], v[36:39]
    ds_read_b64_tr_b16 a[170:171], v202 offset:50176
    v_mfma_f32_16x16x32_bf16 v[52:55], a[152:155], v[152:155], v[52:55]
    v_cvt_pk_bf16_f32 v66, v16, v17
    ds_read_b64_tr_b16 a[172:173], v203 offset:49152
    v_mfma_f32_16x16x32_bf16 v[40:43], a[136:139], v[168:171], v[40:43]
    v_exp_f32 v18, v18
    v_mfma_f32_16x16x32_bf16 v[56:59], a[152:155], v[168:171], v[56:59]
    v_exp_f32 v19, v19
    s_nop 0
    v_cvt_pk_bf16_f32 v67, v18, v19
    v_exp_f32 v20, v20
    v_exp_f32 v21, v21
    v_mfma_f32_16x16x32_bf16 a[64:67], a[176:179], v[80:83], a[64:67]
    ds_read_b64_tr_b16 a[174:175], v203 offset:50176
    v_mfma_f32_16x16x32_bf16 a[80:83], a[180:183], v[80:83], a[80:83]
    v_cvt_pk_bf16_f32 v70, v20, v21
    v_mfma_f32_16x16x32_bf16 a[68:71], a[176:179], v[84:87], a[68:71]
    v_exp_f32 v22, v22
    v_mfma_f32_16x16x32_bf16 a[84:87], a[180:183], v[84:87], a[84:87]
    v_exp_f32 v23, v23
    v_mfma_f32_16x16x32_bf16 a[72:75], a[176:179], v[88:91], a[72:75]
    v_mfma_f32_16x16x32_bf16 a[88:91], a[180:183], v[88:91], a[88:91]
    v_cvt_pk_bf16_f32 v71, v22, v23
    v_mfma_f32_16x16x32_bf16 v[120:123], v[252:255], v[88:91], v[120:123]
    ds_read_b64_tr_b16 a[176:177], v204 offset:49152
    v_mfma_f32_16x16x32_bf16 v[32:35], a[140:143], v[140:143], v[32:35]
    v_exp_f32 v24, v24
    v_mfma_f32_16x16x32_bf16 v[48:51], a[156:159], v[140:143], v[48:51]
    v_exp_f32 v25, v25
    v_mfma_f32_16x16x32_bf16 v[36:39], a[140:143], v[156:159], v[36:39]
    ds_read_b64_tr_b16 a[178:179], v204 offset:50176
    v_mfma_f32_16x16x32_bf16 v[52:55], a[156:159], v[156:159], v[52:55]
    v_cvt_pk_bf16_f32 v74, v24, v25
    ds_read_b64_tr_b16 a[180:181], v205 offset:49152
    v_mfma_f32_16x16x32_bf16 v[40:43], a[140:143], v[172:175], v[40:43]
    v_exp_f32 v26, v26
    v_mfma_f32_16x16x32_bf16 v[56:59], a[156:159], v[172:175], v[56:59]
    v_exp_f32 v27, v27
    s_nop 0
    v_cvt_pk_bf16_f32 v75, v26, v27
    v_mfma_f32_16x16x32_bf16 a[96:99], a[184:187], v[80:83], a[96:99]
    v_mfma_f32_16x16x32_bf16 a[112:115], a[188:191], v[80:83], a[112:115]
    v_mfma_f32_16x16x32_bf16 a[100:103], a[184:187], v[84:87], a[100:103]
    ds_read_b64_tr_b16 a[182:183], v205 offset:50176
    v_mfma_f32_16x16x32_bf16 a[116:119], a[188:191], v[84:87], a[116:119]
    v_mfma_f32_16x16x32_bf16 a[104:107], a[184:187], v[88:91], a[104:107]
    v_mfma_f32_16x16x32_bf16 a[120:123], a[188:191], v[88:91], a[120:123]
    s_waitcnt lgkmcnt(4)
    ds_read_b64_tr_b16 a[184:185], v206 offset:49152
    v_exp_f32 v32, v32
    v_exp_f32 v33, v33
    ds_read_b64_tr_b16 a[186:187], v206 offset:50176
    v_cvt_pk_bf16_f32 v80, v32, v33
    ds_read_b64_tr_b16 a[188:189], v207 offset:49152
    v_exp_f32 v34, v34
    v_exp_f32 v35, v35
    s_add_u32 s35, s35, s100
    s_bitset0_b32 s35, s42
    v_cvt_pk_bf16_f32 v81, v34, v35
    v_mfma_f32_16x16x32_bf16 a[4:7], a[160:163], v[68:71], a[4:7]
    v_exp_f32 v36, v36
    v_mfma_f32_16x16x32_bf16 a[20:23], a[164:167], v[68:71], a[20:23]
    v_exp_f32 v37, v37
    v_mfma_f32_16x16x32_bf16 a[8:11], a[160:163], v[72:75], a[8:11]
    ds_read_b64_tr_b16 a[190:191], v207 offset:50176
    v_mfma_f32_16x16x32_bf16 a[24:27], a[164:167], v[72:75], a[24:27]
    v_cvt_pk_bf16_f32 v84, v36, v37
    v_exp_f32 v38, v38
    v_exp_f32 v39, v39
    v_mfma_f32_16x16x32_bf16 a[0:3], a[160:163], v[64:67], a[0:3]
    v_mfma_f32_16x16x32_bf16 a[16:19], a[164:167], v[64:67], a[16:19]
    v_cvt_pk_bf16_f32 v85, v38, v39
    v_mfma_f32_16x16x32_bf16 v[112:115], v[252:255], v[64:67], v[112:115]
    ds_read_b64_tr_b16 a[160:161], v200 offset:57344
    v_exp_f32 v40, v40
    v_exp_f32 v41, v41
    ds_read_b64_tr_b16 a[162:163], v200 offset:58368
    v_cvt_pk_bf16_f32 v88, v40, v41
    ds_read_b64_tr_b16 a[164:165], v201 offset:57344
    v_exp_f32 v42, v42
    v_exp_f32 v43, v43
    s_nop 0
    v_cvt_pk_bf16_f32 v89, v42, v43
    v_mfma_f32_16x16x32_bf16 a[40:43], a[168:171], v[72:75], a[40:43]
    v_mfma_f32_16x16x32_bf16 a[56:59], a[172:175], v[72:75], a[56:59]
    ds_read_b64_tr_b16 a[166:167], v201 offset:58368
    v_mfma_f32_16x16x32_bf16 a[32:35], a[168:171], v[64:67], a[32:35]
    v_mfma_f32_16x16x32_bf16 a[48:51], a[172:175], v[64:67], a[48:51]
    v_mfma_f32_16x16x32_bf16 a[36:39], a[168:171], v[68:71], a[36:39]
    s_waitcnt lgkmcnt(4)
    v_mfma_f32_16x16x32_bf16 a[52:55], a[172:175], v[68:71], a[52:55]
    v_mfma_f32_16x16x32_bf16 v[116:119], v[252:255], v[68:71], v[116:119]
    ds_read_b64_tr_b16 a[168:169], v202 offset:57344
    v_exp_f32 v48, v48
    v_exp_f32 v49, v49
    ds_read_b64_tr_b16 a[170:171], v202 offset:58368
    v_cvt_pk_bf16_f32 v82, v48, v49
    ds_read_b64_tr_b16 a[172:173], v203 offset:57344
    v_exp_f32 v50, v50
    v_exp_f32 v51, v51
    s_nop 0
    v_cvt_pk_bf16_f32 v83, v50, v51
    v_exp_f32 v52, v52
    v_exp_f32 v53, v53
    v_mfma_f32_16x16x32_bf16 a[64:67], a[176:179], v[64:67], a[64:67]
    ds_read_b64_tr_b16 a[174:175], v203 offset:58368
    v_mfma_f32_16x16x32_bf16 a[80:83], a[180:183], v[64:67], a[80:83]
    v_cvt_pk_bf16_f32 v86, v52, v53
    v_mfma_f32_16x16x32_bf16 a[68:71], a[176:179], v[68:71], a[68:71]
    v_exp_f32 v54, v54
    v_mfma_f32_16x16x32_bf16 a[84:87], a[180:183], v[68:71], a[84:87]
    v_exp_f32 v55, v55
    v_mfma_f32_16x16x32_bf16 a[72:75], a[176:179], v[72:75], a[72:75]
    v_mfma_f32_16x16x32_bf16 a[88:91], a[180:183], v[72:75], a[88:91]
    v_cvt_pk_bf16_f32 v87, v54, v55
    v_mfma_f32_16x16x32_bf16 v[120:123], v[252:255], v[72:75], v[120:123]
    ds_read_b64_tr_b16 a[176:177], v204 offset:57344
    v_exp_f32 v56, v56
    v_exp_f32 v57, v57
    ds_read_b64_tr_b16 a[178:179], v204 offset:58368
    v_cvt_pk_bf16_f32 v90, v56, v57
    ds_read_b64_tr_b16 a[180:181], v205 offset:57344
    v_exp_f32 v58, v58
    v_exp_f32 v59, v59
    s_nop 0
    v_cvt_pk_bf16_f32 v91, v58, v59
    v_mfma_f32_16x16x32_bf16 a[96:99], a[184:187], v[64:67], a[96:99]
    v_mfma_f32_16x16x32_bf16 a[112:115], a[188:191], v[64:67], a[112:115]
    v_mfma_f32_16x16x32_bf16 a[100:103], a[184:187], v[68:71], a[100:103]
    ds_read_b64_tr_b16 a[182:183], v205 offset:58368
    v_mfma_f32_16x16x32_bf16 a[116:119], a[188:191], v[68:71], a[116:119]
    v_mfma_f32_16x16x32_bf16 a[104:107], a[184:187], v[72:75], a[104:107]
    v_mfma_f32_16x16x32_bf16 a[120:123], a[188:191], v[72:75], a[120:123]
    s_waitcnt lgkmcnt(12)
    ds_read_b64_tr_b16 a[184:185], v206 offset:57344
    s_waitcnt vmcnt(13)
    s_barrier
    s_mov_b32 s40, 131072
    s_mov_b32 s41, 0
    s_mov_b32 s42, 32768
    s_mov_b32 s43, 0
    s_add_u32 s39, s29, 114688
    v_mov_b32 v224, v200
    v_mov_b32 v225, v201
    v_mov_b32 v226, v202
    v_mov_b32 v227, v203
    v_mov_b32 v228, v204
    v_mov_b32 v229, v205
    v_mov_b32 v230, v206
    v_mov_b32 v231, v207
    v_add_u32 v222, 131072, v220
    v_add_u32 v223, 131072, v221
    s_waitcnt lgkmcnt(0)
    ds_read_b64_tr_b16 a[186:187], v206 offset:58368
    ds_read_b64_tr_b16 a[188:189], v207 offset:57344
    ds_read_b128 a[192:195], v222 offset:0
    v_mfma_f32_16x16x32_bf16 a[4:7], a[160:163], v[84:87], a[4:7]
    v_mfma_f32_16x16x32_bf16 a[20:23], a[164:167], v[84:87], a[20:23]
    v_mfma_f32_16x16x32_bf16 a[8:11], a[160:163], v[88:91], a[8:11]
    ds_read_b64_tr_b16 a[190:191], v207 offset:58368
    v_mfma_f32_16x16x32_bf16 a[24:27], a[164:167], v[88:91], a[24:27]
    ds_read_b128 a[196:199], v222 offset:2048
    v_mfma_f32_16x16x32_bf16 a[0:3], a[160:163], v[80:83], a[0:3]
    v_mfma_f32_16x16x32_bf16 a[16:19], a[164:167], v[80:83], a[16:19]
    v_mfma_f32_16x16x32_bf16 v[112:115], v[252:255], v[80:83], v[112:115]
    ds_read_b64_tr_b16 a[160:161], v224 offset:0
    ds_read_b64_tr_b16 a[162:163], v224 offset:1024
    ds_read_b64_tr_b16 a[164:165], v225 offset:0
    ds_read_b64_tr_b16 a[166:167], v225 offset:1024
    ds_read_b128 a[200:203], v222 offset:4096
    v_mfma_f32_16x16x32_bf16 a[40:43], a[168:171], v[88:91], a[40:43]
    v_mfma_f32_16x16x32_bf16 a[56:59], a[172:175], v[88:91], a[56:59]
    v_mfma_f32_16x16x32_bf16 a[32:35], a[168:171], v[80:83], a[32:35]
    v_mfma_f32_16x16x32_bf16 a[48:51], a[172:175], v[80:83], a[48:51]
    ds_read_b128 a[204:207], v222 offset:6144
    v_mfma_f32_16x16x32_bf16 a[36:39], a[168:171], v[84:87], a[36:39]
    v_mfma_f32_16x16x32_bf16 a[52:55], a[172:175], v[84:87], a[52:55]
    v_mfma_f32_16x16x32_bf16 v[116:119], v[252:255], v[84:87], v[116:119]
    ds_read_b64_tr_b16 a[168:169], v226 offset:0
    ds_read_b64_tr_b16 a[170:171], v226 offset:1024
    ds_read_b64_tr_b16 a[172:173], v227 offset:0
    ds_read_b64_tr_b16 a[174:175], v227 offset:1024
    ds_write_b128 v250, v[246:249] offset:63488
    v_mfma_f32_16x16x32_bf16 a[64:67], a[176:179], v[80:83], a[64:67]
    v_mfma_f32_16x16x32_bf16 a[80:83], a[180:183], v[80:83], a[80:83]
    v_mfma_f32_16x16x32_bf16 a[68:71], a[176:179], v[84:87], a[68:71]
    v_mfma_f32_16x16x32_bf16 a[84:87], a[180:183], v[84:87], a[84:87]
    ds_write_b128 v250, v[246:249] offset:64512
    v_mfma_f32_16x16x32_bf16 a[72:75], a[176:179], v[88:91], a[72:75]
    v_mfma_f32_16x16x32_bf16 a[88:91], a[180:183], v[88:91], a[88:91]
    v_mfma_f32_16x16x32_bf16 v[120:123], v[252:255], v[88:91], v[120:123]
    ds_read_b64_tr_b16 a[176:177], v228 offset:0
    ds_read_b64_tr_b16 a[178:179], v228 offset:1024
    ds_read_b64_tr_b16 a[180:181], v229 offset:0
    ds_read_b64_tr_b16 a[182:183], v229 offset:1024
    s_waitcnt lgkmcnt(15)
    v_mfma_f32_16x16x32_bf16 a[96:99], a[184:187], v[80:83], a[96:99]
    v_mfma_f32_16x16x32_bf16 a[112:115], a[188:191], v[80:83], a[112:115]
    v_mfma_f32_16x16x32_bf16 a[100:103], a[184:187], v[84:87], a[100:103]
    v_mfma_f32_16x16x32_bf16 a[116:119], a[188:191], v[84:87], a[116:119]
    v_mfma_f32_16x16x32_bf16 a[104:107], a[184:187], v[88:91], a[104:107]
    v_mfma_f32_16x16x32_bf16 a[120:123], a[188:191], v[88:91], a[120:123]
    ds_read_b64_tr_b16 a[184:185], v230 offset:0
    ds_read_b64_tr_b16 a[186:187], v230 offset:1024
    ds_read_b64_tr_b16 a[188:189], v231 offset:0
    ds_read_b64_tr_b16 a[190:191], v231 offset:1024
    s_branch L_w3e_A
    s_endpgm
.section .rodata,"a"
.p2align 6
.amdhsa_kernel concat_heads__mha_block_cached__mha_block_cached__near_ridge_kernel
  .amdhsa_next_free_vgpr 512
  .amdhsa_next_free_sgpr 102
  .amdhsa_accum_offset 256
  .amdhsa_group_segment_fixed_size 0
  .amdhsa_kernarg_size 104
  .amdhsa_user_sgpr_count 2
  .amdhsa_user_sgpr_kernarg_segment_ptr 1
  .amdhsa_system_sgpr_workgroup_id_x 1
.end_amdhsa_kernel
```
